```python
import torch

def _softmax(x, axis=-1):
    return torch.softmax(x, dim=axis)
def _gelu(x):
    return torch.nn.functional.gelu(x, approximate="tanh")
def _silu(x):
    return torch.nn.functional.silu(x)
def _sigmoid(x):
    return torch.sigmoid(x)
def _layernorm(x, axis=-1, eps=1e-5):
    m = x.mean(dim=axis, keepdim=True)
    v = x.var(dim=axis, keepdim=True, unbiased=False)
    return (x - m) / torch.sqrt(v + eps)
def _scatter_add(tgt, idx, src, axis=0):
    return tgt.clone().index_add_(axis, idx, src)
def _segment_sum(src, seg, n):
    out = torch.zeros((n,) + src.shape[1:], dtype=src.dtype)
    return out.index_add_(0, seg, src)
def _pad(x, pw):
    flat = tuple(v for pair in reversed(pw) for v in pair)
    return torch.nn.functional.pad(x, flat)

kernel_name = 'standalone__gqa_softmax__near_ridge'

def setup_inputs():

    _w = (lambda a: (lambda t: t.to(torch.bfloat16) if t.is_floating_point() else t)(torch.as_tensor(a)))
    B, Hq, Hkv, Sq, Sk, D = 32, 16, 8, 256, 512, 256
    return {
        "q": _w((lambda *s: torch.randn(*s, dtype=torch.bfloat16) * 0.8)(B, Hq, Sq, D)),
        "k": _w((lambda *s: torch.randn(*s, dtype=torch.bfloat16) * 0.8)(B, Hkv, Sk, D)),
        "v": _w((lambda *s: torch.randn(*s, dtype=torch.bfloat16) * 0.05)(B, Hkv, Sk, D)),
    }

def reference(q, k, v):
    B, Hq, Sq, D = q.shape
    Hkv = k.shape[1]
    rep = Hq // Hkv
    k = (lambda x, n, axis: torch.repeat_interleave(x, n, dim=axis))(k, rep, axis=1)
    v = (lambda x, n, axis: torch.repeat_interleave(x, n, dim=axis))(v, rep, axis=1)
    scale = D ** -0.5
    scores = torch.einsum("bhqd,bhkd->bhqk", q, k) * scale
    p = _softmax(scores, axis=-1)
    return torch.einsum("bhqk,bhkd->bhqd", p, v)
```

```asm
; @launch grid=(256,1,1) block=(256,1,1) lds=163840
.amdgcn_target "amdgcn-amd-amdhsa--gfx950"
.text
.globl standalone__gqa_softmax__near_ridge_kernel
.p2align 8
.type standalone__gqa_softmax__near_ridge_kernel,@function
standalone__gqa_softmax__near_ridge_kernel:
    s_cmp_ge_u32 s2, 256
    s_cbranch_scc1 EXIT
    s_load_dwordx4 s[44:47], s[0:1], 0
    s_load_dwordx4 s[48:51], s[0:1], 16
    v_and_b32 v234, 63, v0
    v_lshrrev_b32 v237, 6, v0
    v_and_b32 v235, 31, v0
    v_readfirstlane_b32 s21, v237
    v_lshrrev_b32 v236, 5, v234
    v_lshrrev_b32 v238, 1, v235
    v_mul_u32_u24 v216, 1056, v238
    v_and_b32 v238, 1, v235
    v_lshl_add_u32 v216, v238, 9, v216
    v_xor_b32 v238, v238, v236
    v_lshl_add_u32 v216, v238, 4, v216
    v_bfe_u32 v238, v234, 3, 1
    v_lshl_add_u32 v238, v236, 1, v238
    v_mul_u32_u24 v217, 1088, v238
    v_and_b32 v238, 1, v234
    v_lshl_add_u32 v217, v238, 5, v217
    v_bfe_u32 v238, v234, 4, 1
    v_lshl_add_u32 v217, v238, 4, v217
    v_bfe_u32 v238, v234, 1, 1
    v_lshl_add_u32 v217, v238, 3, v217
    v_bfe_u32 v238, v234, 2, 1
    v_mul_u32_u24 v239, 384, v238
    v_add_u32 v218, v217, v239
    v_mul_u32_u24 v239, 640, v238
    v_add_u32 v217, v217, v239
    v_lshlrev_b32 v238, 12, v237
    v_lshl_add_u32 v238, v236, 9, v238
    v_xor_b32 v239, v235, v236
    v_lshl_add_u32 v222, v239, 4, v238
    v_lshlrev_b32 v239, 3, v236
    v_xor_b32 v239, v235, v239
    v_lshl_add_u32 v223, v239, 4, v238
    v_lshlrev_b32 v238, 15, v237
    v_lshrrev_b32 v239, 3, v234
    v_lshl_add_u32 v238, v239, 9, v238
    v_and_b32 v239, 7, v234
    v_lshrrev_b32 v240, 4, v234
    v_xor_b32 v239, v239, v240
    v_lshl_add_u32 v224, v239, 4, v238
    v_xor_b32 v225, 64, v224
    v_bfe_u32 v238, v235, 1, 3
    v_xor_b32 v238, v238, v236
    v_lshlrev_b32 v238, 4, v238
    v_lshl_add_u32 v250, v235, 7, v238
    s_and_b32 s36, s2, 7
    s_lshr_b32 s37, s2, 3
    s_and_b32 s38, s37, 1
    s_lshr_b32 s37, s37, 1
    s_lshl_b32 s37, s37, 3
    s_add_u32 s37, s37, s36
    s_lshl_b32 s39, s37, 2
    s_add_u32 s39, s39, s38
    s_lshl_b32 s31, s39, 17
    s_add_u32 s32, s31, 16384
    s_mov_b32 s41, s31
    s_mul_i32 s35, s21, 2304
    s_add_u32 s35, s35, 154624
    s_lshl_b32 s37, s37, 19
    s_mov_b32 s20, 0x3db8aa3b
    s_mov_b32 s40, 0x43800000
    s_mul_i32 s24, s21, 4224
    s_mov_b32 s52, s24
    s_add_u32 s33, s24, 67584
    s_mul_i32 s53, s21, 4352
    s_add_u32 s25, s53, 67584
    s_add_u32 s34, s25, 87040
    s_mov_b32 s22, 0
    s_mov_b32 s23, 0
    s_mov_b32 s26, 0
    s_mov_b32 s27, 67584
    s_mov_b32 s29, 0
    s_waitcnt lgkmcnt(0)
    s_mov_b32 s4, s44
    s_and_b32 s5, s45, 0xffff
    s_mov_b32 s6, 0x4000000
    s_mov_b32 s7, 0x20000
    s_add_u32 s8, s46, s37
    s_addc_u32 s9, s47, 0
    s_and_b32 s9, s9, 0xffff
    s_mov_b32 s10, 524288
    s_mov_b32 s11, 0x20000
    s_add_u32 s12, s48, s37
    s_addc_u32 s13, s49, 0
    s_and_b32 s13, s13, 0xffff
    s_mov_b32 s14, 524288
    s_mov_b32 s15, 0x20000
    s_mov_b32 s16, s50
    s_and_b32 s17, s51, 0xffff
    s_mov_b32 s18, 0x4000000
    s_mov_b32 s19, 0x20000
    s_bitcmp1_b32 s2, 4
    s_cbranch_scc0 TYPE_A
    v_lshlrev_b32 v243, 15, v237
    v_lshl_add_u32 v243, v235, 9, v243
    v_lshl_add_u32 v243, v236, 4, v243
    s_add_u32 m0, s24, 0
    s_nop 0
    buffer_load_dwordx4 v222, s[8:11], s22 offen offset:0 nt lds
    s_add_u32 m0, s24, 32
    s_nop 0
    buffer_load_dwordx4 v222, s[8:11], s22 offen offset:1024 nt lds
    s_add_u32 m0, s24, 64
    s_nop 0
    buffer_load_dwordx4 v222, s[8:11], s22 offen offset:2048 nt lds
    s_add_u32 m0, s24, 96
    s_nop 0
    buffer_load_dwordx4 v222, s[8:11], s22 offen offset:3072 nt lds
    s_add_u32 s22, s22, 16384
    s_add_u32 s24, s24, 16896
    s_cmp_ge_u32 s24, s33
    s_cselect_b32 s36, 67584, 0
    s_sub_u32 s24, s24, s36
    buffer_load_dwordx4 a[128:131], v243, s[4:7], s31 offen offset:0 nt
    buffer_load_dwordx4 a[132:135], v243, s[4:7], s31 offen offset:32 nt
    buffer_load_dwordx4 a[136:139], v243, s[4:7], s31 offen offset:64 nt
    buffer_load_dwordx4 a[140:143], v243, s[4:7], s31 offen offset:96 nt
    buffer_load_dwordx4 a[144:147], v243, s[4:7], s31 offen offset:128 nt
    buffer_load_dwordx4 a[148:151], v243, s[4:7], s31 offen offset:160 nt
    buffer_load_dwordx4 a[152:155], v243, s[4:7], s31 offen offset:192 nt
    buffer_load_dwordx4 a[156:159], v243, s[4:7], s31 offen offset:224 nt
    buffer_load_dwordx4 a[160:163], v243, s[4:7], s31 offen offset:256 nt
    buffer_load_dwordx4 a[164:167], v243, s[4:7], s31 offen offset:288 nt
    buffer_load_dwordx4 a[168:171], v243, s[4:7], s31 offen offset:320 nt
    buffer_load_dwordx4 a[172:175], v243, s[4:7], s31 offen offset:352 nt
    buffer_load_dwordx4 a[176:179], v243, s[4:7], s31 offen offset:384 nt
    buffer_load_dwordx4 a[180:183], v243, s[4:7], s31 offen offset:416 nt
    buffer_load_dwordx4 a[184:187], v243, s[4:7], s31 offen offset:448 nt
    buffer_load_dwordx4 a[188:191], v243, s[4:7], s31 offen offset:480 nt
    buffer_load_dwordx4 a[192:195], v243, s[4:7], s32 offen offset:0 nt
    buffer_load_dwordx4 a[196:199], v243, s[4:7], s32 offen offset:32 nt
    buffer_load_dwordx4 a[200:203], v243, s[4:7], s32 offen offset:64 nt
    buffer_load_dwordx4 a[204:207], v243, s[4:7], s32 offen offset:96 nt
    buffer_load_dwordx4 a[208:211], v243, s[4:7], s32 offen offset:128 nt
    buffer_load_dwordx4 a[212:215], v243, s[4:7], s32 offen offset:160 nt
    buffer_load_dwordx4 a[216:219], v243, s[4:7], s32 offen offset:192 nt
    buffer_load_dwordx4 a[220:223], v243, s[4:7], s32 offen offset:224 nt
    buffer_load_dwordx4 a[224:227], v243, s[4:7], s32 offen offset:256 nt
    buffer_load_dwordx4 a[228:231], v243, s[4:7], s32 offen offset:288 nt
    buffer_load_dwordx4 a[232:235], v243, s[4:7], s32 offen offset:320 nt
    buffer_load_dwordx4 a[236:239], v243, s[4:7], s32 offen offset:352 nt
    buffer_load_dwordx4 a[240:243], v243, s[4:7], s32 offen offset:384 nt
    buffer_load_dwordx4 a[244:247], v243, s[4:7], s32 offen offset:416 nt
    buffer_load_dwordx4 a[248:251], v243, s[4:7], s32 offen offset:448 nt
    buffer_load_dwordx4 a[252:255], v243, s[4:7], s32 offen offset:480 nt
    s_add_u32 m0, s25, 0
    s_nop 0
    buffer_load_dwordx4 v223, s[12:15], s23 offen offset:0 nt lds
    s_add_u32 m0, s25, 64
    s_nop 0
    buffer_load_dwordx4 v223, s[12:15], s23 offen offset:1024 nt lds
    s_add_u32 m0, s25, 128
    s_nop 0
    buffer_load_dwordx4 v223, s[12:15], s23 offen offset:2048 nt lds
    s_add_u32 m0, s25, 192
    s_nop 0
    buffer_load_dwordx4 v223, s[12:15], s23 offen offset:3072 nt lds
    s_add_u32 s23, s23, 16384
    s_add_u32 s25, s25, 17408
    s_cmp_ge_u32 s25, s34
    s_cselect_b32 s36, 87040, 0
    s_sub_u32 s25, s25, s36
    s_add_u32 m0, s24, 0
    s_nop 0
    buffer_load_dwordx4 v222, s[8:11], s22 offen offset:0 nt lds
    s_add_u32 m0, s24, 32
    s_nop 0
    buffer_load_dwordx4 v222, s[8:11], s22 offen offset:1024 nt lds
    s_add_u32 m0, s24, 64
    s_nop 0
    buffer_load_dwordx4 v222, s[8:11], s22 offen offset:2048 nt lds
    s_add_u32 m0, s24, 96
    s_nop 0
    buffer_load_dwordx4 v222, s[8:11], s22 offen offset:3072 nt lds
    s_add_u32 s22, s22, 16384
    s_add_u32 s24, s24, 16896
    s_cmp_ge_u32 s24, s33
    s_cselect_b32 s36, 67584, 0
    s_sub_u32 s24, s24, s36
    s_add_u32 m0, s25, 0
    s_nop 0
    buffer_load_dwordx4 v223, s[12:15], s23 offen offset:0 nt lds
    s_add_u32 m0, s25, 64
    s_nop 0
    buffer_load_dwordx4 v223, s[12:15], s23 offen offset:1024 nt lds
    s_add_u32 m0, s25, 128
    s_nop 0
    buffer_load_dwordx4 v223, s[12:15], s23 offen offset:2048 nt lds
    s_add_u32 m0, s25, 192
    s_nop 0
    buffer_load_dwordx4 v223, s[12:15], s23 offen offset:3072 nt lds
    s_add_u32 s23, s23, 16384
    s_add_u32 s25, s25, 17408
    s_cmp_ge_u32 s25, s34
    s_cselect_b32 s36, 87040, 0
    s_sub_u32 s25, s25, s36
    s_add_u32 m0, s24, 0
    s_nop 0
    buffer_load_dwordx4 v222, s[8:11], s22 offen offset:0 nt lds
    s_add_u32 m0, s24, 32
    s_nop 0
    buffer_load_dwordx4 v222, s[8:11], s22 offen offset:1024 nt lds
    s_add_u32 m0, s24, 64
    s_nop 0
    buffer_load_dwordx4 v222, s[8:11], s22 offen offset:2048 nt lds
    s_add_u32 m0, s24, 96
    s_nop 0
    buffer_load_dwordx4 v222, s[8:11], s22 offen offset:3072 nt lds
    s_add_u32 s22, s22, 16384
    s_add_u32 s24, s24, 16896
    s_cmp_ge_u32 s24, s33
    s_cselect_b32 s36, 67584, 0
    s_sub_u32 s24, s24, s36
    s_add_u32 m0, s25, 0
    s_nop 0
    buffer_load_dwordx4 v223, s[12:15], s23 offen offset:0 nt lds
    s_add_u32 m0, s25, 64
    s_nop 0
    buffer_load_dwordx4 v223, s[12:15], s23 offen offset:1024 nt lds
    s_add_u32 m0, s25, 128
    s_nop 0
    buffer_load_dwordx4 v223, s[12:15], s23 offen offset:2048 nt lds
    s_add_u32 m0, s25, 192
    s_nop 0
    buffer_load_dwordx4 v223, s[12:15], s23 offen offset:3072 nt lds
    s_add_u32 s23, s23, 16384
    s_add_u32 s25, s25, 17408
    s_cmp_ge_u32 s25, s34
    s_cselect_b32 s36, 87040, 0
    s_sub_u32 s25, s25, s36
    s_add_u32 m0, s24, 0
    s_nop 0
    buffer_load_dwordx4 v222, s[8:11], s22 offen offset:0 nt lds
    s_add_u32 m0, s24, 32
    s_nop 0
    buffer_load_dwordx4 v222, s[8:11], s22 offen offset:1024 nt lds
    s_add_u32 m0, s24, 64
    s_nop 0
    buffer_load_dwordx4 v222, s[8:11], s22 offen offset:2048 nt lds
    s_add_u32 m0, s24, 96
    s_nop 0
    buffer_load_dwordx4 v222, s[8:11], s22 offen offset:3072 nt lds
    s_add_u32 s22, s22, 16384
    s_add_u32 s24, s24, 16896
    s_cmp_ge_u32 s24, s33
    s_cselect_b32 s36, 67584, 0
    s_sub_u32 s24, s24, s36
    s_add_u32 s41, s31, 262144
    v_add_u32 v219, s26, v216
    s_add_u32 s26, s26, 16896
    s_cmp_ge_u32 s26, 67584
    s_cselect_b32 s26, 0, s26
    s_mov_b32 s30, 0
    s_waitcnt vmcnt(24)
    s_barrier
    s_branch BLOCK_TOP
TYPE_A:
    s_add_u32 m0, s24, 0
    s_nop 0
    buffer_load_dwordx4 v222, s[8:11], s22 offen offset:0 nt lds
    s_add_u32 m0, s24, 32
    s_nop 0
    buffer_load_dwordx4 v222, s[8:11], s22 offen offset:1024 nt lds
    s_add_u32 m0, s24, 64
    s_nop 0
    buffer_load_dwordx4 v222, s[8:11], s22 offen offset:2048 nt lds
    s_add_u32 m0, s24, 96
    s_nop 0
    buffer_load_dwordx4 v222, s[8:11], s22 offen offset:3072 nt lds
    s_add_u32 s22, s22, 16384
    s_add_u32 s24, s24, 16896
    s_cmp_ge_u32 s24, s33
    s_cselect_b32 s36, 67584, 0
    s_sub_u32 s24, s24, s36
    s_add_u32 m0, s25, 0
    s_add_u32 s37, s41, 16384
    buffer_load_dwordx4 v224, s[4:7], s37 offen nt lds
    s_add_u32 m0, s25, 1024
    s_add_u32 s37, s41, 20480
    buffer_load_dwordx4 v225, s[4:7], s37 offen nt lds
    s_add_u32 m0, s25, 2048
    s_add_u32 s37, s41, 24576
    buffer_load_dwordx4 v224, s[4:7], s37 offen nt lds
    s_add_u32 m0, s25, 3072
    s_add_u32 s37, s41, 28672
    buffer_load_dwordx4 v225, s[4:7], s37 offen nt lds
    s_add_u32 s25, s25, 17408
    s_cmp_ge_u32 s25, s34
    s_cselect_b32 s36, 87040, 0
    s_sub_u32 s25, s25, s36
    s_add_u32 m0, s25, 0
    s_add_u32 s37, s41, 16512
    buffer_load_dwordx4 v224, s[4:7], s37 offen nt lds
    s_add_u32 m0, s25, 1024
    s_add_u32 s37, s41, 20608
    buffer_load_dwordx4 v225, s[4:7], s37 offen nt lds
    s_add_u32 m0, s25, 2048
    s_add_u32 s37, s41, 24704
    buffer_load_dwordx4 v224, s[4:7], s37 offen nt lds
    s_add_u32 m0, s25, 3072
    s_add_u32 s37, s41, 28800
    buffer_load_dwordx4 v225, s[4:7], s37 offen nt lds
    s_add_u32 s25, s25, 17408
    s_cmp_ge_u32 s25, s34
    s_cselect_b32 s36, 87040, 0
    s_sub_u32 s25, s25, s36
    s_add_u32 m0, s24, 0
    s_add_u32 s37, s41, 128
    buffer_load_dwordx4 v224, s[4:7], s37 offen nt lds
    s_add_u32 m0, s24, 1024
    s_add_u32 s37, s41, 4224
    buffer_load_dwordx4 v225, s[4:7], s37 offen nt lds
    s_add_u32 m0, s24, 2048
    s_add_u32 s37, s41, 8320
    buffer_load_dwordx4 v224, s[4:7], s37 offen nt lds
    s_add_u32 m0, s24, 3072
    s_add_u32 s37, s41, 12416
    buffer_load_dwordx4 v225, s[4:7], s37 offen nt lds
    s_add_u32 s24, s24, 16896
    s_cmp_ge_u32 s24, s33
    s_cselect_b32 s36, 67584, 0
    s_sub_u32 s24, s24, s36
    s_add_u32 m0, s25, 0
    s_add_u32 s37, s41, 16640
    buffer_load_dwordx4 v224, s[4:7], s37 offen nt lds
    s_add_u32 m0, s25, 1024
    s_add_u32 s37, s41, 20736
    buffer_load_dwordx4 v225, s[4:7], s37 offen nt lds
    s_add_u32 m0, s25, 2048
    s_add_u32 s37, s41, 24832
    buffer_load_dwordx4 v224, s[4:7], s37 offen nt lds
    s_add_u32 m0, s25, 3072
    s_add_u32 s37, s41, 28928
    buffer_load_dwordx4 v225, s[4:7], s37 offen nt lds
    s_add_u32 s25, s25, 17408
    s_cmp_ge_u32 s25, s34
    s_cselect_b32 s36, 87040, 0
    s_sub_u32 s25, s25, s36
    s_add_u32 m0, s24, 0
    s_add_u32 s37, s41, 256
    buffer_load_dwordx4 v224, s[4:7], s37 offen nt lds
    s_add_u32 m0, s24, 1024
    s_add_u32 s37, s41, 4352
    buffer_load_dwordx4 v225, s[4:7], s37 offen nt lds
    s_add_u32 m0, s24, 2048
    s_add_u32 s37, s41, 8448
    buffer_load_dwordx4 v224, s[4:7], s37 offen nt lds
    s_add_u32 m0, s24, 3072
    s_add_u32 s37, s41, 12544
    buffer_load_dwordx4 v225, s[4:7], s37 offen nt lds
    s_add_u32 s24, s24, 16896
    s_cmp_ge_u32 s24, s33
    s_cselect_b32 s36, 67584, 0
    s_sub_u32 s24, s24, s36
    s_add_u32 m0, s25, 0
    s_add_u32 s37, s41, 16768
    buffer_load_dwordx4 v224, s[4:7], s37 offen nt lds
    s_add_u32 m0, s25, 1024
    s_add_u32 s37, s41, 20864
    buffer_load_dwordx4 v225, s[4:7], s37 offen nt lds
    s_add_u32 m0, s25, 2048
    s_add_u32 s37, s41, 24960
    buffer_load_dwordx4 v224, s[4:7], s37 offen nt lds
    s_add_u32 m0, s25, 3072
    s_add_u32 s37, s41, 29056
    buffer_load_dwordx4 v225, s[4:7], s37 offen nt lds
    s_add_u32 s25, s25, 17408
    s_cmp_ge_u32 s25, s34
    s_cselect_b32 s36, 87040, 0
    s_sub_u32 s25, s25, s36
    s_add_u32 m0, s24, 0
    s_add_u32 s37, s41, 384
    buffer_load_dwordx4 v224, s[4:7], s37 offen nt lds
    s_add_u32 m0, s24, 1024
    s_add_u32 s37, s41, 4480
    buffer_load_dwordx4 v225, s[4:7], s37 offen nt lds
    s_add_u32 m0, s24, 2048
    s_add_u32 s37, s41, 8576
    buffer_load_dwordx4 v224, s[4:7], s37 offen nt lds
    s_add_u32 m0, s24, 3072
    s_add_u32 s37, s41, 12672
    buffer_load_dwordx4 v225, s[4:7], s37 offen nt lds
    s_add_u32 s24, s24, 16896
    s_cmp_ge_u32 s24, s33
    s_cselect_b32 s36, 67584, 0
    s_sub_u32 s24, s24, s36
    s_add_u32 m0, s25, 0
    s_add_u32 s37, s41, 0
    buffer_load_dwordx4 v224, s[4:7], s37 offen nt lds
    s_add_u32 m0, s25, 1024
    s_add_u32 s37, s41, 4096
    buffer_load_dwordx4 v225, s[4:7], s37 offen nt lds
    s_add_u32 m0, s25, 2048
    s_add_u32 s37, s41, 8192
    buffer_load_dwordx4 v224, s[4:7], s37 offen nt lds
    s_add_u32 m0, s25, 3072
    s_add_u32 s37, s41, 12288
    buffer_load_dwordx4 v225, s[4:7], s37 offen nt lds
    s_add_u32 s25, s25, 17408
    s_cmp_ge_u32 s25, s34
    s_cselect_b32 s36, 87040, 0
    s_sub_u32 s25, s25, s36
    s_add_u32 s24, s24, 16896
    s_cmp_ge_u32 s24, s33
    s_cselect_b32 s36, 67584, 0
    s_sub_u32 s24, s24, s36
    s_waitcnt vmcnt(28)
    s_add_u32 s38, s53, 67584
    v_xor_b32 v248, 0, v250
    v_add_u32 v248, s38, v248
    ds_read_b128 a[192:195], v248
    v_xor_b32 v249, 32, v250
    v_add_u32 v249, s38, v249
    ds_read_b128 a[196:199], v249
    v_xor_b32 v251, 64, v250
    v_add_u32 v251, s38, v251
    ds_read_b128 a[200:203], v251
    v_xor_b32 v252, 96, v250
    v_add_u32 v252, s38, v252
    ds_read_b128 a[204:207], v252
    s_waitcnt vmcnt(20)
    s_add_u32 s38, s53, 84992
    v_xor_b32 v248, 0, v250
    v_add_u32 v248, s38, v248
    ds_read_b128 a[208:211], v248
    v_xor_b32 v249, 32, v250
    v_add_u32 v249, s38, v249
    ds_read_b128 a[212:215], v249
    v_xor_b32 v251, 64, v250
    v_add_u32 v251, s38, v251
    ds_read_b128 a[216:219], v251
    v_xor_b32 v252, 96, v250
    v_add_u32 v252, s38, v252
    ds_read_b128 a[220:223], v252
    s_add_u32 s38, s52, 16896
    v_xor_b32 v248, 0, v250
    v_add_u32 v248, s38, v248
    ds_read_b128 a[144:147], v248
    v_xor_b32 v249, 32, v250
    v_add_u32 v249, s38, v249
    ds_read_b128 a[148:151], v249
    v_xor_b32 v251, 64, v250
    v_add_u32 v251, s38, v251
    ds_read_b128 a[152:155], v251
    v_xor_b32 v252, 96, v250
    v_add_u32 v252, s38, v252
    ds_read_b128 a[156:159], v252
    s_waitcnt lgkmcnt(0)
    s_add_u32 m0, s25, 0
    s_nop 0
    buffer_load_dwordx4 v223, s[12:15], s23 offen offset:0 nt lds
    s_add_u32 m0, s25, 64
    s_nop 0
    buffer_load_dwordx4 v223, s[12:15], s23 offen offset:1024 nt lds
    s_add_u32 m0, s25, 128
    s_nop 0
    buffer_load_dwordx4 v223, s[12:15], s23 offen offset:2048 nt lds
    s_add_u32 m0, s25, 192
    s_nop 0
    buffer_load_dwordx4 v223, s[12:15], s23 offen offset:3072 nt lds
    s_add_u32 s23, s23, 16384
    s_add_u32 s25, s25, 17408
    s_cmp_ge_u32 s25, s34
    s_cselect_b32 s36, 87040, 0
    s_sub_u32 s25, s25, s36
    s_add_u32 m0, s24, 0
    s_nop 0
    buffer_load_dwordx4 v222, s[8:11], s22 offen offset:0 nt lds
    s_add_u32 m0, s24, 32
    s_nop 0
    buffer_load_dwordx4 v222, s[8:11], s22 offen offset:1024 nt lds
    s_add_u32 m0, s24, 64
    s_nop 0
    buffer_load_dwordx4 v222, s[8:11], s22 offen offset:2048 nt lds
    s_add_u32 m0, s24, 96
    s_nop 0
    buffer_load_dwordx4 v222, s[8:11], s22 offen offset:3072 nt lds
    s_add_u32 s22, s22, 16384
    s_add_u32 s24, s24, 16896
    s_cmp_ge_u32 s24, s33
    s_cselect_b32 s36, 67584, 0
    s_sub_u32 s24, s24, s36
    s_waitcnt vmcnt(20)
    s_add_u32 s38, s53, 102400
    v_xor_b32 v248, 0, v250
    v_add_u32 v248, s38, v248
    ds_read_b128 a[224:227], v248
    v_xor_b32 v249, 32, v250
    v_add_u32 v249, s38, v249
    ds_read_b128 a[228:231], v249
    v_xor_b32 v251, 64, v250
    v_add_u32 v251, s38, v251
    ds_read_b128 a[232:235], v251
    v_xor_b32 v252, 96, v250
    v_add_u32 v252, s38, v252
    ds_read_b128 a[236:239], v252
    s_add_u32 s38, s52, 33792
    v_xor_b32 v248, 0, v250
    v_add_u32 v248, s38, v248
    ds_read_b128 a[160:163], v248
    v_xor_b32 v249, 32, v250
    v_add_u32 v249, s38, v249
    ds_read_b128 a[164:167], v249
    v_xor_b32 v251, 64, v250
    v_add_u32 v251, s38, v251
    ds_read_b128 a[168:171], v251
    v_xor_b32 v252, 96, v250
    v_add_u32 v252, s38, v252
    ds_read_b128 a[172:175], v252
    s_waitcnt vmcnt(12)
    s_add_u32 s38, s53, 119808
    v_xor_b32 v248, 0, v250
    v_add_u32 v248, s38, v248
    ds_read_b128 a[240:243], v248
    v_xor_b32 v249, 32, v250
    v_add_u32 v249, s38, v249
    ds_read_b128 a[244:247], v249
    v_xor_b32 v251, 64, v250
    v_add_u32 v251, s38, v251
    ds_read_b128 a[248:251], v251
    v_xor_b32 v252, 96, v250
    v_add_u32 v252, s38, v252
    ds_read_b128 a[252:255], v252
    s_add_u32 s38, s52, 50688
    v_xor_b32 v248, 0, v250
    v_add_u32 v248, s38, v248
    ds_read_b128 a[176:179], v248
    v_xor_b32 v249, 32, v250
    v_add_u32 v249, s38, v249
    ds_read_b128 a[180:183], v249
    v_xor_b32 v251, 64, v250
    v_add_u32 v251, s38, v251
    ds_read_b128 a[184:187], v251
    v_xor_b32 v252, 96, v250
    v_add_u32 v252, s38, v252
    ds_read_b128 a[188:191], v252
    s_waitcnt vmcnt(8)
    s_add_u32 s38, s53, 137216
    v_xor_b32 v248, 0, v250
    v_add_u32 v248, s38, v248
    ds_read_b128 a[128:131], v248
    v_xor_b32 v249, 32, v250
    v_add_u32 v249, s38, v249
    ds_read_b128 a[132:135], v249
    v_xor_b32 v251, 64, v250
    v_add_u32 v251, s38, v251
    ds_read_b128 a[136:139], v251
    v_xor_b32 v252, 96, v250
    v_add_u32 v252, s38, v252
    ds_read_b128 a[140:143], v252
    s_add_u32 s41, s31, 262144
    v_add_u32 v219, s26, v216
    s_add_u32 s26, s26, 16896
    s_cmp_ge_u32 s26, 67584
    s_cselect_b32 s26, 0, s26
    s_mov_b32 s30, 0
    s_waitcnt lgkmcnt(0)
    s_barrier
    ds_read_b128 v[200:203], v219 offset:0
    ds_read_b128 v[204:207], v219 offset:32
    ds_read_b128 v[208:211], v219 offset:64
    s_waitcnt lgkmcnt(2)
    v_mfma_f32_32x32x16_bf16 v[176:191], v[200:203], a[128:131], 0
    ds_read_b128 v[212:215], v219 offset:96
    s_add_u32 m0, s25, 0
    s_nop 0
    v_mfma_f32_32x32x16_bf16 v[144:159], v[200:203], a[192:195], 0
    buffer_load_dwordx4 v223, s[12:15], s23 offen offset:0 nt lds
    s_add_u32 m0, s25, 64
    s_waitcnt lgkmcnt(2)
    v_mfma_f32_32x32x16_bf16 v[176:191], v[204:207], a[132:135], v[176:191]
    ds_read_b128 v[200:203], v219 offset:128
    s_nop 0
    buffer_load_dwordx4 v223, s[12:15], s23 offen offset:1024 nt lds
    v_mfma_f32_32x32x16_bf16 v[144:159], v[204:207], a[196:199], v[144:159]
    s_add_u32 m0, s25, 128
    s_nop 0
    s_waitcnt lgkmcnt(2)
    v_mfma_f32_32x32x16_bf16 v[176:191], v[208:211], a[136:139], v[176:191]
    ds_read_b128 v[204:207], v219 offset:160
    buffer_load_dwordx4 v223, s[12:15], s23 offen offset:2048 nt lds
    s_add_u32 m0, s25, 192
    v_mfma_f32_32x32x16_bf16 v[144:159], v[208:211], a[200:203], v[144:159]
    s_nop 0
    s_waitcnt lgkmcnt(2)
    v_mfma_f32_32x32x16_bf16 v[176:191], v[212:215], a[140:143], v[176:191]
    ds_read_b128 v[208:211], v219 offset:192
    buffer_load_dwordx4 v223, s[12:15], s23 offen offset:3072 nt lds
    s_add_u32 s23, s23, 16384
    v_mfma_f32_32x32x16_bf16 v[144:159], v[212:215], a[204:207], v[144:159]
    s_add_u32 s25, s25, 17408
    s_cmp_ge_u32 s25, s34
    s_cselect_b32 s36, 87040, 0
    s_sub_u32 s25, s25, s36
    s_waitcnt lgkmcnt(2)
    v_mfma_f32_32x32x16_bf16 v[176:191], v[200:203], a[144:147], v[176:191]
    ds_read_b128 v[212:215], v219 offset:224
    s_add_u32 m0, s24, 0
    s_nop 0
    v_mfma_f32_32x32x16_bf16 v[144:159], v[200:203], a[208:211], v[144:159]
    buffer_load_dwordx4 v222, s[8:11], s22 offen offset:0 nt lds
    s_add_u32 m0, s24, 32
    s_waitcnt lgkmcnt(2)
    v_mfma_f32_32x32x16_bf16 v[176:191], v[204:207], a[148:151], v[176:191]
    ds_read_b128 v[200:203], v219 offset:256
    s_nop 0
    buffer_load_dwordx4 v222, s[8:11], s22 offen offset:1024 nt lds
    v_mfma_f32_32x32x16_bf16 v[144:159], v[204:207], a[212:215], v[144:159]
    s_add_u32 m0, s24, 64
    s_nop 0
    s_waitcnt lgkmcnt(2)
    v_mfma_f32_32x32x16_bf16 v[176:191], v[208:211], a[152:155], v[176:191]
    ds_read_b128 v[204:207], v219 offset:288
    buffer_load_dwordx4 v222, s[8:11], s22 offen offset:2048 nt lds
    s_add_u32 m0, s24, 96
    v_mfma_f32_32x32x16_bf16 v[144:159], v[208:211], a[216:219], v[144:159]
    s_nop 0
    s_waitcnt lgkmcnt(2)
    v_mfma_f32_32x32x16_bf16 v[176:191], v[212:215], a[156:159], v[176:191]
    ds_read_b128 v[208:211], v219 offset:320
    buffer_load_dwordx4 v222, s[8:11], s22 offen offset:3072 nt lds
    s_add_u32 s22, s22, 16384
    v_mfma_f32_32x32x16_bf16 v[144:159], v[212:215], a[220:223], v[144:159]
    s_add_u32 s24, s24, 16896
    s_cmp_ge_u32 s24, s33
    s_cselect_b32 s36, 67584, 0
    s_sub_u32 s24, s24, s36
    s_waitcnt lgkmcnt(2)
    v_mfma_f32_32x32x16_bf16 v[176:191], v[200:203], a[160:163], v[176:191]
    ds_read_b128 v[212:215], v219 offset:352
    s_add_u32 m0, s25, 0
    s_nop 0
    v_mfma_f32_32x32x16_bf16 v[144:159], v[200:203], a[224:227], v[144:159]
    buffer_load_dwordx4 v223, s[12:15], s23 offen offset:0 nt lds
    s_add_u32 m0, s25, 64
    s_waitcnt lgkmcnt(2)
    v_mfma_f32_32x32x16_bf16 v[176:191], v[204:207], a[164:167], v[176:191]
    ds_read_b128 v[200:203], v219 offset:384
    s_nop 0
    buffer_load_dwordx4 v223, s[12:15], s23 offen offset:1024 nt lds
    v_mfma_f32_32x32x16_bf16 v[144:159], v[204:207], a[228:231], v[144:159]
    s_add_u32 m0, s25, 128
    s_nop 0
    s_waitcnt lgkmcnt(2)
    v_mfma_f32_32x32x16_bf16 v[176:191], v[208:211], a[168:171], v[176:191]
    ds_read_b128 v[204:207], v219 offset:416
    buffer_load_dwordx4 v223, s[12:15], s23 offen offset:2048 nt lds
    s_add_u32 m0, s25, 192
    v_mfma_f32_32x32x16_bf16 v[144:159], v[208:211], a[232:235], v[144:159]
    s_nop 0
    s_waitcnt lgkmcnt(2)
    v_mfma_f32_32x32x16_bf16 v[176:191], v[212:215], a[172:175], v[176:191]
    ds_read_b128 v[208:211], v219 offset:448
    buffer_load_dwordx4 v223, s[12:15], s23 offen offset:3072 nt lds
    s_add_u32 s23, s23, 16384
    v_mfma_f32_32x32x16_bf16 v[144:159], v[212:215], a[236:239], v[144:159]
    s_add_u32 s25, s25, 17408
    s_cmp_ge_u32 s25, s34
    s_cselect_b32 s36, 87040, 0
    s_sub_u32 s25, s25, s36
    s_waitcnt lgkmcnt(2)
    v_mfma_f32_32x32x16_bf16 v[176:191], v[200:203], a[176:179], v[176:191]
    ds_read_b128 v[212:215], v219 offset:480
    s_add_u32 m0, s24, 0
    s_nop 0
    v_mfma_f32_32x32x16_bf16 v[144:159], v[200:203], a[240:243], v[144:159]
    buffer_load_dwordx4 v222, s[8:11], s22 offen offset:0 nt lds
    s_add_u32 m0, s24, 32
    s_waitcnt lgkmcnt(2)
    v_mfma_f32_32x32x16_bf16 v[176:191], v[204:207], a[180:183], v[176:191]
    s_nop 0
    buffer_load_dwordx4 v222, s[8:11], s22 offen offset:1024 nt lds
    v_mfma_f32_32x32x16_bf16 v[144:159], v[204:207], a[244:247], v[144:159]
    s_add_u32 m0, s24, 64
    s_nop 0
    s_waitcnt lgkmcnt(1)
    v_mfma_f32_32x32x16_bf16 v[176:191], v[208:211], a[184:187], v[176:191]
    buffer_load_dwordx4 v222, s[8:11], s22 offen offset:2048 nt lds
    s_add_u32 m0, s24, 96
    v_mfma_f32_32x32x16_bf16 v[144:159], v[208:211], a[248:251], v[144:159]
    s_nop 0
    s_waitcnt lgkmcnt(0)
    v_mfma_f32_32x32x16_bf16 v[176:191], v[212:215], a[188:191], v[176:191]
    buffer_load_dwordx4 v222, s[8:11], s22 offen offset:3072 nt lds
    s_add_u32 s22, s22, 16384
    v_mfma_f32_32x32x16_bf16 v[144:159], v[212:215], a[252:255], v[144:159]
    s_add_u32 s24, s24, 16896
    s_cmp_ge_u32 s24, s33
    s_cselect_b32 s36, 67584, 0
    s_sub_u32 s24, s24, s36
    s_branch AFTER_QK0
BLOCK_TOP:
    ds_read_b128 v[200:203], v219 offset:0
    ds_read_b128 v[204:207], v219 offset:32
    ds_read_b128 v[208:211], v219 offset:64
    s_waitcnt lgkmcnt(2)
    v_mfma_f32_32x32x16_bf16 v[176:191], v[200:203], a[128:131], 0
    ds_read_b128 v[212:215], v219 offset:96
    v_mfma_f32_32x32x16_bf16 v[144:159], v[200:203], a[192:195], 0
    s_waitcnt lgkmcnt(2)
    v_mfma_f32_32x32x16_bf16 v[176:191], v[204:207], a[132:135], v[176:191]
    ds_read_b128 v[200:203], v219 offset:128
    v_mfma_f32_32x32x16_bf16 v[144:159], v[204:207], a[196:199], v[144:159]
    s_waitcnt lgkmcnt(2)
    v_mfma_f32_32x32x16_bf16 v[176:191], v[208:211], a[136:139], v[176:191]
    ds_read_b128 v[204:207], v219 offset:160
    v_mfma_f32_32x32x16_bf16 v[144:159], v[208:211], a[200:203], v[144:159]
    s_waitcnt lgkmcnt(2)
    v_mfma_f32_32x32x16_bf16 v[176:191], v[212:215], a[140:143], v[176:191]
    ds_read_b128 v[208:211], v219 offset:192
    v_mfma_f32_32x32x16_bf16 v[144:159], v[212:215], a[204:207], v[144:159]
    s_waitcnt lgkmcnt(2)
    v_mfma_f32_32x32x16_bf16 v[176:191], v[200:203], a[144:147], v[176:191]
    ds_read_b128 v[212:215], v219 offset:224
    v_mfma_f32_32x32x16_bf16 v[144:159], v[200:203], a[208:211], v[144:159]
    s_waitcnt lgkmcnt(2)
    v_mfma_f32_32x32x16_bf16 v[176:191], v[204:207], a[148:151], v[176:191]
    ds_read_b128 v[200:203], v219 offset:256
    v_mfma_f32_32x32x16_bf16 v[144:159], v[204:207], a[212:215], v[144:159]
    s_waitcnt lgkmcnt(2)
    v_mfma_f32_32x32x16_bf16 v[176:191], v[208:211], a[152:155], v[176:191]
    ds_read_b128 v[204:207], v219 offset:288
    v_mfma_f32_32x32x16_bf16 v[144:159], v[208:211], a[216:219], v[144:159]
    s_waitcnt lgkmcnt(2)
    v_mfma_f32_32x32x16_bf16 v[176:191], v[212:215], a[156:159], v[176:191]
    ds_read_b128 v[208:211], v219 offset:320
    v_mfma_f32_32x32x16_bf16 v[144:159], v[212:215], a[220:223], v[144:159]
    s_waitcnt lgkmcnt(2)
    v_mfma_f32_32x32x16_bf16 v[176:191], v[200:203], a[160:163], v[176:191]
    ds_read_b128 v[212:215], v219 offset:352
    v_mfma_f32_32x32x16_bf16 v[144:159], v[200:203], a[224:227], v[144:159]
    s_waitcnt lgkmcnt(2)
    v_mfma_f32_32x32x16_bf16 v[176:191], v[204:207], a[164:167], v[176:191]
    ds_read_b128 v[200:203], v219 offset:384
    v_mfma_f32_32x32x16_bf16 v[144:159], v[204:207], a[228:231], v[144:159]
    s_waitcnt lgkmcnt(2)
    v_mfma_f32_32x32x16_bf16 v[176:191], v[208:211], a[168:171], v[176:191]
    ds_read_b128 v[204:207], v219 offset:416
    v_mfma_f32_32x32x16_bf16 v[144:159], v[208:211], a[232:235], v[144:159]
    s_waitcnt lgkmcnt(2)
    v_mfma_f32_32x32x16_bf16 v[176:191], v[212:215], a[172:175], v[176:191]
    ds_read_b128 v[208:211], v219 offset:448
    v_mfma_f32_32x32x16_bf16 v[144:159], v[212:215], a[236:239], v[144:159]
    s_waitcnt lgkmcnt(2)
    v_mfma_f32_32x32x16_bf16 v[176:191], v[200:203], a[176:179], v[176:191]
    ds_read_b128 v[212:215], v219 offset:480
    v_mfma_f32_32x32x16_bf16 v[144:159], v[200:203], a[240:243], v[144:159]
    s_waitcnt lgkmcnt(2)
    v_mfma_f32_32x32x16_bf16 v[176:191], v[204:207], a[180:183], v[176:191]
    v_mfma_f32_32x32x16_bf16 v[144:159], v[204:207], a[244:247], v[144:159]
    s_waitcnt lgkmcnt(1)
    v_mfma_f32_32x32x16_bf16 v[176:191], v[208:211], a[184:187], v[176:191]
    v_mfma_f32_32x32x16_bf16 v[144:159], v[208:211], a[248:251], v[144:159]
    s_waitcnt lgkmcnt(0)
    v_mfma_f32_32x32x16_bf16 v[176:191], v[212:215], a[188:191], v[176:191]
    v_mfma_f32_32x32x16_bf16 v[144:159], v[212:215], a[252:255], v[144:159]
AFTER_QK0:
    v_add_u32 v219, s26, v216
    s_add_u32 s26, s26, 16896
    s_cmp_ge_u32 s26, 67584
    s_cselect_b32 s26, 0, s26
    s_cmp_eq_u32 s29, 0
    s_cbranch_scc1 BW0_1
    s_waitcnt vmcnt(48)
    s_branch BW1_1
BW0_1:
    s_waitcnt vmcnt(16)
BW1_1:
    s_barrier
    ds_read_b128 v[200:203], v219 offset:0
    ds_read_b128 v[204:207], v219 offset:32
    ds_read_b128 v[208:211], v219 offset:64
    s_waitcnt lgkmcnt(2)
    v_mfma_f32_32x32x16_bf16 v[128:143], v[200:203], a[128:131], 0
    ds_read_b128 v[212:215], v219 offset:96
    s_add_u32 m0, s25, 0
    v_max3_f32 v242, v176, v177, v178
    buffer_load_dwordx4 v223, s[12:15], s23 offen offset:0 nt lds
    v_max3_f32 v243, v179, v180, v181
    v_max3_f32 v242, v242, v182, v183
    v_max3_f32 v243, v243, v184, v185
    v_mfma_f32_32x32x16_bf16 v[160:175], v[200:203], a[192:195], 0
    v_max3_f32 v242, v242, v186, v187
    v_max3_f32 v243, v243, v188, v189
    v_max3_f32 v242, v242, v190, v191
    v_max_f32 v242, v242, v243
    v_mov_b32 v243, v242
    s_nop 1
    v_permlane32_swap_b32 v242, v243
    s_nop 1
    s_waitcnt lgkmcnt(2)
    v_mfma_f32_32x32x16_bf16 v[128:143], v[204:207], a[132:135], v[128:143]
    ds_read_b128 v[200:203], v219 offset:128
    v_max_f32 v242, v242, v243
    v_mul_f32_e64 v226, -v242, s20
    v_fma_f32 v234, v176, s20, v226
    v_fma_f32 v235, v177, s20, v226
    v_exp_f32 v234, v234
    s_add_u32 m0, s25, 64
    v_mfma_f32_32x32x16_bf16 v[160:175], v[204:207], a[196:199], v[160:175]
    v_fma_f32 v236, v178, s20, v226
    buffer_load_dwordx4 v223, s[12:15], s23 offen offset:1024 nt lds
    v_exp_f32 v235, v235
    v_fma_f32 v237, v179, s20, v226
    s_waitcnt lgkmcnt(2)
    v_mfma_f32_32x32x16_bf16 v[128:143], v[208:211], a[136:139], v[128:143]
    ds_read_b128 v[204:207], v219 offset:160
    v_exp_f32 v236, v236
    v_mov_b32 v232, v234
    v_fma_f32 v238, v180, s20, v226
    v_exp_f32 v237, v237
    v_mov_b32 v233, v235
    v_mfma_f32_32x32x16_bf16 v[160:175], v[208:211], a[200:203], v[160:175]
    v_cvt_pk_bf16_f32 v176, v234, v235
    v_fma_f32 v239, v181, s20, v226
    v_exp_f32 v238, v238
    v_add_f32 v232, v232, v236
    v_fma_f32 v240, v182, s20, v226
    v_exp_f32 v239, v239
    s_waitcnt lgkmcnt(2)
    v_mfma_f32_32x32x16_bf16 v[128:143], v[212:215], a[140:143], v[128:143]
    ds_read_b128 v[208:211], v219 offset:192
    v_add_f32 v233, v233, v237
    s_add_u32 m0, s25, 128
    v_cvt_pk_bf16_f32 v177, v236, v237
    buffer_load_dwordx4 v223, s[12:15], s23 offen offset:2048 nt lds
    v_fma_f32 v241, v183, s20, v226
    v_mfma_f32_32x32x16_bf16 v[160:175], v[212:215], a[204:207], v[160:175]
    v_exp_f32 v240, v240
    v_add_f32 v232, v232, v238
    v_fma_f32 v234, v184, s20, v226
    v_exp_f32 v241, v241
    v_add_f32 v233, v233, v239
    s_waitcnt lgkmcnt(2)
    v_mfma_f32_32x32x16_bf16 v[128:143], v[200:203], a[144:147], v[128:143]
    ds_read_b128 v[212:215], v219 offset:224
    v_cvt_pk_bf16_f32 v178, v238, v239
    v_fma_f32 v235, v185, s20, v226
    v_exp_f32 v234, v234
    v_add_f32 v232, v232, v240
    v_fma_f32 v236, v186, s20, v226
    v_mfma_f32_32x32x16_bf16 v[160:175], v[200:203], a[208:211], v[160:175]
    v_exp_f32 v235, v235
    v_add_f32 v233, v233, v241
    v_cvt_pk_bf16_f32 v179, v240, v241
    s_add_u32 m0, s25, 192
    v_fma_f32 v237, v187, s20, v226
    buffer_load_dwordx4 v223, s[12:15], s23 offen offset:3072 nt lds
    s_waitcnt lgkmcnt(2)
    v_mfma_f32_32x32x16_bf16 v[128:143], v[204:207], a[148:151], v[128:143]
    ds_read_b128 v[200:203], v219 offset:256
    v_exp_f32 v236, v236
    v_add_f32 v232, v232, v234
    v_fma_f32 v238, v188, s20, v226
    v_exp_f32 v237, v237
    v_add_f32 v233, v233, v235
    v_mfma_f32_32x32x16_bf16 v[160:175], v[204:207], a[212:215], v[160:175]
    v_cvt_pk_bf16_f32 v180, v234, v235
    v_fma_f32 v239, v189, s20, v226
    v_exp_f32 v238, v238
    v_add_f32 v232, v232, v236
    v_fma_f32 v240, v190, s20, v226
    s_waitcnt lgkmcnt(2)
    v_mfma_f32_32x32x16_bf16 v[128:143], v[208:211], a[152:155], v[128:143]
    ds_read_b128 v[204:207], v219 offset:288
    v_exp_f32 v239, v239
    v_add_f32 v233, v233, v237
    v_cvt_pk_bf16_f32 v181, v236, v237
    v_fma_f32 v241, v191, s20, v226
    s_add_u32 s23, s23, 16384
    s_add_u32 s25, s25, 17408
    s_cmp_ge_u32 s25, s34
    s_cselect_b32 s36, 87040, 0
    s_sub_u32 s25, s25, s36
    v_mfma_f32_32x32x16_bf16 v[160:175], v[208:211], a[216:219], v[160:175]
    s_add_u32 m0, s24, 0
    v_exp_f32 v240, v240
    buffer_load_dwordx4 v222, s[8:11], s22 offen offset:0 nt lds
    v_add_f32 v232, v232, v238
    s_waitcnt lgkmcnt(2)
    v_mfma_f32_32x32x16_bf16 v[128:143], v[212:215], a[156:159], v[128:143]
    ds_read_b128 v[208:211], v219 offset:320
    v_exp_f32 v241, v241
    v_add_f32 v233, v233, v239
    v_cvt_pk_bf16_f32 v182, v238, v239
    v_add_f32 v232, v232, v240
    v_add_f32 v233, v233, v241
    v_cvt_pk_bf16_f32 v183, v240, v241
    v_mfma_f32_32x32x16_bf16 v[160:175], v[212:215], a[220:223], v[160:175]
    v_add_f32 v232, v232, v233
    v_mov_b32 v228, v232
    v_max3_f32 v242, v144, v145, v146
    v_max3_f32 v243, v147, v148, v149
    v_max3_f32 v242, v242, v150, v151
    v_max3_f32 v243, v243, v152, v153
    s_waitcnt lgkmcnt(2)
    v_mfma_f32_32x32x16_bf16 v[128:143], v[200:203], a[160:163], v[128:143]
    ds_read_b128 v[212:215], v219 offset:352
    v_max3_f32 v242, v242, v154, v155
    s_add_u32 m0, s24, 32
    v_max3_f32 v243, v243, v156, v157
    buffer_load_dwordx4 v222, s[8:11], s22 offen offset:1024 nt lds
    v_max3_f32 v242, v242, v158, v159
    v_max_f32 v242, v242, v243
    v_mov_b32 v243, v242
    v_mfma_f32_32x32x16_bf16 v[160:175], v[200:203], a[224:227], v[160:175]
    s_nop 1
    v_permlane32_swap_b32 v242, v243
    s_nop 1
    v_max_f32 v242, v242, v243
    v_mul_f32_e64 v227, -v242, s20
    v_fma_f32 v234, v144, s20, v227
    v_fma_f32 v235, v145, s20, v227
    s_waitcnt lgkmcnt(2)
    v_mfma_f32_32x32x16_bf16 v[128:143], v[204:207], a[164:167], v[128:143]
    ds_read_b128 v[200:203], v219 offset:384
    v_exp_f32 v234, v234
    v_fma_f32 v236, v146, s20, v227
    v_exp_f32 v235, v235
    v_fma_f32 v237, v147, s20, v227
    v_mfma_f32_32x32x16_bf16 v[160:175], v[204:207], a[228:231], v[160:175]
    v_exp_f32 v236, v236
    v_mov_b32 v232, v234
    s_add_u32 m0, s24, 64
    v_fma_f32 v238, v148, s20, v227
    buffer_load_dwordx4 v222, s[8:11], s22 offen offset:2048 nt lds
    v_exp_f32 v237, v237
    s_waitcnt lgkmcnt(2)
    v_mfma_f32_32x32x16_bf16 v[128:143], v[208:211], a[168:171], v[128:143]
    ds_read_b128 v[204:207], v219 offset:416
    v_mov_b32 v233, v235
    v_cvt_pk_bf16_f32 v192, v234, v235
    v_fma_f32 v239, v149, s20, v227
    v_exp_f32 v238, v238
    v_add_f32 v232, v232, v236
    v_add_u32 v220, s27, v217
    v_mfma_f32_32x32x16_bf16 v[160:175], v[208:211], a[232:235], v[160:175]
    v_fma_f32 v240, v150, s20, v227
    v_exp_f32 v239, v239
    v_add_f32 v233, v233, v237
    v_cvt_pk_bf16_f32 v193, v236, v237
    v_fma_f32 v241, v151, s20, v227
    v_add_u32 v221, s27, v218
    s_waitcnt lgkmcnt(2)
    v_mfma_f32_32x32x16_bf16 v[128:143], v[212:215], a[172:175], v[128:143]
    ds_read_b128 v[208:211], v219 offset:448
    v_exp_f32 v240, v240
    v_add_f32 v232, v232, v238
    v_fma_f32 v234, v152, s20, v227
    s_add_u32 m0, s24, 96
    v_exp_f32 v241, v241
    v_mfma_f32_32x32x16_bf16 v[160:175], v[212:215], a[236:239], v[160:175]
    buffer_load_dwordx4 v222, s[8:11], s22 offen offset:3072 nt lds
    v_add_f32 v233, v233, v239
    v_cvt_pk_bf16_f32 v194, v238, v239
    v_fma_f32 v235, v153, s20, v227
    v_exp_f32 v234, v234
    v_add_f32 v232, v232, v240
    s_add_u32 s27, s27, 17408
    s_cmp_ge_u32 s27, 154624
    s_cselect_b32 s27, 67584, s27
    s_waitcnt lgkmcnt(2)
    v_mfma_f32_32x32x16_bf16 v[128:143], v[200:203], a[176:179], v[128:143]
    ds_read_b128 v[212:215], v219 offset:480
    v_fma_f32 v236, v154, s20, v227
    v_exp_f32 v235, v235
    v_add_f32 v233, v233, v241
    v_cvt_pk_bf16_f32 v195, v240, v241
    v_fma_f32 v237, v155, s20, v227
    v_mfma_f32_32x32x16_bf16 v[160:175], v[200:203], a[240:243], v[160:175]
    v_exp_f32 v236, v236
    v_add_f32 v232, v232, v234
    v_fma_f32 v238, v156, s20, v227
    v_exp_f32 v237, v237
    s_add_u32 s22, s22, 16384
    s_waitcnt lgkmcnt(2)
    v_mfma_f32_32x32x16_bf16 v[128:143], v[204:207], a[180:183], v[128:143]
    ds_read_b64_tr_b16 v[200:201], v220 offset:0
    ds_read_b64_tr_b16 v[202:203], v220 offset:4352
    s_add_u32 s24, s24, 16896
    s_cmp_ge_u32 s24, s33
    s_cselect_b32 s36, 67584, 0
    s_sub_u32 s24, s24, s36
    v_add_f32 v233, v233, v235
    v_cvt_pk_bf16_f32 v196, v234, v235
    v_fma_f32 v239, v157, s20, v227
    v_exp_f32 v238, v238
    v_mfma_f32_32x32x16_bf16 v[160:175], v[204:207], a[244:247], v[160:175]
    v_add_f32 v232, v232, v236
    v_fma_f32 v240, v158, s20, v227
    v_exp_f32 v239, v239
    v_add_f32 v233, v233, v237
    v_cvt_pk_bf16_f32 v197, v236, v237
    s_waitcnt lgkmcnt(3)
    v_mfma_f32_32x32x16_bf16 v[128:143], v[208:211], a[184:187], v[128:143]
    ds_read_b64_tr_b16 v[204:205], v220 offset:8704
    ds_read_b64_tr_b16 v[206:207], v220 offset:13056
    v_fma_f32 v241, v159, s20, v227
    v_exp_f32 v240, v240
    v_add_f32 v232, v232, v238
    v_exp_f32 v241, v241
    v_mfma_f32_32x32x16_bf16 v[160:175], v[208:211], a[248:251], v[160:175]
    v_add_f32 v233, v233, v239
    v_cvt_pk_bf16_f32 v198, v238, v239
    v_add_f32 v232, v232, v240
    v_add_f32 v233, v233, v241
    v_cvt_pk_bf16_f32 v199, v240, v241
    v_add_f32 v232, v232, v233
    v_mov_b32 v229, v232
    s_waitcnt lgkmcnt(4)
    v_mfma_f32_32x32x16_bf16 v[128:143], v[212:215], a[188:191], v[128:143]
    ds_read_b64_tr_b16 v[208:209], v220 offset:64
    ds_read_b64_tr_b16 v[210:211], v220 offset:4416
    v_mfma_f32_32x32x16_bf16 v[160:175], v[212:215], a[252:255], v[160:175]
    v_mov_b32 v230, 1.0
    v_mov_b32 v231, 1.0
    s_mov_b32 s30, 0
    s_waitcnt lgkmcnt(4)
    v_mfma_f32_32x32x16_bf16 v[0:15], v[200:203], v[176:179], 0
    ds_read_b64_tr_b16 v[212:213], v220 offset:8768
    ds_read_b64_tr_b16 v[214:215], v220 offset:13120
    v_mfma_f32_32x32x16_bf16 a[0:15], v[200:203], v[192:195], 0
    s_cmp_eq_u32 s29, 0
    s_cbranch_scc1 BW0_2
    s_waitcnt vmcnt(48)
    s_branch BW1_2
BW0_2:
    s_waitcnt vmcnt(16)
BW1_2:
    s_barrier
    s_waitcnt lgkmcnt(4)
    v_mfma_f32_32x32x16_bf16 v[0:15], v[204:207], v[180:183], v[0:15]
    ds_read_b64_tr_b16 v[200:201], v221 offset:128
    ds_read_b64_tr_b16 v[202:203], v221 offset:4480
    v_mfma_f32_32x32x16_bf16 a[0:15], v[204:207], v[196:199], a[0:15]
    s_waitcnt lgkmcnt(4)
    v_mfma_f32_32x32x16_bf16 v[16:31], v[208:211], v[176:179], 0
    ds_read_b64_tr_b16 v[204:205], v221 offset:8832
    ds_read_b64_tr_b16 v[206:207], v221 offset:13184
    v_mfma_f32_32x32x16_bf16 a[16:31], v[208:211], v[192:195], 0
    v_fma_f32 v234, v128, s20, v226
    v_fma_f32 v235, v129, s20, v226
    s_waitcnt lgkmcnt(4)
    v_mfma_f32_32x32x16_bf16 v[16:31], v[212:215], v[180:183], v[16:31]
    ds_read_b64_tr_b16 v[208:209], v221 offset:192
    ds_read_b64_tr_b16 v[210:211], v221 offset:4544
    v_exp_f32 v234, v234
    v_fma_f32 v236, v130, s20, v226
    v_mfma_f32_32x32x16_bf16 a[16:31], v[212:215], v[196:199], a[16:31]
    v_exp_f32 v235, v235
    v_fma_f32 v237, v131, s20, v226
    s_waitcnt lgkmcnt(4)
    v_mfma_f32_32x32x16_bf16 v[32:47], v[200:203], v[176:179], 0
    ds_read_b64_tr_b16 v[212:213], v221 offset:8896
    ds_read_b64_tr_b16 v[214:215], v221 offset:13248
    v_exp_f32 v236, v236
    v_mov_b32 v232, v234
    v_fma_f32 v238, v132, s20, v226
    v_mfma_f32_32x32x16_bf16 a[32:47], v[200:203], v[192:195], 0
    v_exp_f32 v237, v237
    v_mov_b32 v233, v235
    s_waitcnt lgkmcnt(4)
    v_mfma_f32_32x32x16_bf16 v[32:47], v[204:207], v[180:183], v[32:47]
    ds_read_b64_tr_b16 v[200:201], v220 offset:256
    ds_read_b64_tr_b16 v[202:203], v220 offset:4608
    v_cvt_pk_bf16_f32 v184, v234, v235
    v_fma_f32 v239, v133, s20, v226
    v_mfma_f32_32x32x16_bf16 a[32:47], v[204:207], v[196:199], a[32:47]
    v_exp_f32 v238, v238
    v_add_f32 v232, v232, v236
    s_waitcnt lgkmcnt(4)
    v_mfma_f32_32x32x16_bf16 v[48:63], v[208:211], v[176:179], 0
    ds_read_b64_tr_b16 v[204:205], v220 offset:8960
    ds_read_b64_tr_b16 v[206:207], v220 offset:13312
    v_fma_f32 v240, v134, s20, v226
    v_exp_f32 v239, v239
    v_mfma_f32_32x32x16_bf16 a[48:63], v[208:211], v[192:195], 0
    v_add_f32 v233, v233, v237
    v_cvt_pk_bf16_f32 v185, v236, v237
    v_fma_f32 v241, v135, s20, v226
    s_waitcnt lgkmcnt(4)
    v_mfma_f32_32x32x16_bf16 v[48:63], v[212:215], v[180:183], v[48:63]
    ds_read_b64_tr_b16 v[208:209], v220 offset:320
    ds_read_b64_tr_b16 v[210:211], v220 offset:4672
    v_exp_f32 v240, v240
    v_add_f32 v232, v232, v238
    v_mfma_f32_32x32x16_bf16 a[48:63], v[212:215], v[196:199], a[48:63]
    v_fma_f32 v234, v136, s20, v226
    v_exp_f32 v241, v241
    s_waitcnt lgkmcnt(4)
    v_mfma_f32_32x32x16_bf16 v[64:79], v[200:203], v[176:179], 0
    ds_read_b64_tr_b16 v[212:213], v220 offset:9024
    ds_read_b64_tr_b16 v[214:215], v220 offset:13376
    v_add_f32 v233, v233, v239
    v_cvt_pk_bf16_f32 v186, v238, v239
    v_fma_f32 v235, v137, s20, v226
    v_mfma_f32_32x32x16_bf16 a[64:79], v[200:203], v[192:195], 0
    v_exp_f32 v234, v234
    v_add_f32 v232, v232, v240
    s_waitcnt lgkmcnt(4)
    v_mfma_f32_32x32x16_bf16 v[64:79], v[204:207], v[180:183], v[64:79]
    ds_read_b64_tr_b16 v[200:201], v221 offset:384
    ds_read_b64_tr_b16 v[202:203], v221 offset:4736
    v_fma_f32 v236, v138, s20, v226
    v_exp_f32 v235, v235
    v_mfma_f32_32x32x16_bf16 a[64:79], v[204:207], v[196:199], a[64:79]
    v_add_f32 v233, v233, v241
    v_cvt_pk_bf16_f32 v187, v240, v241
    v_fma_f32 v237, v139, s20, v226
    s_waitcnt lgkmcnt(4)
    v_mfma_f32_32x32x16_bf16 v[80:95], v[208:211], v[176:179], 0
    ds_read_b64_tr_b16 v[204:205], v221 offset:9088
    ds_read_b64_tr_b16 v[206:207], v221 offset:13440
    v_exp_f32 v236, v236
    v_add_f32 v232, v232, v234
    v_mfma_f32_32x32x16_bf16 a[80:95], v[208:211], v[192:195], 0
    v_fma_f32 v238, v140, s20, v226
    v_exp_f32 v237, v237
    v_add_u32 v219, s26, v216
    s_waitcnt lgkmcnt(4)
    v_mfma_f32_32x32x16_bf16 v[80:95], v[212:215], v[180:183], v[80:95]
    ds_read_b64_tr_b16 v[208:209], v221 offset:448
    ds_read_b64_tr_b16 v[210:211], v221 offset:4800
    v_add_f32 v233, v233, v235
    v_cvt_pk_bf16_f32 v188, v234, v235
    v_mfma_f32_32x32x16_bf16 a[80:95], v[212:215], v[196:199], a[80:95]
    v_fma_f32 v239, v141, s20, v226
    v_exp_f32 v238, v238
    s_add_u32 s26, s26, 16896
    s_cmp_ge_u32 s26, 67584
    s_cselect_b32 s26, 0, s26
    s_waitcnt lgkmcnt(4)
    v_mfma_f32_32x32x16_bf16 v[96:111], v[200:203], v[176:179], 0
    ds_read_b64_tr_b16 v[212:213], v221 offset:9152
    ds_read_b64_tr_b16 v[214:215], v221 offset:13504
    v_add_f32 v232, v232, v236
    v_fma_f32 v240, v142, s20, v226
    v_exp_f32 v239, v239
    v_mfma_f32_32x32x16_bf16 a[96:111], v[200:203], v[192:195], 0
    v_add_f32 v233, v233, v237
    v_cvt_pk_bf16_f32 v189, v236, v237
    s_waitcnt lgkmcnt(4)
    v_mfma_f32_32x32x16_bf16 v[96:111], v[204:207], v[180:183], v[96:111]
    ds_read_b128 v[200:203], v219 offset:0
    v_fma_f32 v241, v143, s20, v226
    v_exp_f32 v240, v240
    v_mfma_f32_32x32x16_bf16 a[96:111], v[204:207], v[196:199], a[96:111]
    v_add_f32 v232, v232, v238
    v_exp_f32 v241, v241
    s_waitcnt lgkmcnt(3)
    v_mfma_f32_32x32x16_bf16 v[112:127], v[208:211], v[176:179], 0
    ds_read_b128 v[204:207], v219 offset:32
    v_add_f32 v233, v233, v239
    v_cvt_pk_bf16_f32 v190, v238, v239
    v_add_f32 v232, v232, v240
    v_mfma_f32_32x32x16_bf16 a[112:127], v[208:211], v[192:195], 0
    v_add_f32 v233, v233, v241
    v_cvt_pk_bf16_f32 v191, v240, v241
    v_add_f32 v232, v232, v233
    s_waitcnt lgkmcnt(2)
    v_mfma_f32_32x32x16_bf16 v[112:127], v[212:215], v[180:183], v[112:127]
    ds_read_b128 v[208:211], v219 offset:64
    v_cmp_lt_f32 vcc, s40, v232
    s_cbranch_vccnz RARE_3
BACK_3:
    v_add_f32 v228, v228, v232
    v_mfma_f32_32x32x16_bf16 a[112:127], v[212:215], v[196:199], a[112:127]
    s_mov_b32 s28, 5
LOOP:
    s_waitcnt lgkmcnt(2)
    v_mfma_f32_32x32x16_bf16 v[128:143], v[200:203], a[128:131], 0
    ds_read_b128 v[212:215], v219 offset:96
    s_add_u32 m0, s25, 0
    v_fma_f32 v234, v160, s20, v227
    buffer_load_dwordx4 v223, s[12:15], s23 offen offset:0 nt lds
    v_mfma_f32_32x32x16_bf16 v[144:159], v[200:203], a[192:195], 0
    v_fma_f32 v235, v161, s20, v227
    v_exp_f32 v234, v234
    s_waitcnt lgkmcnt(2)
    v_mfma_f32_32x32x16_bf16 v[128:143], v[204:207], a[132:135], v[128:143]
    ds_read_b128 v[200:203], v219 offset:128
    v_fma_f32 v236, v162, s20, v227
    v_exp_f32 v235, v235
    v_fma_f32 v237, v163, s20, v227
    v_mfma_f32_32x32x16_bf16 v[144:159], v[204:207], a[196:199], v[144:159]
    s_add_u32 m0, s25, 64
    v_exp_f32 v236, v236
    s_waitcnt lgkmcnt(2)
    v_mfma_f32_32x32x16_bf16 v[128:143], v[208:211], a[136:139], v[128:143]
    ds_read_b128 v[204:207], v219 offset:160
    buffer_load_dwordx4 v223, s[12:15], s23 offen offset:1024 nt lds
    v_mov_b32 v232, v234
    v_fma_f32 v238, v164, s20, v227
    v_mfma_f32_32x32x16_bf16 v[144:159], v[208:211], a[200:203], v[144:159]
    v_exp_f32 v237, v237
    v_mov_b32 v233, v235
    s_waitcnt lgkmcnt(2)
    v_mfma_f32_32x32x16_bf16 v[128:143], v[212:215], a[140:143], v[128:143]
    ds_read_b128 v[208:211], v219 offset:192
    v_cvt_pk_bf16_f32 v192, v234, v235
    s_add_u32 m0, s25, 128
    v_fma_f32 v239, v165, s20, v227
    buffer_load_dwordx4 v223, s[12:15], s23 offen offset:2048 nt lds
    v_mfma_f32_32x32x16_bf16 v[144:159], v[212:215], a[204:207], v[144:159]
    v_exp_f32 v238, v238
    v_add_f32 v232, v232, v236
    s_waitcnt lgkmcnt(2)
    v_mfma_f32_32x32x16_bf16 v[128:143], v[200:203], a[144:147], v[128:143]
    ds_read_b128 v[212:215], v219 offset:224
    v_fma_f32 v240, v166, s20, v227
    v_exp_f32 v239, v239
    v_mfma_f32_32x32x16_bf16 v[144:159], v[200:203], a[208:211], v[144:159]
    v_add_f32 v233, v233, v237
    s_add_u32 m0, s25, 192
    v_cvt_pk_bf16_f32 v193, v236, v237
    buffer_load_dwordx4 v223, s[12:15], s23 offen offset:3072 nt lds
    s_waitcnt lgkmcnt(2)
    v_mfma_f32_32x32x16_bf16 v[128:143], v[204:207], a[148:151], v[128:143]
    ds_read_b128 v[200:203], v219 offset:256
    v_fma_f32 v241, v167, s20, v227
    v_exp_f32 v240, v240
    v_mfma_f32_32x32x16_bf16 v[144:159], v[204:207], a[212:215], v[144:159]
    v_add_f32 v232, v232, v238
    v_fma_f32 v234, v168, s20, v227
    s_waitcnt lgkmcnt(2)
    v_mfma_f32_32x32x16_bf16 v[128:143], v[208:211], a[152:155], v[128:143]
    ds_read_b128 v[204:207], v219 offset:288
    v_exp_f32 v241, v241
    s_add_u32 s23, s23, 16384
    s_add_u32 s25, s25, 17408
    s_cmp_ge_u32 s25, s34
    s_cselect_b32 s36, 87040, 0
    s_sub_u32 s25, s25, s36
    v_mfma_f32_32x32x16_bf16 v[144:159], v[208:211], a[216:219], v[144:159]
    s_add_u32 m0, s24, 0
    v_add_f32 v233, v233, v239
    buffer_load_dwordx4 v222, s[8:11], s22 offen offset:0 nt lds
    s_waitcnt lgkmcnt(2)
    v_mfma_f32_32x32x16_bf16 v[128:143], v[212:215], a[156:159], v[128:143]
    ds_read_b128 v[208:211], v219 offset:320
    v_cvt_pk_bf16_f32 v194, v238, v239
    v_fma_f32 v235, v169, s20, v227
    v_mfma_f32_32x32x16_bf16 v[144:159], v[212:215], a[220:223], v[144:159]
    v_exp_f32 v234, v234
    v_add_f32 v232, v232, v240
    v_fma_f32 v236, v170, s20, v227
    s_waitcnt lgkmcnt(2)
    v_mfma_f32_32x32x16_bf16 v[128:143], v[200:203], a[160:163], v[128:143]
    ds_read_b128 v[212:215], v219 offset:352
    s_add_u32 m0, s24, 32
    v_exp_f32 v235, v235
    v_mfma_f32_32x32x16_bf16 v[144:159], v[200:203], a[224:227], v[144:159]
    buffer_load_dwordx4 v222, s[8:11], s22 offen offset:1024 nt lds
    v_add_f32 v233, v233, v241
    v_cvt_pk_bf16_f32 v195, v240, v241
    s_waitcnt lgkmcnt(2)
    v_mfma_f32_32x32x16_bf16 v[128:143], v[204:207], a[164:167], v[128:143]
    ds_read_b128 v[200:203], v219 offset:384
    v_fma_f32 v237, v171, s20, v227
    v_exp_f32 v236, v236
    v_add_f32 v232, v232, v234
    v_mfma_f32_32x32x16_bf16 v[144:159], v[204:207], a[228:231], v[144:159]
    s_add_u32 m0, s24, 64
    v_fma_f32 v238, v172, s20, v227
    buffer_load_dwordx4 v222, s[8:11], s22 offen offset:2048 nt lds
    s_waitcnt lgkmcnt(2)
    v_mfma_f32_32x32x16_bf16 v[128:143], v[208:211], a[168:171], v[128:143]
    ds_read_b128 v[204:207], v219 offset:416
    v_exp_f32 v237, v237
    v_add_f32 v233, v233, v235
    v_add_u32 v220, s27, v217
    v_mfma_f32_32x32x16_bf16 v[144:159], v[208:211], a[232:235], v[144:159]
    v_cvt_pk_bf16_f32 v196, v234, v235
    v_fma_f32 v239, v173, s20, v227
    v_exp_f32 v238, v238
    v_add_u32 v221, s27, v218
    s_waitcnt lgkmcnt(2)
    v_mfma_f32_32x32x16_bf16 v[128:143], v[212:215], a[172:175], v[128:143]
    ds_read_b128 v[208:211], v219 offset:448
    s_add_u32 m0, s24, 96
    v_add_f32 v232, v232, v236
    buffer_load_dwordx4 v222, s[8:11], s22 offen offset:3072 nt lds
    v_mfma_f32_32x32x16_bf16 v[144:159], v[212:215], a[236:239], v[144:159]
    v_fma_f32 v240, v174, s20, v227
    v_exp_f32 v239, v239
    s_add_u32 s27, s27, 17408
    s_cmp_ge_u32 s27, 154624
    s_cselect_b32 s27, 67584, s27
    s_waitcnt lgkmcnt(2)
    v_mfma_f32_32x32x16_bf16 v[128:143], v[200:203], a[176:179], v[128:143]
    ds_read_b128 v[212:215], v219 offset:480
    v_add_f32 v233, v233, v237
    v_cvt_pk_bf16_f32 v197, v236, v237
    v_fma_f32 v241, v175, s20, v227
    v_mfma_f32_32x32x16_bf16 v[144:159], v[200:203], a[240:243], v[144:159]
    s_add_u32 s22, s22, 16384
    s_add_u32 s24, s24, 16896
    s_cmp_ge_u32 s24, s33
    s_cselect_b32 s36, 67584, 0
    s_sub_u32 s24, s24, s36
    s_waitcnt lgkmcnt(2)
    v_mfma_f32_32x32x16_bf16 v[128:143], v[204:207], a[180:183], v[128:143]
    ds_read_b64_tr_b16 v[200:201], v220 offset:0
    ds_read_b64_tr_b16 v[202:203], v220 offset:4352
    v_exp_f32 v240, v240
    v_add_f32 v232, v232, v238
    v_mfma_f32_32x32x16_bf16 v[144:159], v[204:207], a[244:247], v[144:159]
    v_exp_f32 v241, v241
    v_add_f32 v233, v233, v239
    v_cvt_pk_bf16_f32 v198, v238, v239
    s_waitcnt lgkmcnt(3)
    v_mfma_f32_32x32x16_bf16 v[128:143], v[208:211], a[184:187], v[128:143]
    ds_read_b64_tr_b16 v[204:205], v220 offset:8704
    ds_read_b64_tr_b16 v[206:207], v220 offset:13056
    v_add_f32 v232, v232, v240
    v_add_f32 v233, v233, v241
    v_cvt_pk_bf16_f32 v199, v240, v241
    v_mfma_f32_32x32x16_bf16 v[144:159], v[208:211], a[248:251], v[144:159]
    v_add_f32 v232, v232, v233
    v_cmp_lt_f32 vcc, s40, v232
    s_cbranch_vccnz RARE_4
BACK_4:
    v_add_f32 v229, v229, v232
    s_waitcnt lgkmcnt(4)
    v_mfma_f32_32x32x16_bf16 v[128:143], v[212:215], a[188:191], v[128:143]
    ds_read_b64_tr_b16 v[208:209], v220 offset:64
    ds_read_b64_tr_b16 v[210:211], v220 offset:4416
    v_mfma_f32_32x32x16_bf16 v[144:159], v[212:215], a[252:255], v[144:159]
    s_cmp_lg_u32 s30, 0
    s_cbranch_scc1 RESC_5
RBACK_5:
    s_waitcnt lgkmcnt(4)
    v_mfma_f32_32x32x16_bf16 v[0:15], v[200:203], v[184:187], v[0:15]
    ds_read_b64_tr_b16 v[212:213], v220 offset:8768
    ds_read_b64_tr_b16 v[214:215], v220 offset:13120
    v_mfma_f32_32x32x16_bf16 a[0:15], v[200:203], v[192:195], a[0:15]
    s_waitcnt vmcnt(16)
    s_barrier
    s_waitcnt lgkmcnt(4)
    v_mfma_f32_32x32x16_bf16 v[0:15], v[204:207], v[188:191], v[0:15]
    ds_read_b64_tr_b16 v[200:201], v221 offset:128
    ds_read_b64_tr_b16 v[202:203], v221 offset:4480
    v_mfma_f32_32x32x16_bf16 a[0:15], v[204:207], v[196:199], a[0:15]
    s_waitcnt lgkmcnt(4)
    v_mfma_f32_32x32x16_bf16 v[16:31], v[208:211], v[184:187], v[16:31]
    ds_read_b64_tr_b16 v[204:205], v221 offset:8832
    ds_read_b64_tr_b16 v[206:207], v221 offset:13184
    v_mfma_f32_32x32x16_bf16 a[16:31], v[208:211], v[192:195], a[16:31]
    v_fma_f32 v234, v128, s20, v226
    v_fma_f32 v235, v129, s20, v226
    s_waitcnt lgkmcnt(4)
    v_mfma_f32_32x32x16_bf16 v[16:31], v[212:215], v[188:191], v[16:31]
    ds_read_b64_tr_b16 v[208:209], v221 offset:192
    ds_read_b64_tr_b16 v[210:211], v221 offset:4544
    v_exp_f32 v234, v234
    v_fma_f32 v236, v130, s20, v226
    v_mfma_f32_32x32x16_bf16 a[16:31], v[212:215], v[196:199], a[16:31]
    v_exp_f32 v235, v235
    v_fma_f32 v237, v131, s20, v226
    s_waitcnt lgkmcnt(4)
    v_mfma_f32_32x32x16_bf16 v[32:47], v[200:203], v[184:187], v[32:47]
    ds_read_b64_tr_b16 v[212:213], v221 offset:8896
    ds_read_b64_tr_b16 v[214:215], v221 offset:13248
    v_exp_f32 v236, v236
    v_mov_b32 v232, v234
    v_fma_f32 v238, v132, s20, v226
    v_mfma_f32_32x32x16_bf16 a[32:47], v[200:203], v[192:195], a[32:47]
    v_exp_f32 v237, v237
    v_mov_b32 v233, v235
    s_waitcnt lgkmcnt(4)
    v_mfma_f32_32x32x16_bf16 v[32:47], v[204:207], v[188:191], v[32:47]
    ds_read_b64_tr_b16 v[200:201], v220 offset:256
    ds_read_b64_tr_b16 v[202:203], v220 offset:4608
    v_cvt_pk_bf16_f32 v176, v234, v235
    v_fma_f32 v239, v133, s20, v226
    v_mfma_f32_32x32x16_bf16 a[32:47], v[204:207], v[196:199], a[32:47]
    v_exp_f32 v238, v238
    v_add_f32 v232, v232, v236
    s_waitcnt lgkmcnt(4)
    v_mfma_f32_32x32x16_bf16 v[48:63], v[208:211], v[184:187], v[48:63]
    ds_read_b64_tr_b16 v[204:205], v220 offset:8960
    ds_read_b64_tr_b16 v[206:207], v220 offset:13312
    v_fma_f32 v240, v134, s20, v226
    v_exp_f32 v239, v239
    v_mfma_f32_32x32x16_bf16 a[48:63], v[208:211], v[192:195], a[48:63]
    v_add_f32 v233, v233, v237
    v_cvt_pk_bf16_f32 v177, v236, v237
    v_fma_f32 v241, v135, s20, v226
    s_waitcnt lgkmcnt(4)
    v_mfma_f32_32x32x16_bf16 v[48:63], v[212:215], v[188:191], v[48:63]
    ds_read_b64_tr_b16 v[208:209], v220 offset:320
    ds_read_b64_tr_b16 v[210:211], v220 offset:4672
    v_exp_f32 v240, v240
    v_add_f32 v232, v232, v238
    v_mfma_f32_32x32x16_bf16 a[48:63], v[212:215], v[196:199], a[48:63]
    v_fma_f32 v234, v136, s20, v226
    v_exp_f32 v241, v241
    s_waitcnt lgkmcnt(4)
    v_mfma_f32_32x32x16_bf16 v[64:79], v[200:203], v[184:187], v[64:79]
    ds_read_b64_tr_b16 v[212:213], v220 offset:9024
    ds_read_b64_tr_b16 v[214:215], v220 offset:13376
    v_add_f32 v233, v233, v239
    v_cvt_pk_bf16_f32 v178, v238, v239
    v_fma_f32 v235, v137, s20, v226
    v_mfma_f32_32x32x16_bf16 a[64:79], v[200:203], v[192:195], a[64:79]
    v_exp_f32 v234, v234
    v_add_f32 v232, v232, v240
    s_waitcnt lgkmcnt(4)
    v_mfma_f32_32x32x16_bf16 v[64:79], v[204:207], v[188:191], v[64:79]
    ds_read_b64_tr_b16 v[200:201], v221 offset:384
    ds_read_b64_tr_b16 v[202:203], v221 offset:4736
    v_fma_f32 v236, v138, s20, v226
    v_exp_f32 v235, v235
    v_mfma_f32_32x32x16_bf16 a[64:79], v[204:207], v[196:199], a[64:79]
    v_add_f32 v233, v233, v241
    v_cvt_pk_bf16_f32 v179, v240, v241
    v_fma_f32 v237, v139, s20, v226
    s_waitcnt lgkmcnt(4)
    v_mfma_f32_32x32x16_bf16 v[80:95], v[208:211], v[184:187], v[80:95]
    ds_read_b64_tr_b16 v[204:205], v221 offset:9088
    ds_read_b64_tr_b16 v[206:207], v221 offset:13440
    v_exp_f32 v236, v236
    v_add_f32 v232, v232, v234
    v_mfma_f32_32x32x16_bf16 a[80:95], v[208:211], v[192:195], a[80:95]
    v_fma_f32 v238, v140, s20, v226
    v_exp_f32 v237, v237
    v_add_u32 v219, s26, v216
    s_waitcnt lgkmcnt(4)
    v_mfma_f32_32x32x16_bf16 v[80:95], v[212:215], v[188:191], v[80:95]
    ds_read_b64_tr_b16 v[208:209], v221 offset:448
    ds_read_b64_tr_b16 v[210:211], v221 offset:4800
    v_add_f32 v233, v233, v235
    v_cvt_pk_bf16_f32 v180, v234, v235
    v_mfma_f32_32x32x16_bf16 a[80:95], v[212:215], v[196:199], a[80:95]
    v_fma_f32 v239, v141, s20, v226
    v_exp_f32 v238, v238
    s_add_u32 s26, s26, 16896
    s_cmp_ge_u32 s26, 67584
    s_cselect_b32 s26, 0, s26
    s_waitcnt lgkmcnt(4)
    v_mfma_f32_32x32x16_bf16 v[96:111], v[200:203], v[184:187], v[96:111]
    ds_read_b64_tr_b16 v[212:213], v221 offset:9152
    ds_read_b64_tr_b16 v[214:215], v221 offset:13504
    v_add_f32 v232, v232, v236
    v_fma_f32 v240, v142, s20, v226
    v_exp_f32 v239, v239
    v_mfma_f32_32x32x16_bf16 a[96:111], v[200:203], v[192:195], a[96:111]
    v_add_f32 v233, v233, v237
    v_cvt_pk_bf16_f32 v181, v236, v237
    s_waitcnt lgkmcnt(4)
    v_mfma_f32_32x32x16_bf16 v[96:111], v[204:207], v[188:191], v[96:111]
    ds_read_b128 v[200:203], v219 offset:0
    v_fma_f32 v241, v143, s20, v226
    v_exp_f32 v240, v240
    v_mfma_f32_32x32x16_bf16 a[96:111], v[204:207], v[196:199], a[96:111]
    v_add_f32 v232, v232, v238
    v_exp_f32 v241, v241
    s_waitcnt lgkmcnt(3)
    v_mfma_f32_32x32x16_bf16 v[112:127], v[208:211], v[184:187], v[112:127]
    ds_read_b128 v[204:207], v219 offset:32
    v_add_f32 v233, v233, v239
    v_cvt_pk_bf16_f32 v182, v238, v239
    v_add_f32 v232, v232, v240
    v_mfma_f32_32x32x16_bf16 a[112:127], v[208:211], v[192:195], a[112:127]
    v_add_f32 v233, v233, v241
    v_cvt_pk_bf16_f32 v183, v240, v241
    v_add_f32 v232, v232, v233
    s_waitcnt lgkmcnt(2)
    v_mfma_f32_32x32x16_bf16 v[112:127], v[212:215], v[188:191], v[112:127]
    ds_read_b128 v[208:211], v219 offset:64
    v_cmp_lt_f32 vcc, s40, v232
    s_cbranch_vccnz RARE_6
BACK_6:
    v_add_f32 v228, v228, v232
    v_mfma_f32_32x32x16_bf16 a[112:127], v[212:215], v[196:199], a[112:127]
    s_waitcnt lgkmcnt(2)
    v_mfma_f32_32x32x16_bf16 v[128:143], v[200:203], a[128:131], 0
    ds_read_b128 v[212:215], v219 offset:96
    s_add_u32 m0, s25, 0
    v_fma_f32 v234, v144, s20, v227
    buffer_load_dwordx4 v223, s[12:15], s23 offen offset:0 nt lds
    v_mfma_f32_32x32x16_bf16 v[160:175], v[200:203], a[192:195], 0
    v_fma_f32 v235, v145, s20, v227
    v_exp_f32 v234, v234
    s_waitcnt lgkmcnt(2)
    v_mfma_f32_32x32x16_bf16 v[128:143], v[204:207], a[132:135], v[128:143]
    ds_read_b128 v[200:203], v219 offset:128
    v_fma_f32 v236, v146, s20, v227
    v_exp_f32 v235, v235
    v_fma_f32 v237, v147, s20, v227
    v_mfma_f32_32x32x16_bf16 v[160:175], v[204:207], a[196:199], v[160:175]
    s_add_u32 m0, s25, 64
    v_exp_f32 v236, v236
    s_waitcnt lgkmcnt(2)
    v_mfma_f32_32x32x16_bf16 v[128:143], v[208:211], a[136:139], v[128:143]
    ds_read_b128 v[204:207], v219 offset:160
    buffer_load_dwordx4 v223, s[12:15], s23 offen offset:1024 nt lds
    v_mov_b32 v232, v234
    v_fma_f32 v238, v148, s20, v227
    v_mfma_f32_32x32x16_bf16 v[160:175], v[208:211], a[200:203], v[160:175]
    v_exp_f32 v237, v237
    v_mov_b32 v233, v235
    s_waitcnt lgkmcnt(2)
    v_mfma_f32_32x32x16_bf16 v[128:143], v[212:215], a[140:143], v[128:143]
    ds_read_b128 v[208:211], v219 offset:192
    v_cvt_pk_bf16_f32 v192, v234, v235
    s_add_u32 m0, s25, 128
    v_fma_f32 v239, v149, s20, v227
    buffer_load_dwordx4 v223, s[12:15], s23 offen offset:2048 nt lds
    v_mfma_f32_32x32x16_bf16 v[160:175], v[212:215], a[204:207], v[160:175]
    v_exp_f32 v238, v238
    v_add_f32 v232, v232, v236
    s_waitcnt lgkmcnt(2)
    v_mfma_f32_32x32x16_bf16 v[128:143], v[200:203], a[144:147], v[128:143]
    ds_read_b128 v[212:215], v219 offset:224
    v_fma_f32 v240, v150, s20, v227
    v_exp_f32 v239, v239
    v_mfma_f32_32x32x16_bf16 v[160:175], v[200:203], a[208:211], v[160:175]
    v_add_f32 v233, v233, v237
    s_add_u32 m0, s25, 192
    v_cvt_pk_bf16_f32 v193, v236, v237
    buffer_load_dwordx4 v223, s[12:15], s23 offen offset:3072 nt lds
    s_waitcnt lgkmcnt(2)
    v_mfma_f32_32x32x16_bf16 v[128:143], v[204:207], a[148:151], v[128:143]
    ds_read_b128 v[200:203], v219 offset:256
    v_fma_f32 v241, v151, s20, v227
    v_exp_f32 v240, v240
    v_mfma_f32_32x32x16_bf16 v[160:175], v[204:207], a[212:215], v[160:175]
    v_add_f32 v232, v232, v238
    v_fma_f32 v234, v152, s20, v227
    s_waitcnt lgkmcnt(2)
    v_mfma_f32_32x32x16_bf16 v[128:143], v[208:211], a[152:155], v[128:143]
    ds_read_b128 v[204:207], v219 offset:288
    v_exp_f32 v241, v241
    s_add_u32 s23, s23, 16384
    s_add_u32 s25, s25, 17408
    s_cmp_ge_u32 s25, s34
    s_cselect_b32 s36, 87040, 0
    s_sub_u32 s25, s25, s36
    v_mfma_f32_32x32x16_bf16 v[160:175], v[208:211], a[216:219], v[160:175]
    s_add_u32 m0, s24, 0
    v_add_f32 v233, v233, v239
    buffer_load_dwordx4 v222, s[8:11], s22 offen offset:0 nt lds
    s_waitcnt lgkmcnt(2)
    v_mfma_f32_32x32x16_bf16 v[128:143], v[212:215], a[156:159], v[128:143]
    ds_read_b128 v[208:211], v219 offset:320
    v_cvt_pk_bf16_f32 v194, v238, v239
    v_fma_f32 v235, v153, s20, v227
    v_mfma_f32_32x32x16_bf16 v[160:175], v[212:215], a[220:223], v[160:175]
    v_exp_f32 v234, v234
    v_add_f32 v232, v232, v240
    v_fma_f32 v236, v154, s20, v227
    s_waitcnt lgkmcnt(2)
    v_mfma_f32_32x32x16_bf16 v[128:143], v[200:203], a[160:163], v[128:143]
    ds_read_b128 v[212:215], v219 offset:352
    s_add_u32 m0, s24, 32
    v_exp_f32 v235, v235
    v_mfma_f32_32x32x16_bf16 v[160:175], v[200:203], a[224:227], v[160:175]
    buffer_load_dwordx4 v222, s[8:11], s22 offen offset:1024 nt lds
    v_add_f32 v233, v233, v241
    v_cvt_pk_bf16_f32 v195, v240, v241
    s_waitcnt lgkmcnt(2)
    v_mfma_f32_32x32x16_bf16 v[128:143], v[204:207], a[164:167], v[128:143]
    ds_read_b128 v[200:203], v219 offset:384
    v_fma_f32 v237, v155, s20, v227
    v_exp_f32 v236, v236
    v_add_f32 v232, v232, v234
    v_mfma_f32_32x32x16_bf16 v[160:175], v[204:207], a[228:231], v[160:175]
    s_add_u32 m0, s24, 64
    v_fma_f32 v238, v156, s20, v227
    buffer_load_dwordx4 v222, s[8:11], s22 offen offset:2048 nt lds
    s_waitcnt lgkmcnt(2)
    v_mfma_f32_32x32x16_bf16 v[128:143], v[208:211], a[168:171], v[128:143]
    ds_read_b128 v[204:207], v219 offset:416
    v_exp_f32 v237, v237
    v_add_f32 v233, v233, v235
    v_add_u32 v220, s27, v217
    v_mfma_f32_32x32x16_bf16 v[160:175], v[208:211], a[232:235], v[160:175]
    v_cvt_pk_bf16_f32 v196, v234, v235
    v_fma_f32 v239, v157, s20, v227
    v_exp_f32 v238, v238
    v_add_u32 v221, s27, v218
    s_waitcnt lgkmcnt(2)
    v_mfma_f32_32x32x16_bf16 v[128:143], v[212:215], a[172:175], v[128:143]
    ds_read_b128 v[208:211], v219 offset:448
    s_add_u32 m0, s24, 96
    v_add_f32 v232, v232, v236
    buffer_load_dwordx4 v222, s[8:11], s22 offen offset:3072 nt lds
    v_mfma_f32_32x32x16_bf16 v[160:175], v[212:215], a[236:239], v[160:175]
    v_fma_f32 v240, v158, s20, v227
    v_exp_f32 v239, v239
    s_add_u32 s27, s27, 17408
    s_cmp_ge_u32 s27, 154624
    s_cselect_b32 s27, 67584, s27
    s_waitcnt lgkmcnt(2)
    v_mfma_f32_32x32x16_bf16 v[128:143], v[200:203], a[176:179], v[128:143]
    ds_read_b128 v[212:215], v219 offset:480
    v_add_f32 v233, v233, v237
    v_cvt_pk_bf16_f32 v197, v236, v237
    v_fma_f32 v241, v159, s20, v227
    v_mfma_f32_32x32x16_bf16 v[160:175], v[200:203], a[240:243], v[160:175]
    s_add_u32 s22, s22, 16384
    s_add_u32 s24, s24, 16896
    s_cmp_ge_u32 s24, s33
    s_cselect_b32 s36, 67584, 0
    s_sub_u32 s24, s24, s36
    s_waitcnt lgkmcnt(2)
    v_mfma_f32_32x32x16_bf16 v[128:143], v[204:207], a[180:183], v[128:143]
    ds_read_b64_tr_b16 v[200:201], v220 offset:0
    ds_read_b64_tr_b16 v[202:203], v220 offset:4352
    v_exp_f32 v240, v240
    v_add_f32 v232, v232, v238
    v_mfma_f32_32x32x16_bf16 v[160:175], v[204:207], a[244:247], v[160:175]
    v_exp_f32 v241, v241
    v_add_f32 v233, v233, v239
    v_cvt_pk_bf16_f32 v198, v238, v239
    s_waitcnt lgkmcnt(3)
    v_mfma_f32_32x32x16_bf16 v[128:143], v[208:211], a[184:187], v[128:143]
    ds_read_b64_tr_b16 v[204:205], v220 offset:8704
    ds_read_b64_tr_b16 v[206:207], v220 offset:13056
    v_add_f32 v232, v232, v240
    v_add_f32 v233, v233, v241
    v_cvt_pk_bf16_f32 v199, v240, v241
    v_mfma_f32_32x32x16_bf16 v[160:175], v[208:211], a[248:251], v[160:175]
    v_add_f32 v232, v232, v233
    v_cmp_lt_f32 vcc, s40, v232
    s_cbranch_vccnz RARE_7
BACK_7:
    v_add_f32 v229, v229, v232
    s_waitcnt lgkmcnt(4)
    v_mfma_f32_32x32x16_bf16 v[128:143], v[212:215], a[188:191], v[128:143]
    ds_read_b64_tr_b16 v[208:209], v220 offset:64
    ds_read_b64_tr_b16 v[210:211], v220 offset:4416
    v_mfma_f32_32x32x16_bf16 v[160:175], v[212:215], a[252:255], v[160:175]
    s_cmp_lg_u32 s30, 0
    s_cbranch_scc1 RESC_8
RBACK_8:
    s_waitcnt lgkmcnt(4)
    v_mfma_f32_32x32x16_bf16 v[0:15], v[200:203], v[176:179], v[0:15]
    ds_read_b64_tr_b16 v[212:213], v220 offset:8768
    ds_read_b64_tr_b16 v[214:215], v220 offset:13120
    v_mfma_f32_32x32x16_bf16 a[0:15], v[200:203], v[192:195], a[0:15]
    s_waitcnt vmcnt(16)
    s_barrier
    s_waitcnt lgkmcnt(4)
    v_mfma_f32_32x32x16_bf16 v[0:15], v[204:207], v[180:183], v[0:15]
    ds_read_b64_tr_b16 v[200:201], v221 offset:128
    ds_read_b64_tr_b16 v[202:203], v221 offset:4480
    v_mfma_f32_32x32x16_bf16 a[0:15], v[204:207], v[196:199], a[0:15]
    s_waitcnt lgkmcnt(4)
    v_mfma_f32_32x32x16_bf16 v[16:31], v[208:211], v[176:179], v[16:31]
    ds_read_b64_tr_b16 v[204:205], v221 offset:8832
    ds_read_b64_tr_b16 v[206:207], v221 offset:13184
    v_mfma_f32_32x32x16_bf16 a[16:31], v[208:211], v[192:195], a[16:31]
    v_fma_f32 v234, v128, s20, v226
    v_fma_f32 v235, v129, s20, v226
    s_waitcnt lgkmcnt(4)
    v_mfma_f32_32x32x16_bf16 v[16:31], v[212:215], v[180:183], v[16:31]
    ds_read_b64_tr_b16 v[208:209], v221 offset:192
    ds_read_b64_tr_b16 v[210:211], v221 offset:4544
    v_exp_f32 v234, v234
    v_fma_f32 v236, v130, s20, v226
    v_mfma_f32_32x32x16_bf16 a[16:31], v[212:215], v[196:199], a[16:31]
    v_exp_f32 v235, v235
    v_fma_f32 v237, v131, s20, v226
    s_waitcnt lgkmcnt(4)
    v_mfma_f32_32x32x16_bf16 v[32:47], v[200:203], v[176:179], v[32:47]
    ds_read_b64_tr_b16 v[212:213], v221 offset:8896
    ds_read_b64_tr_b16 v[214:215], v221 offset:13248
    v_exp_f32 v236, v236
    v_mov_b32 v232, v234
    v_fma_f32 v238, v132, s20, v226
    v_mfma_f32_32x32x16_bf16 a[32:47], v[200:203], v[192:195], a[32:47]
    v_exp_f32 v237, v237
    v_mov_b32 v233, v235
    s_waitcnt lgkmcnt(4)
    v_mfma_f32_32x32x16_bf16 v[32:47], v[204:207], v[180:183], v[32:47]
    ds_read_b64_tr_b16 v[200:201], v220 offset:256
    ds_read_b64_tr_b16 v[202:203], v220 offset:4608
    v_cvt_pk_bf16_f32 v184, v234, v235
    v_fma_f32 v239, v133, s20, v226
    v_mfma_f32_32x32x16_bf16 a[32:47], v[204:207], v[196:199], a[32:47]
    v_exp_f32 v238, v238
    v_add_f32 v232, v232, v236
    s_waitcnt lgkmcnt(4)
    v_mfma_f32_32x32x16_bf16 v[48:63], v[208:211], v[176:179], v[48:63]
    ds_read_b64_tr_b16 v[204:205], v220 offset:8960
    ds_read_b64_tr_b16 v[206:207], v220 offset:13312
    v_fma_f32 v240, v134, s20, v226
    v_exp_f32 v239, v239
    v_mfma_f32_32x32x16_bf16 a[48:63], v[208:211], v[192:195], a[48:63]
    v_add_f32 v233, v233, v237
    v_cvt_pk_bf16_f32 v185, v236, v237
    v_fma_f32 v241, v135, s20, v226
    s_waitcnt lgkmcnt(4)
    v_mfma_f32_32x32x16_bf16 v[48:63], v[212:215], v[180:183], v[48:63]
    ds_read_b64_tr_b16 v[208:209], v220 offset:320
    ds_read_b64_tr_b16 v[210:211], v220 offset:4672
    v_exp_f32 v240, v240
    v_add_f32 v232, v232, v238
    v_mfma_f32_32x32x16_bf16 a[48:63], v[212:215], v[196:199], a[48:63]
    v_fma_f32 v234, v136, s20, v226
    v_exp_f32 v241, v241
    s_waitcnt lgkmcnt(4)
    v_mfma_f32_32x32x16_bf16 v[64:79], v[200:203], v[176:179], v[64:79]
    ds_read_b64_tr_b16 v[212:213], v220 offset:9024
    ds_read_b64_tr_b16 v[214:215], v220 offset:13376
    v_add_f32 v233, v233, v239
    v_cvt_pk_bf16_f32 v186, v238, v239
    v_fma_f32 v235, v137, s20, v226
    v_mfma_f32_32x32x16_bf16 a[64:79], v[200:203], v[192:195], a[64:79]
    v_exp_f32 v234, v234
    v_add_f32 v232, v232, v240
    s_waitcnt lgkmcnt(4)
    v_mfma_f32_32x32x16_bf16 v[64:79], v[204:207], v[180:183], v[64:79]
    ds_read_b64_tr_b16 v[200:201], v221 offset:384
    ds_read_b64_tr_b16 v[202:203], v221 offset:4736
    v_fma_f32 v236, v138, s20, v226
    v_exp_f32 v235, v235
    v_mfma_f32_32x32x16_bf16 a[64:79], v[204:207], v[196:199], a[64:79]
    v_add_f32 v233, v233, v241
    v_cvt_pk_bf16_f32 v187, v240, v241
    v_fma_f32 v237, v139, s20, v226
    s_waitcnt lgkmcnt(4)
    v_mfma_f32_32x32x16_bf16 v[80:95], v[208:211], v[176:179], v[80:95]
    ds_read_b64_tr_b16 v[204:205], v221 offset:9088
    ds_read_b64_tr_b16 v[206:207], v221 offset:13440
    v_exp_f32 v236, v236
    v_add_f32 v232, v232, v234
    v_mfma_f32_32x32x16_bf16 a[80:95], v[208:211], v[192:195], a[80:95]
    v_fma_f32 v238, v140, s20, v226
    v_exp_f32 v237, v237
    v_add_u32 v219, s26, v216
    s_waitcnt lgkmcnt(4)
    v_mfma_f32_32x32x16_bf16 v[80:95], v[212:215], v[180:183], v[80:95]
    ds_read_b64_tr_b16 v[208:209], v221 offset:448
    ds_read_b64_tr_b16 v[210:211], v221 offset:4800
    v_add_f32 v233, v233, v235
    v_cvt_pk_bf16_f32 v188, v234, v235
    v_mfma_f32_32x32x16_bf16 a[80:95], v[212:215], v[196:199], a[80:95]
    v_fma_f32 v239, v141, s20, v226
    v_exp_f32 v238, v238
    s_add_u32 s26, s26, 16896
    s_cmp_ge_u32 s26, 67584
    s_cselect_b32 s26, 0, s26
    s_waitcnt lgkmcnt(4)
    v_mfma_f32_32x32x16_bf16 v[96:111], v[200:203], v[176:179], v[96:111]
    ds_read_b64_tr_b16 v[212:213], v221 offset:9152
    ds_read_b64_tr_b16 v[214:215], v221 offset:13504
    v_add_f32 v232, v232, v236
    v_fma_f32 v240, v142, s20, v226
    v_exp_f32 v239, v239
    v_mfma_f32_32x32x16_bf16 a[96:111], v[200:203], v[192:195], a[96:111]
    v_add_f32 v233, v233, v237
    v_cvt_pk_bf16_f32 v189, v236, v237
    s_waitcnt lgkmcnt(4)
    v_mfma_f32_32x32x16_bf16 v[96:111], v[204:207], v[180:183], v[96:111]
    ds_read_b128 v[200:203], v219 offset:0
    v_fma_f32 v241, v143, s20, v226
    v_exp_f32 v240, v240
    v_mfma_f32_32x32x16_bf16 a[96:111], v[204:207], v[196:199], a[96:111]
    v_add_f32 v232, v232, v238
    v_exp_f32 v241, v241
    s_waitcnt lgkmcnt(3)
    v_mfma_f32_32x32x16_bf16 v[112:127], v[208:211], v[176:179], v[112:127]
    ds_read_b128 v[204:207], v219 offset:32
    v_add_f32 v233, v233, v239
    v_cvt_pk_bf16_f32 v190, v238, v239
    v_add_f32 v232, v232, v240
    v_mfma_f32_32x32x16_bf16 a[112:127], v[208:211], v[192:195], a[112:127]
    v_add_f32 v233, v233, v241
    v_cvt_pk_bf16_f32 v191, v240, v241
    v_add_f32 v232, v232, v233
    s_waitcnt lgkmcnt(2)
    v_mfma_f32_32x32x16_bf16 v[112:127], v[212:215], v[180:183], v[112:127]
    ds_read_b128 v[208:211], v219 offset:64
    v_cmp_lt_f32 vcc, s40, v232
    s_cbranch_vccnz RARE_9
BACK_9:
    v_add_f32 v228, v228, v232
    v_mfma_f32_32x32x16_bf16 a[112:127], v[212:215], v[196:199], a[112:127]
    s_sub_u32 s28, s28, 1
    s_cmp_lg_u32 s28, 0
    s_cbranch_scc1 LOOP
    s_waitcnt lgkmcnt(2)
    v_mfma_f32_32x32x16_bf16 v[128:143], v[200:203], a[128:131], 0
    ds_read_b128 v[212:215], v219 offset:96
    s_add_u32 m0, s25, 0
    v_fma_f32 v234, v160, s20, v227
    buffer_load_dwordx4 v223, s[12:15], s23 offen offset:0 nt lds
    v_mfma_f32_32x32x16_bf16 v[144:159], v[200:203], a[192:195], 0
    v_fma_f32 v235, v161, s20, v227
    v_exp_f32 v234, v234
    s_waitcnt lgkmcnt(2)
    v_mfma_f32_32x32x16_bf16 v[128:143], v[204:207], a[132:135], v[128:143]
    ds_read_b128 v[200:203], v219 offset:128
    v_fma_f32 v236, v162, s20, v227
    v_exp_f32 v235, v235
    v_fma_f32 v237, v163, s20, v227
    v_mfma_f32_32x32x16_bf16 v[144:159], v[204:207], a[196:199], v[144:159]
    s_add_u32 m0, s25, 64
    v_exp_f32 v236, v236
    s_waitcnt lgkmcnt(2)
    v_mfma_f32_32x32x16_bf16 v[128:143], v[208:211], a[136:139], v[128:143]
    ds_read_b128 v[204:207], v219 offset:160
    buffer_load_dwordx4 v223, s[12:15], s23 offen offset:1024 nt lds
    v_mov_b32 v232, v234
    v_fma_f32 v238, v164, s20, v227
    v_mfma_f32_32x32x16_bf16 v[144:159], v[208:211], a[200:203], v[144:159]
    v_exp_f32 v237, v237
    v_mov_b32 v233, v235
    s_waitcnt lgkmcnt(2)
    v_mfma_f32_32x32x16_bf16 v[128:143], v[212:215], a[140:143], v[128:143]
    ds_read_b128 v[208:211], v219 offset:192
    v_cvt_pk_bf16_f32 v192, v234, v235
    s_add_u32 m0, s25, 128
    v_fma_f32 v239, v165, s20, v227
    buffer_load_dwordx4 v223, s[12:15], s23 offen offset:2048 nt lds
    v_mfma_f32_32x32x16_bf16 v[144:159], v[212:215], a[204:207], v[144:159]
    v_exp_f32 v238, v238
    v_add_f32 v232, v232, v236
    s_waitcnt lgkmcnt(2)
    v_mfma_f32_32x32x16_bf16 v[128:143], v[200:203], a[144:147], v[128:143]
    ds_read_b128 v[212:215], v219 offset:224
    v_fma_f32 v240, v166, s20, v227
    v_exp_f32 v239, v239
    v_mfma_f32_32x32x16_bf16 v[144:159], v[200:203], a[208:211], v[144:159]
    v_add_f32 v233, v233, v237
    s_add_u32 m0, s25, 192
    v_cvt_pk_bf16_f32 v193, v236, v237
    buffer_load_dwordx4 v223, s[12:15], s23 offen offset:3072 nt lds
    s_waitcnt lgkmcnt(2)
    v_mfma_f32_32x32x16_bf16 v[128:143], v[204:207], a[148:151], v[128:143]
    ds_read_b128 v[200:203], v219 offset:256
    v_fma_f32 v241, v167, s20, v227
    v_exp_f32 v240, v240
    v_mfma_f32_32x32x16_bf16 v[144:159], v[204:207], a[212:215], v[144:159]
    v_add_f32 v232, v232, v238
    v_fma_f32 v234, v168, s20, v227
    s_waitcnt lgkmcnt(2)
    v_mfma_f32_32x32x16_bf16 v[128:143], v[208:211], a[152:155], v[128:143]
    ds_read_b128 v[204:207], v219 offset:288
    v_exp_f32 v241, v241
    s_add_u32 s23, s23, 16384
    s_add_u32 s25, s25, 17408
    s_cmp_ge_u32 s25, s34
    s_cselect_b32 s36, 87040, 0
    s_sub_u32 s25, s25, s36
    v_mfma_f32_32x32x16_bf16 v[144:159], v[208:211], a[216:219], v[144:159]
    s_add_u32 m0, s24, 0
    v_add_f32 v233, v233, v239
    buffer_load_dwordx4 v222, s[8:11], s22 offen offset:0 nt lds
    s_waitcnt lgkmcnt(2)
    v_mfma_f32_32x32x16_bf16 v[128:143], v[212:215], a[156:159], v[128:143]
    ds_read_b128 v[208:211], v219 offset:320
    v_cvt_pk_bf16_f32 v194, v238, v239
    v_fma_f32 v235, v169, s20, v227
    v_mfma_f32_32x32x16_bf16 v[144:159], v[212:215], a[220:223], v[144:159]
    v_exp_f32 v234, v234
    v_add_f32 v232, v232, v240
    v_fma_f32 v236, v170, s20, v227
    s_waitcnt lgkmcnt(2)
    v_mfma_f32_32x32x16_bf16 v[128:143], v[200:203], a[160:163], v[128:143]
    ds_read_b128 v[212:215], v219 offset:352
    s_add_u32 m0, s24, 32
    v_exp_f32 v235, v235
    v_mfma_f32_32x32x16_bf16 v[144:159], v[200:203], a[224:227], v[144:159]
    buffer_load_dwordx4 v222, s[8:11], s22 offen offset:1024 nt lds
    v_add_f32 v233, v233, v241
    v_cvt_pk_bf16_f32 v195, v240, v241
    s_waitcnt lgkmcnt(2)
    v_mfma_f32_32x32x16_bf16 v[128:143], v[204:207], a[164:167], v[128:143]
    ds_read_b128 v[200:203], v219 offset:384
    v_fma_f32 v237, v171, s20, v227
    v_exp_f32 v236, v236
    v_add_f32 v232, v232, v234
    v_mfma_f32_32x32x16_bf16 v[144:159], v[204:207], a[228:231], v[144:159]
    s_add_u32 m0, s24, 64
    v_fma_f32 v238, v172, s20, v227
    buffer_load_dwordx4 v222, s[8:11], s22 offen offset:2048 nt lds
    s_waitcnt lgkmcnt(2)
    v_mfma_f32_32x32x16_bf16 v[128:143], v[208:211], a[168:171], v[128:143]
    ds_read_b128 v[204:207], v219 offset:416
    v_exp_f32 v237, v237
    v_add_f32 v233, v233, v235
    v_add_u32 v220, s27, v217
    v_mfma_f32_32x32x16_bf16 v[144:159], v[208:211], a[232:235], v[144:159]
    v_cvt_pk_bf16_f32 v196, v234, v235
    v_fma_f32 v239, v173, s20, v227
    v_exp_f32 v238, v238
    v_add_u32 v221, s27, v218
    s_waitcnt lgkmcnt(2)
    v_mfma_f32_32x32x16_bf16 v[128:143], v[212:215], a[172:175], v[128:143]
    ds_read_b128 v[208:211], v219 offset:448
    s_add_u32 m0, s24, 96
    v_add_f32 v232, v232, v236
    buffer_load_dwordx4 v222, s[8:11], s22 offen offset:3072 nt lds
    v_mfma_f32_32x32x16_bf16 v[144:159], v[212:215], a[236:239], v[144:159]
    v_fma_f32 v240, v174, s20, v227
    v_exp_f32 v239, v239
    s_add_u32 s27, s27, 17408
    s_cmp_ge_u32 s27, 154624
    s_cselect_b32 s27, 67584, s27
    s_waitcnt lgkmcnt(2)
    v_mfma_f32_32x32x16_bf16 v[128:143], v[200:203], a[176:179], v[128:143]
    ds_read_b128 v[212:215], v219 offset:480
    v_add_f32 v233, v233, v237
    v_cvt_pk_bf16_f32 v197, v236, v237
    v_fma_f32 v241, v175, s20, v227
    v_mfma_f32_32x32x16_bf16 v[144:159], v[200:203], a[240:243], v[144:159]
    s_add_u32 s22, s22, 16384
    s_add_u32 s24, s24, 16896
    s_cmp_ge_u32 s24, s33
    s_cselect_b32 s36, 67584, 0
    s_sub_u32 s24, s24, s36
    s_waitcnt lgkmcnt(2)
    v_mfma_f32_32x32x16_bf16 v[128:143], v[204:207], a[180:183], v[128:143]
    ds_read_b64_tr_b16 v[200:201], v220 offset:0
    ds_read_b64_tr_b16 v[202:203], v220 offset:4352
    v_exp_f32 v240, v240
    v_add_f32 v232, v232, v238
    v_mfma_f32_32x32x16_bf16 v[144:159], v[204:207], a[244:247], v[144:159]
    v_exp_f32 v241, v241
    v_add_f32 v233, v233, v239
    v_cvt_pk_bf16_f32 v198, v238, v239
    s_waitcnt lgkmcnt(3)
    v_mfma_f32_32x32x16_bf16 v[128:143], v[208:211], a[184:187], v[128:143]
    ds_read_b64_tr_b16 v[204:205], v220 offset:8704
    ds_read_b64_tr_b16 v[206:207], v220 offset:13056
    v_add_f32 v232, v232, v240
    v_add_f32 v233, v233, v241
    v_cvt_pk_bf16_f32 v199, v240, v241
    v_mfma_f32_32x32x16_bf16 v[144:159], v[208:211], a[248:251], v[144:159]
    v_add_f32 v232, v232, v233
    v_cmp_lt_f32 vcc, s40, v232
    s_cbranch_vccnz RARE_10
BACK_10:
    v_add_f32 v229, v229, v232
    s_waitcnt lgkmcnt(4)
    v_mfma_f32_32x32x16_bf16 v[128:143], v[212:215], a[188:191], v[128:143]
    ds_read_b64_tr_b16 v[208:209], v220 offset:64
    ds_read_b64_tr_b16 v[210:211], v220 offset:4416
    v_mfma_f32_32x32x16_bf16 v[144:159], v[212:215], a[252:255], v[144:159]
    s_cmp_lg_u32 s30, 0
    s_cbranch_scc1 RESC_11
RBACK_11:
    s_waitcnt lgkmcnt(4)
    v_mfma_f32_32x32x16_bf16 v[0:15], v[200:203], v[184:187], v[0:15]
    ds_read_b64_tr_b16 v[212:213], v220 offset:8768
    ds_read_b64_tr_b16 v[214:215], v220 offset:13120
    v_mfma_f32_32x32x16_bf16 a[0:15], v[200:203], v[192:195], a[0:15]
    s_waitcnt vmcnt(16)
    s_barrier
    s_waitcnt lgkmcnt(4)
    v_mfma_f32_32x32x16_bf16 v[0:15], v[204:207], v[188:191], v[0:15]
    ds_read_b64_tr_b16 v[200:201], v221 offset:128
    ds_read_b64_tr_b16 v[202:203], v221 offset:4480
    v_mfma_f32_32x32x16_bf16 a[0:15], v[204:207], v[196:199], a[0:15]
    s_waitcnt lgkmcnt(4)
    v_mfma_f32_32x32x16_bf16 v[16:31], v[208:211], v[184:187], v[16:31]
    ds_read_b64_tr_b16 v[204:205], v221 offset:8832
    ds_read_b64_tr_b16 v[206:207], v221 offset:13184
    v_mfma_f32_32x32x16_bf16 a[16:31], v[208:211], v[192:195], a[16:31]
    v_fma_f32 v234, v128, s20, v226
    v_fma_f32 v235, v129, s20, v226
    s_waitcnt lgkmcnt(4)
    v_mfma_f32_32x32x16_bf16 v[16:31], v[212:215], v[188:191], v[16:31]
    ds_read_b64_tr_b16 v[208:209], v221 offset:192
    ds_read_b64_tr_b16 v[210:211], v221 offset:4544
    v_exp_f32 v234, v234
    v_fma_f32 v236, v130, s20, v226
    v_mfma_f32_32x32x16_bf16 a[16:31], v[212:215], v[196:199], a[16:31]
    v_exp_f32 v235, v235
    v_fma_f32 v237, v131, s20, v226
    s_waitcnt lgkmcnt(4)
    v_mfma_f32_32x32x16_bf16 v[32:47], v[200:203], v[184:187], v[32:47]
    ds_read_b64_tr_b16 v[212:213], v221 offset:8896
    ds_read_b64_tr_b16 v[214:215], v221 offset:13248
    v_exp_f32 v236, v236
    v_mov_b32 v232, v234
    v_fma_f32 v238, v132, s20, v226
    v_mfma_f32_32x32x16_bf16 a[32:47], v[200:203], v[192:195], a[32:47]
    v_exp_f32 v237, v237
    v_mov_b32 v233, v235
    s_waitcnt lgkmcnt(4)
    v_mfma_f32_32x32x16_bf16 v[32:47], v[204:207], v[188:191], v[32:47]
    ds_read_b64_tr_b16 v[200:201], v220 offset:256
    ds_read_b64_tr_b16 v[202:203], v220 offset:4608
    v_cvt_pk_bf16_f32 v176, v234, v235
    v_fma_f32 v239, v133, s20, v226
    v_mfma_f32_32x32x16_bf16 a[32:47], v[204:207], v[196:199], a[32:47]
    v_exp_f32 v238, v238
    v_add_f32 v232, v232, v236
    s_waitcnt lgkmcnt(4)
    v_mfma_f32_32x32x16_bf16 v[48:63], v[208:211], v[184:187], v[48:63]
    ds_read_b64_tr_b16 v[204:205], v220 offset:8960
    ds_read_b64_tr_b16 v[206:207], v220 offset:13312
    v_fma_f32 v240, v134, s20, v226
    v_exp_f32 v239, v239
    v_mfma_f32_32x32x16_bf16 a[48:63], v[208:211], v[192:195], a[48:63]
    v_add_f32 v233, v233, v237
    v_cvt_pk_bf16_f32 v177, v236, v237
    v_fma_f32 v241, v135, s20, v226
    s_waitcnt lgkmcnt(4)
    v_mfma_f32_32x32x16_bf16 v[48:63], v[212:215], v[188:191], v[48:63]
    ds_read_b64_tr_b16 v[208:209], v220 offset:320
    ds_read_b64_tr_b16 v[210:211], v220 offset:4672
    v_exp_f32 v240, v240
    v_add_f32 v232, v232, v238
    v_mfma_f32_32x32x16_bf16 a[48:63], v[212:215], v[196:199], a[48:63]
    v_fma_f32 v234, v136, s20, v226
    v_exp_f32 v241, v241
    s_waitcnt lgkmcnt(4)
    v_mfma_f32_32x32x16_bf16 v[64:79], v[200:203], v[184:187], v[64:79]
    ds_read_b64_tr_b16 v[212:213], v220 offset:9024
    ds_read_b64_tr_b16 v[214:215], v220 offset:13376
    v_add_f32 v233, v233, v239
    v_cvt_pk_bf16_f32 v178, v238, v239
    v_fma_f32 v235, v137, s20, v226
    v_mfma_f32_32x32x16_bf16 a[64:79], v[200:203], v[192:195], a[64:79]
    v_exp_f32 v234, v234
    v_add_f32 v232, v232, v240
    s_waitcnt lgkmcnt(4)
    v_mfma_f32_32x32x16_bf16 v[64:79], v[204:207], v[188:191], v[64:79]
    ds_read_b64_tr_b16 v[200:201], v221 offset:384
    ds_read_b64_tr_b16 v[202:203], v221 offset:4736
    v_fma_f32 v236, v138, s20, v226
    v_exp_f32 v235, v235
    v_mfma_f32_32x32x16_bf16 a[64:79], v[204:207], v[196:199], a[64:79]
    v_add_f32 v233, v233, v241
    v_cvt_pk_bf16_f32 v179, v240, v241
    v_fma_f32 v237, v139, s20, v226
    s_waitcnt lgkmcnt(4)
    v_mfma_f32_32x32x16_bf16 v[80:95], v[208:211], v[184:187], v[80:95]
    ds_read_b64_tr_b16 v[204:205], v221 offset:9088
    ds_read_b64_tr_b16 v[206:207], v221 offset:13440
    v_exp_f32 v236, v236
    v_add_f32 v232, v232, v234
    v_mfma_f32_32x32x16_bf16 a[80:95], v[208:211], v[192:195], a[80:95]
    v_fma_f32 v238, v140, s20, v226
    v_exp_f32 v237, v237
    v_add_u32 v219, s26, v216
    s_waitcnt lgkmcnt(4)
    v_mfma_f32_32x32x16_bf16 v[80:95], v[212:215], v[188:191], v[80:95]
    ds_read_b64_tr_b16 v[208:209], v221 offset:448
    ds_read_b64_tr_b16 v[210:211], v221 offset:4800
    v_add_f32 v233, v233, v235
    v_cvt_pk_bf16_f32 v180, v234, v235
    v_mfma_f32_32x32x16_bf16 a[80:95], v[212:215], v[196:199], a[80:95]
    v_fma_f32 v239, v141, s20, v226
    v_exp_f32 v238, v238
    s_add_u32 s26, s26, 16896
    s_cmp_ge_u32 s26, 67584
    s_cselect_b32 s26, 0, s26
    s_waitcnt lgkmcnt(4)
    v_mfma_f32_32x32x16_bf16 v[96:111], v[200:203], v[184:187], v[96:111]
    ds_read_b64_tr_b16 v[212:213], v221 offset:9152
    ds_read_b64_tr_b16 v[214:215], v221 offset:13504
    v_add_f32 v232, v232, v236
    v_fma_f32 v240, v142, s20, v226
    v_exp_f32 v239, v239
    v_mfma_f32_32x32x16_bf16 a[96:111], v[200:203], v[192:195], a[96:111]
    v_add_f32 v233, v233, v237
    v_cvt_pk_bf16_f32 v181, v236, v237
    s_waitcnt lgkmcnt(4)
    v_mfma_f32_32x32x16_bf16 v[96:111], v[204:207], v[188:191], v[96:111]
    ds_read_b128 v[200:203], v219 offset:0
    v_fma_f32 v241, v143, s20, v226
    v_exp_f32 v240, v240
    v_mfma_f32_32x32x16_bf16 a[96:111], v[204:207], v[196:199], a[96:111]
    v_add_f32 v232, v232, v238
    v_exp_f32 v241, v241
    s_waitcnt lgkmcnt(3)
    v_mfma_f32_32x32x16_bf16 v[112:127], v[208:211], v[184:187], v[112:127]
    ds_read_b128 v[204:207], v219 offset:32
    v_add_f32 v233, v233, v239
    v_cvt_pk_bf16_f32 v182, v238, v239
    v_add_f32 v232, v232, v240
    v_mfma_f32_32x32x16_bf16 a[112:127], v[208:211], v[192:195], a[112:127]
    v_add_f32 v233, v233, v241
    v_cvt_pk_bf16_f32 v183, v240, v241
    v_add_f32 v232, v232, v233
    s_waitcnt lgkmcnt(2)
    v_mfma_f32_32x32x16_bf16 v[112:127], v[212:215], v[188:191], v[112:127]
    ds_read_b128 v[208:211], v219 offset:64
    v_cmp_lt_f32 vcc, s40, v232
    s_cbranch_vccnz RARE_12
BACK_12:
    v_add_f32 v228, v228, v232
    v_mfma_f32_32x32x16_bf16 a[112:127], v[212:215], v[196:199], a[112:127]
    s_waitcnt lgkmcnt(2)
    v_mfma_f32_32x32x16_bf16 v[128:143], v[200:203], a[128:131], 0
    ds_read_b128 v[212:215], v219 offset:96
    s_add_u32 m0, s25, 0
    v_fma_f32 v234, v144, s20, v227
    buffer_load_dwordx4 v223, s[12:15], s23 offen offset:0 nt lds
    v_mfma_f32_32x32x16_bf16 v[160:175], v[200:203], a[192:195], 0
    v_fma_f32 v235, v145, s20, v227
    v_exp_f32 v234, v234
    v_fma_f32 v236, v146, s20, v227
    s_waitcnt lgkmcnt(2)
    v_mfma_f32_32x32x16_bf16 v[128:143], v[204:207], a[132:135], v[128:143]
    ds_read_b128 v[200:203], v219 offset:128
    v_exp_f32 v235, v235
    v_fma_f32 v237, v147, s20, v227
    v_mfma_f32_32x32x16_bf16 v[160:175], v[204:207], a[196:199], v[160:175]
    s_add_u32 m0, s25, 64
    v_exp_f32 v236, v236
    s_waitcnt lgkmcnt(2)
    v_mfma_f32_32x32x16_bf16 v[128:143], v[208:211], a[136:139], v[128:143]
    ds_read_b128 v[204:207], v219 offset:160
    buffer_load_dwordx4 v223, s[12:15], s23 offen offset:1024 nt lds
    v_mov_b32 v232, v234
    v_fma_f32 v238, v148, s20, v227
    v_mfma_f32_32x32x16_bf16 v[160:175], v[208:211], a[200:203], v[160:175]
    v_exp_f32 v237, v237
    v_mov_b32 v233, v235
    v_cvt_pk_bf16_f32 v192, v234, v235
    s_waitcnt lgkmcnt(2)
    v_mfma_f32_32x32x16_bf16 v[128:143], v[212:215], a[140:143], v[128:143]
    ds_read_b128 v[208:211], v219 offset:192
    s_add_u32 m0, s25, 128
    v_fma_f32 v239, v149, s20, v227
    buffer_load_dwordx4 v223, s[12:15], s23 offen offset:2048 nt lds
    v_mfma_f32_32x32x16_bf16 v[160:175], v[212:215], a[204:207], v[160:175]
    v_exp_f32 v238, v238
    v_add_f32 v232, v232, v236
    s_waitcnt lgkmcnt(2)
    v_mfma_f32_32x32x16_bf16 v[128:143], v[200:203], a[144:147], v[128:143]
    ds_read_b128 v[212:215], v219 offset:224
    v_fma_f32 v240, v150, s20, v227
    v_exp_f32 v239, v239
    v_add_f32 v233, v233, v237
    v_mfma_f32_32x32x16_bf16 v[160:175], v[200:203], a[208:211], v[160:175]
    s_add_u32 m0, s25, 192
    v_cvt_pk_bf16_f32 v193, v236, v237
    buffer_load_dwordx4 v223, s[12:15], s23 offen offset:3072 nt lds
    s_waitcnt lgkmcnt(2)
    v_mfma_f32_32x32x16_bf16 v[128:143], v[204:207], a[148:151], v[128:143]
    ds_read_b128 v[200:203], v219 offset:256
    v_fma_f32 v241, v151, s20, v227
    v_exp_f32 v240, v240
    v_mfma_f32_32x32x16_bf16 v[160:175], v[204:207], a[212:215], v[160:175]
    v_add_f32 v232, v232, v238
    v_fma_f32 v234, v152, s20, v227
    v_exp_f32 v241, v241
    s_waitcnt lgkmcnt(2)
    v_mfma_f32_32x32x16_bf16 v[128:143], v[208:211], a[152:155], v[128:143]
    ds_read_b128 v[204:207], v219 offset:288
    s_add_u32 s23, s23, 16384
    s_add_u32 s25, s25, 17408
    s_cmp_ge_u32 s25, s34
    s_cselect_b32 s36, 87040, 0
    s_sub_u32 s25, s25, s36
    v_mfma_f32_32x32x16_bf16 v[160:175], v[208:211], a[216:219], v[160:175]
    s_add_u32 m0, s24, 0
    s_add_u32 s37, s41, 0
    buffer_load_dwordx4 v224, s[4:7], s37 offen nt lds
    v_add_f32 v233, v233, v239
    s_waitcnt lgkmcnt(2)
    v_mfma_f32_32x32x16_bf16 v[128:143], v[212:215], a[156:159], v[128:143]
    ds_read_b128 v[208:211], v219 offset:320
    v_cvt_pk_bf16_f32 v194, v238, v239
    v_fma_f32 v235, v153, s20, v227
    v_mfma_f32_32x32x16_bf16 v[160:175], v[212:215], a[220:223], v[160:175]
    v_exp_f32 v234, v234
    v_add_f32 v232, v232, v240
    s_add_u32 m0, s24, 1024
    s_add_u32 s37, s41, 4096
    s_waitcnt lgkmcnt(2)
    v_mfma_f32_32x32x16_bf16 v[128:143], v[200:203], a[160:163], v[128:143]
    ds_read_b128 v[212:215], v219 offset:352
    buffer_load_dwordx4 v225, s[4:7], s37 offen nt lds
    v_fma_f32 v236, v154, s20, v227
    v_mfma_f32_32x32x16_bf16 v[160:175], v[200:203], a[224:227], v[160:175]
    v_exp_f32 v235, v235
    v_add_f32 v233, v233, v241
    v_cvt_pk_bf16_f32 v195, v240, v241
    s_waitcnt lgkmcnt(2)
    v_mfma_f32_32x32x16_bf16 v[128:143], v[204:207], a[164:167], v[128:143]
    ds_read_b128 v[200:203], v219 offset:384
    v_fma_f32 v237, v155, s20, v227
    s_add_u32 m0, s24, 2048
    s_add_u32 s37, s41, 8192
    buffer_load_dwordx4 v224, s[4:7], s37 offen nt lds
    v_mfma_f32_32x32x16_bf16 v[160:175], v[204:207], a[228:231], v[160:175]
    v_exp_f32 v236, v236
    v_add_f32 v232, v232, v234
    s_waitcnt lgkmcnt(2)
    v_mfma_f32_32x32x16_bf16 v[128:143], v[208:211], a[168:171], v[128:143]
    ds_read_b128 v[204:207], v219 offset:416
    v_fma_f32 v238, v156, s20, v227
    v_exp_f32 v237, v237
    v_add_f32 v233, v233, v235
    v_add_u32 v220, s27, v217
    v_mfma_f32_32x32x16_bf16 v[160:175], v[208:211], a[232:235], v[160:175]
    s_add_u32 m0, s24, 3072
    s_add_u32 s37, s41, 12288
    buffer_load_dwordx4 v225, s[4:7], s37 offen nt lds
    v_add_u32 v221, s27, v218
    s_waitcnt lgkmcnt(2)
    v_mfma_f32_32x32x16_bf16 v[128:143], v[212:215], a[172:175], v[128:143]
    ds_read_b128 v[208:211], v219 offset:448
    v_cvt_pk_bf16_f32 v196, v234, v235
    v_fma_f32 v239, v157, s20, v227
    v_exp_f32 v238, v238
    v_mfma_f32_32x32x16_bf16 v[160:175], v[212:215], a[236:239], v[160:175]
    v_add_f32 v232, v232, v236
    v_fma_f32 v240, v158, s20, v227
    s_add_u32 s27, s27, 17408
    s_cmp_ge_u32 s27, 154624
    s_cselect_b32 s27, 67584, s27
    s_waitcnt lgkmcnt(2)
    v_mfma_f32_32x32x16_bf16 v[128:143], v[200:203], a[176:179], v[128:143]
    ds_read_b128 v[212:215], v219 offset:480
    s_add_u32 s24, s24, 16896
    s_cmp_ge_u32 s24, s33
    s_cselect_b32 s36, 67584, 0
    s_sub_u32 s24, s24, s36
    v_exp_f32 v239, v239
    v_mfma_f32_32x32x16_bf16 v[160:175], v[200:203], a[240:243], v[160:175]
    v_add_f32 v233, v233, v237
    v_cvt_pk_bf16_f32 v197, v236, v237
    v_fma_f32 v241, v159, s20, v227
    s_waitcnt lgkmcnt(2)
    v_mfma_f32_32x32x16_bf16 v[128:143], v[204:207], a[180:183], v[128:143]
    ds_read_b64_tr_b16 v[200:201], v220 offset:0
    ds_read_b64_tr_b16 v[202:203], v220 offset:4352
    v_exp_f32 v240, v240
    v_add_f32 v232, v232, v238
    v_mfma_f32_32x32x16_bf16 v[160:175], v[204:207], a[244:247], v[160:175]
    v_exp_f32 v241, v241
    v_add_f32 v233, v233, v239
    v_cvt_pk_bf16_f32 v198, v238, v239
    s_waitcnt lgkmcnt(3)
    v_mfma_f32_32x32x16_bf16 v[128:143], v[208:211], a[184:187], v[128:143]
    ds_read_b64_tr_b16 v[204:205], v220 offset:8704
    ds_read_b64_tr_b16 v[206:207], v220 offset:13056
    v_add_f32 v232, v232, v240
    v_add_f32 v233, v233, v241
    v_cvt_pk_bf16_f32 v199, v240, v241
    v_mfma_f32_32x32x16_bf16 v[160:175], v[208:211], a[248:251], v[160:175]
    v_add_f32 v232, v232, v233
    v_cmp_lt_f32 vcc, s40, v232
    s_cbranch_vccnz RARE_13
BACK_13:
    v_add_f32 v229, v229, v232
    s_waitcnt lgkmcnt(4)
    v_mfma_f32_32x32x16_bf16 v[128:143], v[212:215], a[188:191], v[128:143]
    ds_read_b64_tr_b16 v[208:209], v220 offset:64
    ds_read_b64_tr_b16 v[210:211], v220 offset:4416
    v_mfma_f32_32x32x16_bf16 v[160:175], v[212:215], a[252:255], v[160:175]
    s_cmp_lg_u32 s30, 0
    s_cbranch_scc1 RESC_14
RBACK_14:
    s_waitcnt lgkmcnt(4)
    v_mfma_f32_32x32x16_bf16 v[0:15], v[200:203], v[176:179], v[0:15]
    ds_read_b64_tr_b16 v[212:213], v220 offset:8768
    ds_read_b64_tr_b16 v[214:215], v220 offset:13120
    v_mfma_f32_32x32x16_bf16 a[0:15], v[200:203], v[192:195], a[0:15]
    s_waitcnt vmcnt(16)
    s_barrier
    s_waitcnt lgkmcnt(4)
    v_mfma_f32_32x32x16_bf16 v[0:15], v[204:207], v[180:183], v[0:15]
    ds_read_b64_tr_b16 v[200:201], v221 offset:128
    ds_read_b64_tr_b16 v[202:203], v221 offset:4480
    v_mfma_f32_32x32x16_bf16 a[0:15], v[204:207], v[196:199], a[0:15]
    s_waitcnt lgkmcnt(4)
    v_mfma_f32_32x32x16_bf16 v[16:31], v[208:211], v[176:179], v[16:31]
    ds_read_b64_tr_b16 v[204:205], v221 offset:8832
    ds_read_b64_tr_b16 v[206:207], v221 offset:13184
    v_mfma_f32_32x32x16_bf16 a[16:31], v[208:211], v[192:195], a[16:31]
    v_fma_f32 v234, v128, s20, v226
    v_fma_f32 v235, v129, s20, v226
    s_waitcnt lgkmcnt(4)
    v_mfma_f32_32x32x16_bf16 v[16:31], v[212:215], v[180:183], v[16:31]
    ds_read_b64_tr_b16 v[208:209], v221 offset:192
    ds_read_b64_tr_b16 v[210:211], v221 offset:4544
    v_exp_f32 v234, v234
    v_fma_f32 v236, v130, s20, v226
    v_mfma_f32_32x32x16_bf16 a[16:31], v[212:215], v[196:199], a[16:31]
    v_exp_f32 v235, v235
    v_fma_f32 v237, v131, s20, v226
    s_waitcnt lgkmcnt(4)
    v_mfma_f32_32x32x16_bf16 v[32:47], v[200:203], v[176:179], v[32:47]
    ds_read_b64_tr_b16 v[212:213], v221 offset:8896
    ds_read_b64_tr_b16 v[214:215], v221 offset:13248
    v_exp_f32 v236, v236
    v_mov_b32 v232, v234
    v_fma_f32 v238, v132, s20, v226
    v_mfma_f32_32x32x16_bf16 a[32:47], v[200:203], v[192:195], a[32:47]
    v_exp_f32 v237, v237
    v_mov_b32 v233, v235
    s_waitcnt lgkmcnt(4)
    v_mfma_f32_32x32x16_bf16 v[32:47], v[204:207], v[180:183], v[32:47]
    ds_read_b64_tr_b16 v[200:201], v220 offset:256
    ds_read_b64_tr_b16 v[202:203], v220 offset:4608
    v_cvt_pk_bf16_f32 v184, v234, v235
    v_fma_f32 v239, v133, s20, v226
    v_mfma_f32_32x32x16_bf16 a[32:47], v[204:207], v[196:199], a[32:47]
    v_exp_f32 v238, v238
    v_add_f32 v232, v232, v236
    s_waitcnt lgkmcnt(4)
    v_mfma_f32_32x32x16_bf16 v[48:63], v[208:211], v[176:179], v[48:63]
    ds_read_b64_tr_b16 v[204:205], v220 offset:8960
    ds_read_b64_tr_b16 v[206:207], v220 offset:13312
    v_fma_f32 v240, v134, s20, v226
    v_exp_f32 v239, v239
    v_mfma_f32_32x32x16_bf16 a[48:63], v[208:211], v[192:195], a[48:63]
    v_add_f32 v233, v233, v237
    v_cvt_pk_bf16_f32 v185, v236, v237
    v_fma_f32 v241, v135, s20, v226
    s_waitcnt lgkmcnt(4)
    v_mfma_f32_32x32x16_bf16 v[48:63], v[212:215], v[180:183], v[48:63]
    ds_read_b64_tr_b16 v[208:209], v220 offset:320
    ds_read_b64_tr_b16 v[210:211], v220 offset:4672
    v_exp_f32 v240, v240
    v_add_f32 v232, v232, v238
    v_mfma_f32_32x32x16_bf16 a[48:63], v[212:215], v[196:199], a[48:63]
    v_fma_f32 v234, v136, s20, v226
    v_exp_f32 v241, v241
    s_waitcnt lgkmcnt(4)
    v_mfma_f32_32x32x16_bf16 v[64:79], v[200:203], v[176:179], v[64:79]
    ds_read_b64_tr_b16 v[212:213], v220 offset:9024
    ds_read_b64_tr_b16 v[214:215], v220 offset:13376
    v_add_f32 v233, v233, v239
    v_cvt_pk_bf16_f32 v186, v238, v239
    v_fma_f32 v235, v137, s20, v226
    v_mfma_f32_32x32x16_bf16 a[64:79], v[200:203], v[192:195], a[64:79]
    v_exp_f32 v234, v234
    v_add_f32 v232, v232, v240
    s_waitcnt lgkmcnt(4)
    v_mfma_f32_32x32x16_bf16 v[64:79], v[204:207], v[180:183], v[64:79]
    ds_read_b64_tr_b16 v[200:201], v221 offset:384
    ds_read_b64_tr_b16 v[202:203], v221 offset:4736
    v_fma_f32 v236, v138, s20, v226
    v_exp_f32 v235, v235
    v_mfma_f32_32x32x16_bf16 a[64:79], v[204:207], v[196:199], a[64:79]
    v_add_f32 v233, v233, v241
    v_cvt_pk_bf16_f32 v187, v240, v241
    v_fma_f32 v237, v139, s20, v226
    s_waitcnt lgkmcnt(4)
    v_mfma_f32_32x32x16_bf16 v[80:95], v[208:211], v[176:179], v[80:95]
    ds_read_b64_tr_b16 v[204:205], v221 offset:9088
    ds_read_b64_tr_b16 v[206:207], v221 offset:13440
    v_exp_f32 v236, v236
    v_add_f32 v232, v232, v234
    v_mfma_f32_32x32x16_bf16 a[80:95], v[208:211], v[192:195], a[80:95]
    v_fma_f32 v238, v140, s20, v226
    v_exp_f32 v237, v237
    v_add_u32 v219, s26, v216
    s_waitcnt lgkmcnt(4)
    v_mfma_f32_32x32x16_bf16 v[80:95], v[212:215], v[180:183], v[80:95]
    ds_read_b64_tr_b16 v[208:209], v221 offset:448
    ds_read_b64_tr_b16 v[210:211], v221 offset:4800
    v_add_f32 v233, v233, v235
    v_cvt_pk_bf16_f32 v188, v234, v235
    v_mfma_f32_32x32x16_bf16 a[80:95], v[212:215], v[196:199], a[80:95]
    v_fma_f32 v239, v141, s20, v226
    v_exp_f32 v238, v238
    s_add_u32 s26, s26, 16896
    s_cmp_ge_u32 s26, 67584
    s_cselect_b32 s26, 0, s26
    s_waitcnt lgkmcnt(4)
    v_mfma_f32_32x32x16_bf16 v[96:111], v[200:203], v[176:179], v[96:111]
    ds_read_b64_tr_b16 v[212:213], v221 offset:9152
    ds_read_b64_tr_b16 v[214:215], v221 offset:13504
    v_add_f32 v232, v232, v236
    v_fma_f32 v240, v142, s20, v226
    v_exp_f32 v239, v239
    v_mfma_f32_32x32x16_bf16 a[96:111], v[200:203], v[192:195], a[96:111]
    v_add_f32 v233, v233, v237
    v_cvt_pk_bf16_f32 v189, v236, v237
    s_waitcnt lgkmcnt(4)
    v_mfma_f32_32x32x16_bf16 v[96:111], v[204:207], v[180:183], v[96:111]
    ds_read_b128 v[200:203], v219 offset:0
    v_fma_f32 v241, v143, s20, v226
    v_exp_f32 v240, v240
    v_mfma_f32_32x32x16_bf16 a[96:111], v[204:207], v[196:199], a[96:111]
    v_add_f32 v232, v232, v238
    v_exp_f32 v241, v241
    s_waitcnt lgkmcnt(3)
    v_mfma_f32_32x32x16_bf16 v[112:127], v[208:211], v[176:179], v[112:127]
    ds_read_b128 v[204:207], v219 offset:32
    v_add_f32 v233, v233, v239
    v_cvt_pk_bf16_f32 v190, v238, v239
    v_add_f32 v232, v232, v240
    v_mfma_f32_32x32x16_bf16 a[112:127], v[208:211], v[192:195], a[112:127]
    v_add_f32 v233, v233, v241
    v_cvt_pk_bf16_f32 v191, v240, v241
    v_add_f32 v232, v232, v233
    s_waitcnt lgkmcnt(2)
    v_mfma_f32_32x32x16_bf16 v[112:127], v[212:215], v[180:183], v[112:127]
    ds_read_b128 v[208:211], v219 offset:64
    v_cmp_lt_f32 vcc, s40, v232
    s_cbranch_vccnz RARE_15
BACK_15:
    v_add_f32 v228, v228, v232
    v_mfma_f32_32x32x16_bf16 a[112:127], v[212:215], v[196:199], a[112:127]
    s_waitcnt lgkmcnt(2)
    v_mfma_f32_32x32x16_bf16 v[128:143], v[200:203], a[128:131], 0
    ds_read_b128 v[212:215], v219 offset:96
    s_add_u32 m0, s25, 0
    s_add_u32 s37, s41, 16384
    buffer_load_dwordx4 v224, s[4:7], s37 offen nt lds
    v_fma_f32 v234, v160, s20, v227
    v_mfma_f32_32x32x16_bf16 v[144:159], v[200:203], a[192:195], 0
    v_fma_f32 v235, v161, s20, v227
    v_exp_f32 v234, v234
    s_waitcnt lgkmcnt(2)
    v_mfma_f32_32x32x16_bf16 v[128:143], v[204:207], a[132:135], v[128:143]
    ds_read_b128 v[200:203], v219 offset:128
    v_fma_f32 v236, v162, s20, v227
    v_exp_f32 v235, v235
    v_mfma_f32_32x32x16_bf16 v[144:159], v[204:207], a[196:199], v[144:159]
    s_add_u32 m0, s25, 1024
    s_add_u32 s37, s41, 20480
    buffer_load_dwordx4 v225, s[4:7], s37 offen nt lds
    v_fma_f32 v237, v163, s20, v227
    s_waitcnt lgkmcnt(2)
    v_mfma_f32_32x32x16_bf16 v[128:143], v[208:211], a[136:139], v[128:143]
    ds_read_b128 v[204:207], v219 offset:160
    v_exp_f32 v236, v236
    v_mov_b32 v232, v234
    v_fma_f32 v238, v164, s20, v227
    v_mfma_f32_32x32x16_bf16 v[144:159], v[208:211], a[200:203], v[144:159]
    v_exp_f32 v237, v237
    s_add_u32 m0, s25, 2048
    s_add_u32 s37, s41, 24576
    s_waitcnt lgkmcnt(2)
    v_mfma_f32_32x32x16_bf16 v[128:143], v[212:215], a[140:143], v[128:143]
    ds_read_b128 v[208:211], v219 offset:192
    buffer_load_dwordx4 v224, s[4:7], s37 offen nt lds
    v_mov_b32 v233, v235
    v_cvt_pk_bf16_f32 v192, v234, v235
    v_mfma_f32_32x32x16_bf16 v[144:159], v[212:215], a[204:207], v[144:159]
    v_fma_f32 v239, v165, s20, v227
    v_exp_f32 v238, v238
    s_waitcnt lgkmcnt(2)
    v_mfma_f32_32x32x16_bf16 v[128:143], v[200:203], a[144:147], v[128:143]
    ds_read_b128 v[212:215], v219 offset:224
    v_add_f32 v232, v232, v236
    s_add_u32 m0, s25, 3072
    s_add_u32 s37, s41, 28672
    buffer_load_dwordx4 v225, s[4:7], s37 offen nt lds
    v_mfma_f32_32x32x16_bf16 v[144:159], v[200:203], a[208:211], v[144:159]
    v_fma_f32 v240, v166, s20, v227
    v_exp_f32 v239, v239
    s_waitcnt lgkmcnt(2)
    v_mfma_f32_32x32x16_bf16 v[128:143], v[204:207], a[148:151], v[128:143]
    ds_read_b128 v[200:203], v219 offset:256
    v_add_f32 v233, v233, v237
    v_cvt_pk_bf16_f32 v193, v236, v237
    v_fma_f32 v241, v167, s20, v227
    v_mfma_f32_32x32x16_bf16 v[144:159], v[204:207], a[212:215], v[144:159]
    s_add_u32 s25, s25, 17408
    s_cmp_ge_u32 s25, s34
    s_cselect_b32 s36, 87040, 0
    s_sub_u32 s25, s25, s36
    s_add_u32 m0, s24, 0
    s_add_u32 s37, s41, 128
    s_waitcnt lgkmcnt(2)
    v_mfma_f32_32x32x16_bf16 v[128:143], v[208:211], a[152:155], v[128:143]
    ds_read_b128 v[204:207], v219 offset:288
    buffer_load_dwordx4 v224, s[4:7], s37 offen nt lds
    v_exp_f32 v240, v240
    v_mfma_f32_32x32x16_bf16 v[144:159], v[208:211], a[216:219], v[144:159]
    v_add_f32 v232, v232, v238
    v_fma_f32 v234, v168, s20, v227
    v_exp_f32 v241, v241
    s_waitcnt lgkmcnt(2)
    v_mfma_f32_32x32x16_bf16 v[128:143], v[212:215], a[156:159], v[128:143]
    ds_read_b128 v[208:211], v219 offset:320
    v_add_f32 v233, v233, v239
    s_add_u32 m0, s24, 1024
    s_add_u32 s37, s41, 4224
    buffer_load_dwordx4 v225, s[4:7], s37 offen nt lds
    v_mfma_f32_32x32x16_bf16 v[144:159], v[212:215], a[220:223], v[144:159]
    v_cvt_pk_bf16_f32 v194, v238, v239
    v_fma_f32 v235, v169, s20, v227
    s_waitcnt lgkmcnt(2)
    v_mfma_f32_32x32x16_bf16 v[128:143], v[200:203], a[160:163], v[128:143]
    ds_read_b128 v[212:215], v219 offset:352
    v_exp_f32 v234, v234
    v_add_f32 v232, v232, v240
    v_fma_f32 v236, v170, s20, v227
    v_mfma_f32_32x32x16_bf16 v[144:159], v[200:203], a[224:227], v[144:159]
    s_add_u32 m0, s24, 2048
    s_add_u32 s37, s41, 8320
    buffer_load_dwordx4 v224, s[4:7], s37 offen nt lds
    s_waitcnt lgkmcnt(2)
    v_mfma_f32_32x32x16_bf16 v[128:143], v[204:207], a[164:167], v[128:143]
    ds_read_b128 v[200:203], v219 offset:384
    v_exp_f32 v235, v235
    v_add_f32 v233, v233, v241
    v_cvt_pk_bf16_f32 v195, v240, v241
    v_mfma_f32_32x32x16_bf16 v[144:159], v[204:207], a[228:231], v[144:159]
    v_fma_f32 v237, v171, s20, v227
    v_exp_f32 v236, v236
    s_add_u32 m0, s24, 3072
    s_add_u32 s37, s41, 12416
    s_waitcnt lgkmcnt(2)
    v_mfma_f32_32x32x16_bf16 v[128:143], v[208:211], a[168:171], v[128:143]
    ds_read_b128 v[204:207], v219 offset:416
    buffer_load_dwordx4 v225, s[4:7], s37 offen nt lds
    v_add_f32 v232, v232, v234
    v_add_u32 v220, s27, v217
    v_mfma_f32_32x32x16_bf16 v[144:159], v[208:211], a[232:235], v[144:159]
    v_fma_f32 v238, v172, s20, v227
    v_exp_f32 v237, v237
    v_add_f32 v233, v233, v235
    v_add_u32 v221, s27, v218
    s_waitcnt lgkmcnt(2)
    v_mfma_f32_32x32x16_bf16 v[128:143], v[212:215], a[172:175], v[128:143]
    ds_read_b128 v[208:211], v219 offset:448
    v_cvt_pk_bf16_f32 v196, v234, v235
    s_add_u32 s24, s24, 16896
    s_cmp_ge_u32 s24, s33
    s_cselect_b32 s36, 67584, 0
    s_sub_u32 s24, s24, s36
    v_mfma_f32_32x32x16_bf16 v[144:159], v[212:215], a[236:239], v[144:159]
    v_fma_f32 v239, v173, s20, v227
    v_exp_f32 v238, v238
    s_add_u32 s27, s27, 17408
    s_cmp_ge_u32 s27, 154624
    s_cselect_b32 s27, 67584, s27
    s_waitcnt lgkmcnt(2)
    v_mfma_f32_32x32x16_bf16 v[128:143], v[200:203], a[176:179], v[128:143]
    ds_read_b128 v[212:215], v219 offset:480
    v_add_f32 v232, v232, v236
    v_fma_f32 v240, v174, s20, v227
    v_exp_f32 v239, v239
    v_mfma_f32_32x32x16_bf16 v[144:159], v[200:203], a[240:243], v[144:159]
    v_add_f32 v233, v233, v237
    v_cvt_pk_bf16_f32 v197, v236, v237
    v_fma_f32 v241, v175, s20, v227
    s_waitcnt lgkmcnt(2)
    v_mfma_f32_32x32x16_bf16 v[128:143], v[204:207], a[180:183], v[128:143]
    ds_read_b64_tr_b16 v[200:201], v220 offset:0
    ds_read_b64_tr_b16 v[202:203], v220 offset:4352
    v_exp_f32 v240, v240
    v_add_f32 v232, v232, v238
    v_mfma_f32_32x32x16_bf16 v[144:159], v[204:207], a[244:247], v[144:159]
    v_exp_f32 v241, v241
    v_add_f32 v233, v233, v239
    v_cvt_pk_bf16_f32 v198, v238, v239
    s_waitcnt lgkmcnt(3)
    v_mfma_f32_32x32x16_bf16 v[128:143], v[208:211], a[184:187], v[128:143]
    ds_read_b64_tr_b16 v[204:205], v220 offset:8704
    ds_read_b64_tr_b16 v[206:207], v220 offset:13056
    v_add_f32 v232, v232, v240
    v_add_f32 v233, v233, v241
    v_cvt_pk_bf16_f32 v199, v240, v241
    v_mfma_f32_32x32x16_bf16 v[144:159], v[208:211], a[248:251], v[144:159]
    v_add_f32 v232, v232, v233
    v_cmp_lt_f32 vcc, s40, v232
    s_cbranch_vccnz RARE_16
BACK_16:
    v_add_f32 v229, v229, v232
    s_waitcnt lgkmcnt(4)
    v_mfma_f32_32x32x16_bf16 v[128:143], v[212:215], a[188:191], v[128:143]
    ds_read_b64_tr_b16 v[208:209], v220 offset:64
    ds_read_b64_tr_b16 v[210:211], v220 offset:4416
    v_mfma_f32_32x32x16_bf16 v[144:159], v[212:215], a[252:255], v[144:159]
    s_cmp_lg_u32 s30, 0
    s_cbranch_scc1 RESC_17
RBACK_17:
    s_waitcnt lgkmcnt(4)
    v_mfma_f32_32x32x16_bf16 v[0:15], v[200:203], v[184:187], v[0:15]
    ds_read_b64_tr_b16 v[212:213], v220 offset:8768
    ds_read_b64_tr_b16 v[214:215], v220 offset:13120
    v_mfma_f32_32x32x16_bf16 a[0:15], v[200:203], v[192:195], a[0:15]
    s_waitcnt vmcnt(16)
    s_barrier
    s_waitcnt lgkmcnt(4)
    v_mfma_f32_32x32x16_bf16 v[0:15], v[204:207], v[188:191], v[0:15]
    ds_read_b64_tr_b16 v[200:201], v221 offset:128
    ds_read_b64_tr_b16 v[202:203], v221 offset:4480
    v_mfma_f32_32x32x16_bf16 a[0:15], v[204:207], v[196:199], a[0:15]
    s_waitcnt lgkmcnt(4)
    v_mfma_f32_32x32x16_bf16 v[16:31], v[208:211], v[184:187], v[16:31]
    ds_read_b64_tr_b16 v[204:205], v221 offset:8832
    ds_read_b64_tr_b16 v[206:207], v221 offset:13184
    v_mfma_f32_32x32x16_bf16 a[16:31], v[208:211], v[192:195], a[16:31]
    v_fma_f32 v234, v128, s20, v226
    v_fma_f32 v235, v129, s20, v226
    s_waitcnt lgkmcnt(4)
    v_mfma_f32_32x32x16_bf16 v[16:31], v[212:215], v[188:191], v[16:31]
    ds_read_b64_tr_b16 v[208:209], v221 offset:192
    ds_read_b64_tr_b16 v[210:211], v221 offset:4544
    v_exp_f32 v234, v234
    v_fma_f32 v236, v130, s20, v226
    v_mfma_f32_32x32x16_bf16 a[16:31], v[212:215], v[196:199], a[16:31]
    v_exp_f32 v235, v235
    v_fma_f32 v237, v131, s20, v226
    s_waitcnt lgkmcnt(4)
    v_mfma_f32_32x32x16_bf16 v[32:47], v[200:203], v[184:187], v[32:47]
    ds_read_b64_tr_b16 v[212:213], v221 offset:8896
    ds_read_b64_tr_b16 v[214:215], v221 offset:13248
    v_exp_f32 v236, v236
    v_mov_b32 v232, v234
    v_fma_f32 v238, v132, s20, v226
    v_mfma_f32_32x32x16_bf16 a[32:47], v[200:203], v[192:195], a[32:47]
    v_exp_f32 v237, v237
    v_mov_b32 v233, v235
    s_waitcnt lgkmcnt(4)
    v_mfma_f32_32x32x16_bf16 v[32:47], v[204:207], v[188:191], v[32:47]
    ds_read_b64_tr_b16 v[200:201], v220 offset:256
    ds_read_b64_tr_b16 v[202:203], v220 offset:4608
    v_cvt_pk_bf16_f32 v176, v234, v235
    v_fma_f32 v239, v133, s20, v226
    v_mfma_f32_32x32x16_bf16 a[32:47], v[204:207], v[196:199], a[32:47]
    v_exp_f32 v238, v238
    v_add_f32 v232, v232, v236
    s_waitcnt lgkmcnt(4)
    v_mfma_f32_32x32x16_bf16 v[48:63], v[208:211], v[184:187], v[48:63]
    ds_read_b64_tr_b16 v[204:205], v220 offset:8960
    ds_read_b64_tr_b16 v[206:207], v220 offset:13312
    v_fma_f32 v240, v134, s20, v226
    v_exp_f32 v239, v239
    v_mfma_f32_32x32x16_bf16 a[48:63], v[208:211], v[192:195], a[48:63]
    v_add_f32 v233, v233, v237
    v_cvt_pk_bf16_f32 v177, v236, v237
    v_fma_f32 v241, v135, s20, v226
    s_waitcnt lgkmcnt(4)
    v_mfma_f32_32x32x16_bf16 v[48:63], v[212:215], v[188:191], v[48:63]
    ds_read_b64_tr_b16 v[208:209], v220 offset:320
    ds_read_b64_tr_b16 v[210:211], v220 offset:4672
    v_exp_f32 v240, v240
    v_add_f32 v232, v232, v238
    v_mfma_f32_32x32x16_bf16 a[48:63], v[212:215], v[196:199], a[48:63]
    v_fma_f32 v234, v136, s20, v226
    v_exp_f32 v241, v241
    s_waitcnt lgkmcnt(4)
    v_mfma_f32_32x32x16_bf16 v[64:79], v[200:203], v[184:187], v[64:79]
    ds_read_b64_tr_b16 v[212:213], v220 offset:9024
    ds_read_b64_tr_b16 v[214:215], v220 offset:13376
    v_add_f32 v233, v233, v239
    v_cvt_pk_bf16_f32 v178, v238, v239
    v_fma_f32 v235, v137, s20, v226
    v_mfma_f32_32x32x16_bf16 a[64:79], v[200:203], v[192:195], a[64:79]
    v_exp_f32 v234, v234
    v_add_f32 v232, v232, v240
    s_waitcnt lgkmcnt(4)
    v_mfma_f32_32x32x16_bf16 v[64:79], v[204:207], v[188:191], v[64:79]
    ds_read_b64_tr_b16 v[200:201], v221 offset:384
    ds_read_b64_tr_b16 v[202:203], v221 offset:4736
    v_fma_f32 v236, v138, s20, v226
    v_exp_f32 v235, v235
    v_mfma_f32_32x32x16_bf16 a[64:79], v[204:207], v[196:199], a[64:79]
    v_add_f32 v233, v233, v241
    v_cvt_pk_bf16_f32 v179, v240, v241
    v_fma_f32 v237, v139, s20, v226
    s_waitcnt lgkmcnt(4)
    v_mfma_f32_32x32x16_bf16 v[80:95], v[208:211], v[184:187], v[80:95]
    ds_read_b64_tr_b16 v[204:205], v221 offset:9088
    ds_read_b64_tr_b16 v[206:207], v221 offset:13440
    v_exp_f32 v236, v236
    v_add_f32 v232, v232, v234
    v_mfma_f32_32x32x16_bf16 a[80:95], v[208:211], v[192:195], a[80:95]
    v_fma_f32 v238, v140, s20, v226
    v_exp_f32 v237, v237
    v_add_u32 v219, s26, v216
    s_waitcnt lgkmcnt(4)
    v_mfma_f32_32x32x16_bf16 v[80:95], v[212:215], v[188:191], v[80:95]
    ds_read_b64_tr_b16 v[208:209], v221 offset:448
    ds_read_b64_tr_b16 v[210:211], v221 offset:4800
    v_add_f32 v233, v233, v235
    v_cvt_pk_bf16_f32 v180, v234, v235
    v_mfma_f32_32x32x16_bf16 a[80:95], v[212:215], v[196:199], a[80:95]
    v_fma_f32 v239, v141, s20, v226
    v_exp_f32 v238, v238
    s_add_u32 s26, s26, 16896
    s_cmp_ge_u32 s26, 67584
    s_cselect_b32 s26, 0, s26
    s_waitcnt lgkmcnt(4)
    v_mfma_f32_32x32x16_bf16 v[96:111], v[200:203], v[184:187], v[96:111]
    ds_read_b64_tr_b16 v[212:213], v221 offset:9152
    ds_read_b64_tr_b16 v[214:215], v221 offset:13504
    v_add_f32 v232, v232, v236
    v_fma_f32 v240, v142, s20, v226
    v_exp_f32 v239, v239
    v_mfma_f32_32x32x16_bf16 a[96:111], v[200:203], v[192:195], a[96:111]
    v_add_f32 v233, v233, v237
    v_cvt_pk_bf16_f32 v181, v236, v237
    s_waitcnt lgkmcnt(4)
    v_mfma_f32_32x32x16_bf16 v[96:111], v[204:207], v[188:191], v[96:111]
    ds_read_b128 v[200:203], v219 offset:0
    v_fma_f32 v241, v143, s20, v226
    v_exp_f32 v240, v240
    v_mfma_f32_32x32x16_bf16 a[96:111], v[204:207], v[196:199], a[96:111]
    v_add_f32 v232, v232, v238
    v_exp_f32 v241, v241
    s_waitcnt lgkmcnt(3)
    v_mfma_f32_32x32x16_bf16 v[112:127], v[208:211], v[184:187], v[112:127]
    ds_read_b128 v[204:207], v219 offset:32
    v_add_f32 v233, v233, v239
    v_cvt_pk_bf16_f32 v182, v238, v239
    v_add_f32 v232, v232, v240
    v_mfma_f32_32x32x16_bf16 a[112:127], v[208:211], v[192:195], a[112:127]
    v_add_f32 v233, v233, v241
    v_cvt_pk_bf16_f32 v183, v240, v241
    v_add_f32 v232, v232, v233
    s_waitcnt lgkmcnt(2)
    v_mfma_f32_32x32x16_bf16 v[112:127], v[212:215], v[188:191], v[112:127]
    ds_read_b128 v[208:211], v219 offset:64
    v_cmp_lt_f32 vcc, s40, v232
    s_cbranch_vccnz RARE_18
BACK_18:
    v_add_f32 v228, v228, v232
    v_mfma_f32_32x32x16_bf16 a[112:127], v[212:215], v[196:199], a[112:127]
    s_waitcnt lgkmcnt(2)
    v_mfma_f32_32x32x16_bf16 v[128:143], v[200:203], a[128:131], 0
    ds_read_b128 v[212:215], v219 offset:96
    s_add_u32 m0, s25, 0
    s_add_u32 s37, s41, 16512
    buffer_load_dwordx4 v224, s[4:7], s37 offen nt lds
    v_fma_f32 v234, v144, s20, v227
    v_mfma_f32_32x32x16_bf16 v[160:175], v[200:203], a[192:195], 0
    v_fma_f32 v235, v145, s20, v227
    v_exp_f32 v234, v234
    s_waitcnt lgkmcnt(2)
    v_mfma_f32_32x32x16_bf16 v[128:143], v[204:207], a[132:135], v[128:143]
    ds_read_b128 v[200:203], v219 offset:128
    v_fma_f32 v236, v146, s20, v227
    v_exp_f32 v235, v235
    v_mfma_f32_32x32x16_bf16 v[160:175], v[204:207], a[196:199], v[160:175]
    s_add_u32 m0, s25, 1024
    s_add_u32 s37, s41, 20608
    buffer_load_dwordx4 v225, s[4:7], s37 offen nt lds
    v_fma_f32 v237, v147, s20, v227
    s_waitcnt lgkmcnt(2)
    v_mfma_f32_32x32x16_bf16 v[128:143], v[208:211], a[136:139], v[128:143]
    ds_read_b128 v[204:207], v219 offset:160
    v_exp_f32 v236, v236
    v_mov_b32 v232, v234
    v_fma_f32 v238, v148, s20, v227
    v_mfma_f32_32x32x16_bf16 v[160:175], v[208:211], a[200:203], v[160:175]
    v_exp_f32 v237, v237
    s_add_u32 m0, s25, 2048
    s_add_u32 s37, s41, 24704
    s_waitcnt lgkmcnt(2)
    v_mfma_f32_32x32x16_bf16 v[128:143], v[212:215], a[140:143], v[128:143]
    ds_read_b128 v[208:211], v219 offset:192
    buffer_load_dwordx4 v224, s[4:7], s37 offen nt lds
    v_mov_b32 v233, v235
    v_cvt_pk_bf16_f32 v192, v234, v235
    v_mfma_f32_32x32x16_bf16 v[160:175], v[212:215], a[204:207], v[160:175]
    v_fma_f32 v239, v149, s20, v227
    v_exp_f32 v238, v238
    s_waitcnt lgkmcnt(2)
    v_mfma_f32_32x32x16_bf16 v[128:143], v[200:203], a[144:147], v[128:143]
    ds_read_b128 v[212:215], v219 offset:224
    v_add_f32 v232, v232, v236
    s_add_u32 m0, s25, 3072
    s_add_u32 s37, s41, 28800
    buffer_load_dwordx4 v225, s[4:7], s37 offen nt lds
    v_mfma_f32_32x32x16_bf16 v[160:175], v[200:203], a[208:211], v[160:175]
    v_fma_f32 v240, v150, s20, v227
    v_exp_f32 v239, v239
    s_waitcnt lgkmcnt(2)
    v_mfma_f32_32x32x16_bf16 v[128:143], v[204:207], a[148:151], v[128:143]
    ds_read_b128 v[200:203], v219 offset:256
    v_add_f32 v233, v233, v237
    v_cvt_pk_bf16_f32 v193, v236, v237
    v_fma_f32 v241, v151, s20, v227
    v_mfma_f32_32x32x16_bf16 v[160:175], v[204:207], a[212:215], v[160:175]
    s_add_u32 s25, s25, 17408
    s_cmp_ge_u32 s25, s34
    s_cselect_b32 s36, 87040, 0
    s_sub_u32 s25, s25, s36
    s_add_u32 m0, s24, 0
    s_add_u32 s37, s41, 256
    s_waitcnt lgkmcnt(2)
    v_mfma_f32_32x32x16_bf16 v[128:143], v[208:211], a[152:155], v[128:143]
    ds_read_b128 v[204:207], v219 offset:288
    buffer_load_dwordx4 v224, s[4:7], s37 offen nt lds
    v_exp_f32 v240, v240
    v_mfma_f32_32x32x16_bf16 v[160:175], v[208:211], a[216:219], v[160:175]
    v_add_f32 v232, v232, v238
    v_fma_f32 v234, v152, s20, v227
    v_exp_f32 v241, v241
    s_waitcnt lgkmcnt(2)
    v_mfma_f32_32x32x16_bf16 v[128:143], v[212:215], a[156:159], v[128:143]
    ds_read_b128 v[208:211], v219 offset:320
    v_add_f32 v233, v233, v239
    s_add_u32 m0, s24, 1024
    s_add_u32 s37, s41, 4352
    buffer_load_dwordx4 v225, s[4:7], s37 offen nt lds
    v_mfma_f32_32x32x16_bf16 v[160:175], v[212:215], a[220:223], v[160:175]
    v_cvt_pk_bf16_f32 v194, v238, v239
    v_fma_f32 v235, v153, s20, v227
    s_waitcnt lgkmcnt(2)
    v_mfma_f32_32x32x16_bf16 v[128:143], v[200:203], a[160:163], v[128:143]
    ds_read_b128 v[212:215], v219 offset:352
    v_exp_f32 v234, v234
    v_add_f32 v232, v232, v240
    v_fma_f32 v236, v154, s20, v227
    v_mfma_f32_32x32x16_bf16 v[160:175], v[200:203], a[224:227], v[160:175]
    s_add_u32 m0, s24, 2048
    s_add_u32 s37, s41, 8448
    buffer_load_dwordx4 v224, s[4:7], s37 offen nt lds
    s_waitcnt lgkmcnt(2)
    v_mfma_f32_32x32x16_bf16 v[128:143], v[204:207], a[164:167], v[128:143]
    ds_read_b128 v[200:203], v219 offset:384
    v_exp_f32 v235, v235
    v_add_f32 v233, v233, v241
    v_cvt_pk_bf16_f32 v195, v240, v241
    v_mfma_f32_32x32x16_bf16 v[160:175], v[204:207], a[228:231], v[160:175]
    v_fma_f32 v237, v155, s20, v227
    v_exp_f32 v236, v236
    s_add_u32 m0, s24, 3072
    s_add_u32 s37, s41, 12544
    s_waitcnt lgkmcnt(2)
    v_mfma_f32_32x32x16_bf16 v[128:143], v[208:211], a[168:171], v[128:143]
    ds_read_b128 v[204:207], v219 offset:416
    buffer_load_dwordx4 v225, s[4:7], s37 offen nt lds
    v_add_f32 v232, v232, v234
    v_add_u32 v220, s27, v217
    v_mfma_f32_32x32x16_bf16 v[160:175], v[208:211], a[232:235], v[160:175]
    v_fma_f32 v238, v156, s20, v227
    v_exp_f32 v237, v237
    v_add_f32 v233, v233, v235
    v_add_u32 v221, s27, v218
    s_waitcnt lgkmcnt(2)
    v_mfma_f32_32x32x16_bf16 v[128:143], v[212:215], a[172:175], v[128:143]
    ds_read_b128 v[208:211], v219 offset:448
    v_cvt_pk_bf16_f32 v196, v234, v235
    s_add_u32 s24, s24, 16896
    s_cmp_ge_u32 s24, s33
    s_cselect_b32 s36, 67584, 0
    s_sub_u32 s24, s24, s36
    v_mfma_f32_32x32x16_bf16 v[160:175], v[212:215], a[236:239], v[160:175]
    v_fma_f32 v239, v157, s20, v227
    v_exp_f32 v238, v238
    s_add_u32 s27, s27, 17408
    s_cmp_ge_u32 s27, 154624
    s_cselect_b32 s27, 67584, s27
    s_waitcnt lgkmcnt(2)
    v_mfma_f32_32x32x16_bf16 v[128:143], v[200:203], a[176:179], v[128:143]
    ds_read_b128 v[212:215], v219 offset:480
    v_add_f32 v232, v232, v236
    v_fma_f32 v240, v158, s20, v227
    v_exp_f32 v239, v239
    v_mfma_f32_32x32x16_bf16 v[160:175], v[200:203], a[240:243], v[160:175]
    v_add_f32 v233, v233, v237
    v_cvt_pk_bf16_f32 v197, v236, v237
    v_fma_f32 v241, v159, s20, v227
    s_waitcnt lgkmcnt(2)
    v_mfma_f32_32x32x16_bf16 v[128:143], v[204:207], a[180:183], v[128:143]
    ds_read_b64_tr_b16 v[200:201], v220 offset:0
    ds_read_b64_tr_b16 v[202:203], v220 offset:4352
    v_exp_f32 v240, v240
    v_add_f32 v232, v232, v238
    v_mfma_f32_32x32x16_bf16 v[160:175], v[204:207], a[244:247], v[160:175]
    v_exp_f32 v241, v241
    v_add_f32 v233, v233, v239
    v_cvt_pk_bf16_f32 v198, v238, v239
    s_waitcnt lgkmcnt(3)
    v_mfma_f32_32x32x16_bf16 v[128:143], v[208:211], a[184:187], v[128:143]
    ds_read_b64_tr_b16 v[204:205], v220 offset:8704
    ds_read_b64_tr_b16 v[206:207], v220 offset:13056
    v_add_f32 v232, v232, v240
    v_add_f32 v233, v233, v241
    v_cvt_pk_bf16_f32 v199, v240, v241
    v_mfma_f32_32x32x16_bf16 v[160:175], v[208:211], a[248:251], v[160:175]
    v_add_f32 v232, v232, v233
    v_cmp_lt_f32 vcc, s40, v232
    s_cbranch_vccnz RARE_19
BACK_19:
    v_add_f32 v229, v229, v232
    s_waitcnt lgkmcnt(4)
    v_mfma_f32_32x32x16_bf16 v[128:143], v[212:215], a[188:191], v[128:143]
    ds_read_b64_tr_b16 v[208:209], v220 offset:64
    ds_read_b64_tr_b16 v[210:211], v220 offset:4416
    v_mfma_f32_32x32x16_bf16 v[160:175], v[212:215], a[252:255], v[160:175]
    s_cmp_eq_u32 s29, 1
    s_cbranch_scc1 LAST_TAIL
    s_cmp_lg_u32 s30, 0
    s_cbranch_scc1 RESC_20
RBACK_20:
    s_waitcnt lgkmcnt(4)
    v_mfma_f32_32x32x16_bf16 v[0:15], v[200:203], v[176:179], v[0:15]
    ds_read_b64_tr_b16 v[212:213], v220 offset:8768
    ds_read_b64_tr_b16 v[214:215], v220 offset:13120
    v_mfma_f32_32x32x16_bf16 a[0:15], v[200:203], v[192:195], a[0:15]
    s_waitcnt vmcnt(16)
    s_barrier
    s_waitcnt lgkmcnt(4)
    v_mfma_f32_32x32x16_bf16 v[0:15], v[204:207], v[180:183], v[0:15]
    ds_read_b64_tr_b16 v[200:201], v221 offset:128
    ds_read_b64_tr_b16 v[202:203], v221 offset:4480
    s_add_u32 m0, s25, 0
    s_add_u32 s37, s41, 16640
    buffer_load_dwordx4 v224, s[4:7], s37 offen nt lds
    v_mfma_f32_32x32x16_bf16 a[0:15], v[204:207], v[196:199], a[0:15]
    s_add_u32 m0, s25, 1024
    s_add_u32 s37, s41, 20736
    buffer_load_dwordx4 v225, s[4:7], s37 offen nt lds
    s_waitcnt lgkmcnt(4)
    v_mfma_f32_32x32x16_bf16 v[16:31], v[208:211], v[176:179], v[16:31]
    ds_read_b64_tr_b16 v[204:205], v221 offset:8832
    ds_read_b64_tr_b16 v[206:207], v221 offset:13184
    s_add_u32 m0, s25, 2048
    s_add_u32 s37, s41, 24832
    buffer_load_dwordx4 v224, s[4:7], s37 offen nt lds
    s_add_u32 m0, s25, 3072
    s_add_u32 s37, s41, 28928
    v_mfma_f32_32x32x16_bf16 a[16:31], v[208:211], v[192:195], a[16:31]
    v_fma_f32 v234, v128, s20, v226
    v_fma_f32 v235, v129, s20, v226
    buffer_load_dwordx4 v225, s[4:7], s37 offen nt lds
    s_waitcnt lgkmcnt(4)
    v_mfma_f32_32x32x16_bf16 v[16:31], v[212:215], v[180:183], v[16:31]
    ds_read_b64_tr_b16 v[208:209], v221 offset:192
    ds_read_b64_tr_b16 v[210:211], v221 offset:4544
    v_exp_f32 v234, v234
    v_fma_f32 v236, v130, s20, v226
    s_add_u32 s25, s25, 17408
    s_cmp_ge_u32 s25, s34
    s_cselect_b32 s36, 87040, 0
    s_sub_u32 s25, s25, s36
    s_add_u32 m0, s24, 0
    s_add_u32 s37, s41, 384
    v_mfma_f32_32x32x16_bf16 a[16:31], v[212:215], v[196:199], a[16:31]
    v_exp_f32 v235, v235
    v_fma_f32 v237, v131, s20, v226
    buffer_load_dwordx4 v224, s[4:7], s37 offen nt lds
    s_add_u32 m0, s24, 1024
    s_add_u32 s37, s41, 4480
    s_waitcnt lgkmcnt(4)
    v_mfma_f32_32x32x16_bf16 v[32:47], v[200:203], v[176:179], v[32:47]
    ds_read_b64_tr_b16 v[212:213], v221 offset:8896
    ds_read_b64_tr_b16 v[214:215], v221 offset:13248
    v_exp_f32 v236, v236
    v_mov_b32 v232, v234
    v_fma_f32 v238, v132, s20, v226
    buffer_load_dwordx4 v225, s[4:7], s37 offen nt lds
    s_add_u32 m0, s24, 2048
    s_add_u32 s37, s41, 8576
    v_mfma_f32_32x32x16_bf16 a[32:47], v[200:203], v[192:195], a[32:47]
    v_exp_f32 v237, v237
    v_mov_b32 v233, v235
    buffer_load_dwordx4 v224, s[4:7], s37 offen nt lds
    s_add_u32 m0, s24, 3072
    s_add_u32 s37, s41, 12672
    buffer_load_dwordx4 v225, s[4:7], s37 offen nt lds
    s_waitcnt lgkmcnt(4)
    v_mfma_f32_32x32x16_bf16 v[32:47], v[204:207], v[180:183], v[32:47]
    ds_read_b64_tr_b16 v[200:201], v220 offset:256
    ds_read_b64_tr_b16 v[202:203], v220 offset:4608
    v_cvt_pk_bf16_f32 v184, v234, v235
    v_fma_f32 v239, v133, s20, v226
    s_add_u32 s24, s24, 16896
    s_cmp_ge_u32 s24, s33
    s_cselect_b32 s36, 67584, 0
    s_sub_u32 s24, s24, s36
    v_mfma_f32_32x32x16_bf16 a[32:47], v[204:207], v[196:199], a[32:47]
    v_exp_f32 v238, v238
    v_add_f32 v232, v232, v236
    s_waitcnt vmcnt(16)
    s_add_u32 s38, s52, 0
    v_xor_b32 v248, 0, v250
    v_add_u32 v248, s38, v248
    ds_read_b128 a[128:131], v248
    s_waitcnt lgkmcnt(5)
    v_mfma_f32_32x32x16_bf16 v[48:63], v[208:211], v[176:179], v[48:63]
    ds_read_b64_tr_b16 v[204:205], v220 offset:8960
    ds_read_b64_tr_b16 v[206:207], v220 offset:13312
    v_fma_f32 v240, v134, s20, v226
    v_exp_f32 v239, v239
    v_xor_b32 v249, 32, v250
    v_add_u32 v249, s38, v249
    ds_read_b128 a[132:135], v249
    v_xor_b32 v251, 64, v250
    v_add_u32 v251, s38, v251
    v_mfma_f32_32x32x16_bf16 a[48:63], v[208:211], v[192:195], a[48:63]
    v_add_f32 v233, v233, v237
    v_cvt_pk_bf16_f32 v185, v236, v237
    v_fma_f32 v241, v135, s20, v226
    ds_read_b128 a[136:139], v251
    v_xor_b32 v252, 96, v250
    v_add_u32 v252, s38, v252
    s_waitcnt lgkmcnt(7)
    v_mfma_f32_32x32x16_bf16 v[48:63], v[212:215], v[180:183], v[48:63]
    ds_read_b64_tr_b16 v[208:209], v220 offset:320
    ds_read_b64_tr_b16 v[210:211], v220 offset:4672
    v_exp_f32 v240, v240
    v_add_f32 v232, v232, v238
    ds_read_b128 a[140:143], v252
    s_add_u32 s38, s53, 84992
    v_xor_b32 v248, 0, v250
    v_add_u32 v248, s38, v248
    ds_read_b128 a[192:195], v248
    v_mfma_f32_32x32x16_bf16 a[48:63], v[212:215], v[196:199], a[48:63]
    v_fma_f32 v234, v136, s20, v226
    v_exp_f32 v241, v241
    v_xor_b32 v249, 32, v250
    v_add_u32 v249, s38, v249
    ds_read_b128 a[196:199], v249
    v_xor_b32 v251, 64, v250
    v_add_u32 v251, s38, v251
    s_waitcnt lgkmcnt(10)
    v_mfma_f32_32x32x16_bf16 v[64:79], v[200:203], v[176:179], v[64:79]
    ds_read_b64_tr_b16 v[212:213], v220 offset:9024
    ds_read_b64_tr_b16 v[214:215], v220 offset:13376
    v_add_f32 v233, v233, v239
    v_cvt_pk_bf16_f32 v186, v238, v239
    v_fma_f32 v235, v137, s20, v226
    ds_read_b128 a[200:203], v251
    v_xor_b32 v252, 96, v250
    v_add_u32 v252, s38, v252
    ds_read_b128 a[204:207], v252
    v_mfma_f32_32x32x16_bf16 a[64:79], v[200:203], v[192:195], a[64:79]
    v_exp_f32 v234, v234
    v_add_f32 v232, v232, v240
    s_add_u32 s38, s52, 16896
    v_xor_b32 v248, 0, v250
    v_add_u32 v248, s38, v248
    ds_read_b128 a[144:147], v248
    s_waitcnt lgkmcnt(12)
    v_mfma_f32_32x32x16_bf16 v[64:79], v[204:207], v[180:183], v[64:79]
    ds_read_b64_tr_b16 v[200:201], v221 offset:384
    ds_read_b64_tr_b16 v[202:203], v221 offset:4736
    v_fma_f32 v236, v138, s20, v226
    v_exp_f32 v235, v235
    v_xor_b32 v249, 32, v250
    v_add_u32 v249, s38, v249
    ds_read_b128 a[148:151], v249
    v_xor_b32 v251, 64, v250
    v_add_u32 v251, s38, v251
    v_mfma_f32_32x32x16_bf16 a[64:79], v[204:207], v[196:199], a[64:79]
    v_add_f32 v233, v233, v241
    v_cvt_pk_bf16_f32 v187, v240, v241
    v_fma_f32 v237, v139, s20, v226
    ds_read_b128 a[152:155], v251
    v_xor_b32 v252, 96, v250
    v_add_u32 v252, s38, v252
    ds_read_b128 a[156:159], v252
    s_waitcnt lgkmcnt(13)
    v_mfma_f32_32x32x16_bf16 v[80:95], v[208:211], v[176:179], v[80:95]
    ds_read_b64_tr_b16 v[204:205], v221 offset:9088
    ds_read_b64_tr_b16 v[206:207], v221 offset:13440
    v_exp_f32 v236, v236
    v_add_f32 v232, v232, v234
    v_mfma_f32_32x32x16_bf16 a[80:95], v[208:211], v[192:195], a[80:95]
    v_fma_f32 v238, v140, s20, v226
    v_exp_f32 v237, v237
    s_waitcnt lgkmcnt(2)
    s_add_u32 m0, s24, 0
    v_mfma_f32_32x32x16_bf16 v[80:95], v[212:215], v[180:183], v[80:95]
    ds_read_b64_tr_b16 v[208:209], v221 offset:448
    ds_read_b64_tr_b16 v[210:211], v221 offset:4800
    v_add_f32 v233, v233, v235
    v_cvt_pk_bf16_f32 v188, v234, v235
    s_nop 0
    v_mfma_f32_32x32x16_bf16 a[80:95], v[212:215], v[196:199], a[80:95]
    v_fma_f32 v239, v141, s20, v226
    v_exp_f32 v238, v238
    buffer_load_dwordx4 v222, s[8:11], s22 offen offset:0 nt lds
    s_add_u32 m0, s24, 32
    v_mfma_f32_32x32x16_bf16 v[96:111], v[200:203], v[176:179], v[96:111]
    ds_read_b64_tr_b16 v[212:213], v221 offset:9152
    ds_read_b64_tr_b16 v[214:215], v221 offset:13504
    v_add_f32 v232, v232, v236
    v_fma_f32 v240, v142, s20, v226
    v_exp_f32 v239, v239
    s_nop 0
    v_add_u32 v220, s27, v217
    v_add_u32 v221, s27, v218
    s_add_u32 s27, s27, 17408
    s_cmp_ge_u32 s27, 154624
    s_cselect_b32 s27, 67584, s27
    v_mfma_f32_32x32x16_bf16 a[96:111], v[200:203], v[192:195], a[96:111]
    v_add_f32 v233, v233, v237
    v_cvt_pk_bf16_f32 v189, v236, v237
    buffer_load_dwordx4 v222, s[8:11], s22 offen offset:1024 nt lds
    s_waitcnt lgkmcnt(4)
    v_mfma_f32_32x32x16_bf16 v[96:111], v[204:207], v[180:183], v[96:111]
    ds_read_b64_tr_b16 v[200:201], v220 offset:0
    ds_read_b64_tr_b16 v[202:203], v220 offset:4352
    v_fma_f32 v241, v143, s20, v226
    v_exp_f32 v240, v240
    s_add_u32 m0, s24, 64
    s_nop 0
    v_mfma_f32_32x32x16_bf16 a[96:111], v[204:207], v[196:199], a[96:111]
    v_add_f32 v232, v232, v238
    v_exp_f32 v241, v241
    buffer_load_dwordx4 v222, s[8:11], s22 offen offset:2048 nt lds
    s_waitcnt lgkmcnt(4)
    v_mfma_f32_32x32x16_bf16 v[112:127], v[208:211], v[176:179], v[112:127]
    ds_read_b64_tr_b16 v[204:205], v220 offset:8704
    ds_read_b64_tr_b16 v[206:207], v220 offset:13056
    v_add_f32 v233, v233, v239
    v_cvt_pk_bf16_f32 v190, v238, v239
    v_add_f32 v232, v232, v240
    s_add_u32 m0, s24, 96
    s_nop 0
    v_mfma_f32_32x32x16_bf16 a[112:127], v[208:211], v[192:195], a[112:127]
    v_add_f32 v233, v233, v241
    v_cvt_pk_bf16_f32 v191, v240, v241
    v_add_f32 v232, v232, v233
    buffer_load_dwordx4 v222, s[8:11], s22 offen offset:3072 nt lds
    s_waitcnt lgkmcnt(4)
    v_mfma_f32_32x32x16_bf16 v[112:127], v[212:215], v[180:183], v[112:127]
    ds_read_b64_tr_b16 v[208:209], v220 offset:64
    ds_read_b64_tr_b16 v[210:211], v220 offset:4416
    v_cmp_lt_f32 vcc, s40, v232
    s_cbranch_vccnz RARE_21
BACK_21:
    v_add_f32 v228, v228, v232
    s_add_u32 s22, s22, 16384
    v_mfma_f32_32x32x16_bf16 a[112:127], v[212:215], v[196:199], a[112:127]
    s_add_u32 s24, s24, 16896
    s_cmp_ge_u32 s24, s33
    s_cselect_b32 s36, 67584, 0
    s_sub_u32 s24, s24, s36
    s_cmp_lg_u32 s30, 0
    s_cbranch_scc1 RESC_22
RBACK_22:
    s_waitcnt lgkmcnt(4)
    v_mfma_f32_32x32x16_bf16 v[0:15], v[200:203], v[184:187], v[0:15]
    ds_read_b64_tr_b16 v[212:213], v220 offset:8768
    ds_read_b64_tr_b16 v[214:215], v220 offset:13120
    s_barrier
    v_fma_f32 v234, v160, s20, v227
    v_fma_f32 v235, v161, s20, v227
    v_exp_f32 v234, v234
    v_fma_f32 v236, v162, s20, v227
    s_waitcnt lgkmcnt(4)
    v_mfma_f32_32x32x16_bf16 v[0:15], v[204:207], v[188:191], v[0:15]
    ds_read_b64_tr_b16 v[200:201], v221 offset:128
    ds_read_b64_tr_b16 v[202:203], v221 offset:4480
    s_add_u32 m0, s25, 0
    s_add_u32 s37, s41, 16768
    buffer_load_dwordx4 v224, s[4:7], s37 offen nt lds
    s_add_u32 m0, s25, 1024
    s_add_u32 s37, s41, 20864
    v_exp_f32 v235, v235
    v_fma_f32 v237, v163, s20, v227
    v_exp_f32 v236, v236
    v_mov_b32 v232, v234
    v_fma_f32 v238, v164, s20, v227
    s_waitcnt lgkmcnt(4)
    v_mfma_f32_32x32x16_bf16 v[16:31], v[208:211], v[184:187], v[16:31]
    ds_read_b64_tr_b16 v[204:205], v221 offset:8832
    ds_read_b64_tr_b16 v[206:207], v221 offset:13184
    buffer_load_dwordx4 v225, s[4:7], s37 offen nt lds
    s_add_u32 m0, s25, 2048
    s_add_u32 s37, s41, 24960
    v_exp_f32 v237, v237
    v_mov_b32 v233, v235
    v_cvt_pk_bf16_f32 v192, v234, v235
    v_fma_f32 v239, v165, s20, v227
    s_waitcnt lgkmcnt(4)
    v_mfma_f32_32x32x16_bf16 v[16:31], v[212:215], v[188:191], v[16:31]
    ds_read_b64_tr_b16 v[208:209], v221 offset:192
    ds_read_b64_tr_b16 v[210:211], v221 offset:4544
    buffer_load_dwordx4 v224, s[4:7], s37 offen nt lds
    s_add_u32 m0, s25, 3072
    s_add_u32 s37, s41, 29056
    v_exp_f32 v238, v238
    v_add_f32 v232, v232, v236
    v_fma_f32 v240, v166, s20, v227
    v_exp_f32 v239, v239
    s_waitcnt lgkmcnt(4)
    v_mfma_f32_32x32x16_bf16 v[32:47], v[200:203], v[184:187], v[32:47]
    ds_read_b64_tr_b16 v[212:213], v221 offset:8896
    ds_read_b64_tr_b16 v[214:215], v221 offset:13248
    buffer_load_dwordx4 v225, s[4:7], s37 offen nt lds
    s_add_u32 s25, s25, 17408
    s_cmp_ge_u32 s25, s34
    s_cselect_b32 s36, 87040, 0
    s_sub_u32 s25, s25, s36
    v_add_f32 v233, v233, v237
    v_cvt_pk_bf16_f32 v193, v236, v237
    v_fma_f32 v241, v167, s20, v227
    v_exp_f32 v240, v240
    v_add_f32 v232, v232, v238
    s_waitcnt lgkmcnt(4)
    v_mfma_f32_32x32x16_bf16 v[32:47], v[204:207], v[188:191], v[32:47]
    ds_read_b64_tr_b16 v[200:201], v220 offset:256
    ds_read_b64_tr_b16 v[202:203], v220 offset:4608
    s_add_u32 s25, s25, 17408
    s_cmp_ge_u32 s25, s34
    s_cselect_b32 s36, 87040, 0
    s_sub_u32 s25, s25, s36
    s_add_u32 m0, s25, 0
    v_fma_f32 v234, v168, s20, v227
    v_exp_f32 v241, v241
    v_add_f32 v233, v233, v239
    v_cvt_pk_bf16_f32 v194, v238, v239
    v_fma_f32 v235, v169, s20, v227
    s_waitcnt lgkmcnt(4)
    v_mfma_f32_32x32x16_bf16 v[48:63], v[208:211], v[184:187], v[48:63]
    ds_read_b64_tr_b16 v[204:205], v220 offset:8960
    ds_read_b64_tr_b16 v[206:207], v220 offset:13312
    s_nop 0
    buffer_load_dwordx4 v223, s[12:15], s23 offen offset:0 nt lds
    s_add_u32 m0, s25, 64
    s_nop 0
    v_exp_f32 v234, v234
    v_add_f32 v232, v232, v240
    v_fma_f32 v236, v170, s20, v227
    v_exp_f32 v235, v235
    s_waitcnt lgkmcnt(4)
    v_mfma_f32_32x32x16_bf16 v[48:63], v[212:215], v[188:191], v[48:63]
    ds_read_b64_tr_b16 v[208:209], v220 offset:320
    ds_read_b64_tr_b16 v[210:211], v220 offset:4672
    buffer_load_dwordx4 v223, s[12:15], s23 offen offset:1024 nt lds
    s_add_u32 m0, s25, 128
    s_nop 0
    v_add_f32 v233, v233, v241
    v_cvt_pk_bf16_f32 v195, v240, v241
    v_fma_f32 v237, v171, s20, v227
    v_exp_f32 v236, v236
    v_add_f32 v232, v232, v234
    s_waitcnt lgkmcnt(4)
    v_mfma_f32_32x32x16_bf16 v[64:79], v[200:203], v[184:187], v[64:79]
    ds_read_b64_tr_b16 v[212:213], v220 offset:9024
    ds_read_b64_tr_b16 v[214:215], v220 offset:13376
    buffer_load_dwordx4 v223, s[12:15], s23 offen offset:2048 nt lds
    s_add_u32 m0, s25, 192
    s_nop 0
    v_fma_f32 v238, v172, s20, v227
    v_exp_f32 v237, v237
    v_add_f32 v233, v233, v235
    v_cvt_pk_bf16_f32 v196, v234, v235
    s_waitcnt lgkmcnt(4)
    v_mfma_f32_32x32x16_bf16 v[64:79], v[204:207], v[188:191], v[64:79]
    ds_read_b64_tr_b16 v[200:201], v221 offset:384
    ds_read_b64_tr_b16 v[202:203], v221 offset:4736
    buffer_load_dwordx4 v223, s[12:15], s23 offen offset:3072 nt lds
    s_add_u32 s23, s23, 16384
    s_add_u32 s25, s25, 17408
    s_cmp_ge_u32 s25, s34
    s_cselect_b32 s36, 87040, 0
    s_sub_u32 s25, s25, s36
    v_fma_f32 v239, v173, s20, v227
    v_exp_f32 v238, v238
    v_add_f32 v232, v232, v236
    v_fma_f32 v240, v174, s20, v227
    v_exp_f32 v239, v239
    s_waitcnt lgkmcnt(4)
    v_mfma_f32_32x32x16_bf16 v[80:95], v[208:211], v[184:187], v[80:95]
    ds_read_b64_tr_b16 v[204:205], v221 offset:9088
    ds_read_b64_tr_b16 v[206:207], v221 offset:13440
    s_add_u32 m0, s24, 0
    s_nop 0
    v_add_f32 v233, v233, v237
    v_cvt_pk_bf16_f32 v197, v236, v237
    v_fma_f32 v241, v175, s20, v227
    v_exp_f32 v240, v240
    s_waitcnt lgkmcnt(4)
    v_mfma_f32_32x32x16_bf16 v[80:95], v[212:215], v[188:191], v[80:95]
    ds_read_b64_tr_b16 v[208:209], v221 offset:448
    ds_read_b64_tr_b16 v[210:211], v221 offset:4800
    buffer_load_dwordx4 v222, s[8:11], s22 offen offset:0 nt lds
    s_add_u32 m0, s24, 32
    s_nop 0
    buffer_load_dwordx4 v222, s[8:11], s22 offen offset:1024 nt lds
    v_add_f32 v232, v232, v238
    v_exp_f32 v241, v241
    v_add_f32 v233, v233, v239
    v_cvt_pk_bf16_f32 v198, v238, v239
    v_add_f32 v232, v232, v240
    s_waitcnt lgkmcnt(4)
    v_mfma_f32_32x32x16_bf16 v[96:111], v[200:203], v[184:187], v[96:111]
    ds_read_b64_tr_b16 v[212:213], v221 offset:9152
    ds_read_b64_tr_b16 v[214:215], v221 offset:13504
    s_add_u32 m0, s24, 64
    s_nop 0
    buffer_load_dwordx4 v222, s[8:11], s22 offen offset:2048 nt lds
    v_add_f32 v233, v233, v241
    v_cvt_pk_bf16_f32 v199, v240, v241
    v_add_f32 v232, v232, v233
    v_cmp_lt_f32 vcc, s40, v232
    s_cbranch_vccnz RARE_23
BACK_23:
    v_add_f32 v229, v229, v232
    s_waitcnt lgkmcnt(4)
    v_mfma_f32_32x32x16_bf16 v[96:111], v[204:207], v[188:191], v[96:111]
    ds_read_b64_tr_b16 v[200:201], v220 offset:0
    ds_read_b64_tr_b16 v[202:203], v220 offset:4352
    s_add_u32 m0, s24, 96
    s_nop 0
    buffer_load_dwordx4 v222, s[8:11], s22 offen offset:3072 nt lds
    v_mbcnt_lo_u32_b32 v238, -1, 0
    v_mbcnt_hi_u32_b32 v238, -1, v238
    v_lshrrev_b32 v239, 4, v238
    v_and_b32 v239, 2, v239
    v_bfe_u32 v240, v238, 1, 2
    v_xor_b32 v239, v239, v240
    v_and_b32 v240, 31, v238
    v_lshlrev_b32 v240, 6, v240
    v_lshl_add_u32 v253, v239, 4, v240
    v_add_u32 v253, s35, v253
    v_xor_b32 v254, 16, v253
    v_lshrrev_b32 v239, 2, v238
    v_bfe_u32 v240, v238, 3, 2
    s_waitcnt lgkmcnt(4)
    v_mfma_f32_32x32x16_bf16 v[112:127], v[208:211], v[184:187], v[112:127]
    ds_read_b64_tr_b16 v[204:205], v220 offset:8704
    ds_read_b64_tr_b16 v[206:207], v220 offset:13056
    s_add_u32 s22, s22, 16384
    s_add_u32 s24, s24, 16896
    s_cmp_ge_u32 s24, s33
    s_cselect_b32 s36, 67584, 0
    s_sub_u32 s24, s24, s36
    v_and_b32 v233, 3, v238
    v_xor_b32 v240, v240, v233
    v_lshlrev_b32 v255, 6, v239
    v_lshl_add_u32 v255, v240, 4, v255
    v_add_u32 v255, s35, v255
    v_lshlrev_b32 v233, 4, v233
    v_lshl_add_u32 v233, v239, 9, v233
    s_lshl_b32 s39, s21, 15
    v_add_u32 v233, s39, v233
    s_add_u32 s42, s31, 8192
    s_add_u32 s43, s32, 8192
    v_mov_b32 v242, v228
    v_mov_b32 v243, v228
    s_waitcnt lgkmcnt(4)
    v_mfma_f32_32x32x16_bf16 v[112:127], v[212:215], v[188:191], v[112:127]
    ds_read_b64_tr_b16 v[208:209], v220 offset:64
    ds_read_b64_tr_b16 v[210:211], v220 offset:4416
    s_nop 1
    v_permlane32_swap_b32 v242, v243
    s_nop 1
    v_add_f32 v242, v242, v243
    v_rcp_f32 v244, v242
    s_nop 0
    v_mov_b32 v245, v244
    v_mov_b32 v242, v229
    v_mov_b32 v243, v229
    s_nop 1
    v_permlane32_swap_b32 v242, v243
    s_nop 1
    v_add_f32 v242, v242, v243
    v_rcp_f32 v246, v242
    s_nop 0
    v_mov_b32 v247, v246
    s_cmp_lg_u32 s30, 0
    s_cbranch_scc1 RESC_24
RBACK_24:
    s_waitcnt lgkmcnt(4)
    v_mfma_f32_32x32x16_bf16 a[0:15], v[200:203], v[192:195], a[0:15]
    ds_read_b64_tr_b16 v[212:213], v220 offset:8768
    ds_read_b64_tr_b16 v[214:215], v220 offset:13120
    s_waitcnt vmcnt(16)
    s_add_u32 s38, s53, 102400
    v_xor_b32 v248, 0, v250
    v_add_u32 v248, s38, v248
    ds_read_b128 a[208:211], v248
    v_xor_b32 v249, 32, v250
    v_add_u32 v249, s38, v249
    s_waitcnt lgkmcnt(5)
    v_mfma_f32_32x32x16_bf16 a[0:15], v[204:207], v[196:199], a[0:15]
    ds_read_b64_tr_b16 v[200:201], v221 offset:128
    ds_read_b64_tr_b16 v[202:203], v221 offset:4480
    ds_read_b128 a[212:215], v249
    v_xor_b32 v251, 64, v250
    v_add_u32 v251, s38, v251
    ds_read_b128 a[216:219], v251
    v_xor_b32 v252, 96, v250
    v_add_u32 v252, s38, v252
    s_waitcnt lgkmcnt(7)
    v_mfma_f32_32x32x16_bf16 a[16:31], v[208:211], v[192:195], a[16:31]
    ds_read_b64_tr_b16 v[204:205], v221 offset:8832
    ds_read_b64_tr_b16 v[206:207], v221 offset:13184
    ds_read_b128 a[220:223], v252
    s_add_u32 s38, s52, 33792
    v_xor_b32 v248, 0, v250
    v_add_u32 v248, s38, v248
    ds_read_b128 a[160:163], v248
    v_xor_b32 v249, 32, v250
    v_add_u32 v249, s38, v249
    s_waitcnt lgkmcnt(9)
    v_mfma_f32_32x32x16_bf16 a[16:31], v[212:215], v[196:199], a[16:31]
    ds_read_b64_tr_b16 v[208:209], v221 offset:192
    ds_read_b64_tr_b16 v[210:211], v221 offset:4544
    ds_read_b128 a[164:167], v249
    v_xor_b32 v251, 64, v250
    v_add_u32 v251, s38, v251
    ds_read_b128 a[168:171], v251
    v_xor_b32 v252, 96, v250
    v_add_u32 v252, s38, v252
    v_pk_mul_f32 v[128:129], v[0:1], v[244:245]
    v_pk_mul_f32 v[130:131], v[2:3], v[244:245]
    v_pk_mul_f32 v[132:133], v[4:5], v[244:245]
    s_waitcnt lgkmcnt(10)
    v_mfma_f32_32x32x16_bf16 a[32:47], v[200:203], v[192:195], a[32:47]
    ds_read_b64_tr_b16 v[212:213], v221 offset:8896
    ds_read_b64_tr_b16 v[214:215], v221 offset:13248
    ds_read_b128 a[172:175], v252
    s_add_u32 s38, s53, 119808
    v_xor_b32 v248, 0, v250
    v_add_u32 v248, s38, v248
    ds_read_b128 a[224:227], v248
    v_xor_b32 v249, 32, v250
    v_add_u32 v249, s38, v249
    v_pk_mul_f32 v[134:135], v[6:7], v[244:245]
    v_cvt_pk_bf16_f32 v144, v128, v129
    v_cvt_pk_bf16_f32 v145, v130, v131
    s_waitcnt lgkmcnt(10)
    v_mfma_f32_32x32x16_bf16 a[32:47], v[204:207], v[196:199], a[32:47]
    ds_read_b64_tr_b16 v[200:201], v220 offset:256
    ds_read_b64_tr_b16 v[202:203], v220 offset:4608
    ds_read_b128 a[228:231], v249
    v_xor_b32 v251, 64, v250
    v_add_u32 v251, s38, v251
    ds_read_b128 a[232:235], v251
    v_xor_b32 v252, 96, v250
    v_add_u32 v252, s38, v252
    ds_read_b128 a[236:239], v252
    v_cvt_pk_bf16_f32 v146, v132, v133
    v_cvt_pk_bf16_f32 v147, v134, v135
    ds_write_b128 v253, v[144:147]
    s_waitcnt lgkmcnt(12)
    v_mfma_f32_32x32x16_bf16 a[48:63], v[208:211], v[192:195], a[48:63]
    ds_read_b64_tr_b16 v[204:205], v220 offset:8960
    ds_read_b64_tr_b16 v[206:207], v220 offset:13312
    s_add_u32 s38, s52, 50688
    v_xor_b32 v248, 0, v250
    v_add_u32 v248, s38, v248
    ds_read_b128 a[176:179], v248
    v_xor_b32 v249, 32, v250
    v_add_u32 v249, s38, v249
    ds_read_b128 a[180:183], v249
    v_pk_mul_f32 v[136:137], v[8:9], v[244:245]
    v_pk_mul_f32 v[138:139], v[10:11], v[244:245]
    v_pk_mul_f32 v[140:141], v[12:13], v[244:245]
    s_waitcnt lgkmcnt(12)
    v_mfma_f32_32x32x16_bf16 a[48:63], v[212:215], v[196:199], a[48:63]
    ds_read_b64_tr_b16 v[208:209], v220 offset:320
    ds_read_b64_tr_b16 v[210:211], v220 offset:4672
    v_xor_b32 v251, 64, v250
    v_add_u32 v251, s38, v251
    ds_read_b128 a[184:187], v251
    v_xor_b32 v252, 96, v250
    v_add_u32 v252, s38, v252
    ds_read_b128 a[188:191], v252
    v_pk_mul_f32 v[142:143], v[14:15], v[244:245]
    v_cvt_pk_bf16_f32 v148, v136, v137
    v_cvt_pk_bf16_f32 v149, v138, v139
    s_waitcnt lgkmcnt(12)
    v_mfma_f32_32x32x16_bf16 a[64:79], v[200:203], v[192:195], a[64:79]
    ds_read_b64_tr_b16 v[212:213], v220 offset:9024
    ds_read_b64_tr_b16 v[214:215], v220 offset:13376
    v_cvt_pk_bf16_f32 v150, v140, v141
    v_cvt_pk_bf16_f32 v151, v142, v143
    ds_write_b128 v254, v[148:151]
    s_waitcnt lgkmcnt(9)
    v_mfma_f32_32x32x16_bf16 a[64:79], v[204:207], v[196:199], a[64:79]
    ds_read_b64_tr_b16 v[200:201], v221 offset:384
    ds_read_b64_tr_b16 v[202:203], v221 offset:4736
    s_waitcnt lgkmcnt(5)
    s_add_u32 m0, s25, 0
    s_nop 0
    buffer_load_dwordx4 v223, s[12:15], s23 offen offset:0 nt lds
    s_add_u32 m0, s25, 64
    ds_read_b128 v[160:163], v255
    ds_read_b128 v[164:167], v255 offset:1024
    v_pk_mul_f32 v[128:129], v[16:17], v[244:245]
    v_mfma_f32_32x32x16_bf16 a[80:95], v[208:211], v[192:195], a[80:95]
    ds_read_b64_tr_b16 v[204:205], v221 offset:9088
    ds_read_b64_tr_b16 v[206:207], v221 offset:13440
    s_nop 0
    buffer_load_dwordx4 v223, s[12:15], s23 offen offset:1024 nt lds
    s_add_u32 m0, s25, 128
    s_nop 0
    v_pk_mul_f32 v[130:131], v[18:19], v[244:245]
    v_pk_mul_f32 v[132:133], v[20:21], v[244:245]
    v_pk_mul_f32 v[134:135], v[22:23], v[244:245]
    s_waitcnt lgkmcnt(7)
    v_mfma_f32_32x32x16_bf16 a[80:95], v[212:215], v[196:199], a[80:95]
    ds_read_b64_tr_b16 v[208:209], v221 offset:448
    ds_read_b64_tr_b16 v[210:211], v221 offset:4800
    buffer_load_dwordx4 v223, s[12:15], s23 offen offset:2048 nt lds
    s_add_u32 m0, s25, 192
    s_nop 0
    buffer_load_dwordx4 v223, s[12:15], s23 offen offset:3072 nt lds
    v_cvt_pk_bf16_f32 v152, v128, v129
    v_cvt_pk_bf16_f32 v153, v130, v131
    v_cvt_pk_bf16_f32 v154, v132, v133
    s_waitcnt lgkmcnt(6)
    v_mfma_f32_32x32x16_bf16 a[96:111], v[200:203], v[192:195], a[96:111]
    ds_read_b64_tr_b16 v[212:213], v221 offset:9152
    ds_read_b64_tr_b16 v[214:215], v221 offset:13504
    s_add_u32 s23, s23, 16384
    s_add_u32 s25, s25, 17408
    s_cmp_ge_u32 s25, s34
    s_cselect_b32 s36, 87040, 0
    s_sub_u32 s25, s25, s36
    s_add_u32 m0, s24, 0
    s_nop 0
    v_cvt_pk_bf16_f32 v155, v134, v135
    ds_write_b128 v253, v[152:155]
    v_pk_mul_f32 v[136:137], v[24:25], v[244:245]
    s_waitcnt lgkmcnt(5)
    v_mfma_f32_32x32x16_bf16 a[96:111], v[204:207], v[196:199], a[96:111]
    buffer_load_dwordx4 v222, s[8:11], s22 offen offset:0 nt lds
    s_add_u32 m0, s24, 32
    s_nop 0
    buffer_load_dwordx4 v222, s[8:11], s22 offen offset:1024 nt lds
    v_pk_mul_f32 v[138:139], v[26:27], v[244:245]
    v_pk_mul_f32 v[140:141], v[28:29], v[244:245]
    v_pk_mul_f32 v[142:143], v[30:31], v[244:245]
    s_waitcnt lgkmcnt(3)
    v_mfma_f32_32x32x16_bf16 a[112:127], v[208:211], v[192:195], a[112:127]
    s_add_u32 m0, s24, 64
    s_nop 0
    buffer_load_dwordx4 v222, s[8:11], s22 offen offset:2048 nt lds
    s_add_u32 m0, s24, 96
    s_nop 0
    v_cvt_pk_bf16_f32 v156, v136, v137
    v_cvt_pk_bf16_f32 v157, v138, v139
    v_cvt_pk_bf16_f32 v158, v140, v141
    s_waitcnt lgkmcnt(1)
    v_mfma_f32_32x32x16_bf16 a[112:127], v[212:215], v[196:199], a[112:127]
    buffer_load_dwordx4 v222, s[8:11], s22 offen offset:3072 nt lds
    s_add_u32 s22, s22, 16384
    s_add_u32 s24, s24, 16896
    s_cmp_ge_u32 s24, s33
    s_cselect_b32 s36, 67584, 0
    s_sub_u32 s24, s24, s36
    v_cvt_pk_bf16_f32 v159, v142, v143
    buffer_store_dwordx4 v[160:163], v233, s[16:19], s31 offen offset:0
    buffer_store_dwordx4 v[164:167], v233, s[16:19], s42 offen offset:0
    ds_write_b128 v254, v[156:159]
    ds_read_b128 v[168:171], v255
    s_add_u32 m0, s25, 0
    ds_read_b128 v[172:175], v255 offset:1024
    v_pk_mul_f32 v[128:129], v[32:33], v[244:245]
    v_pk_mul_f32 v[130:131], v[34:35], v[244:245]
    s_nop 0
    v_pk_mul_f32 v[132:133], v[36:37], v[244:245]
    v_pk_mul_f32 v[134:135], v[38:39], v[244:245]
    v_cvt_pk_bf16_f32 v144, v128, v129
    buffer_load_dwordx4 v223, s[12:15], s23 offen offset:0 nt lds
    v_cvt_pk_bf16_f32 v145, v130, v131
    v_cvt_pk_bf16_f32 v146, v132, v133
    v_cvt_pk_bf16_f32 v147, v134, v135
    s_add_u32 m0, s25, 64
    ds_write_b128 v253, v[144:147]
    v_pk_mul_f32 v[136:137], v[40:41], v[244:245]
    v_pk_mul_f32 v[138:139], v[42:43], v[244:245]
    s_nop 0
    v_pk_mul_f32 v[140:141], v[44:45], v[244:245]
    v_pk_mul_f32 v[142:143], v[46:47], v[244:245]
    v_cvt_pk_bf16_f32 v148, v136, v137
    buffer_load_dwordx4 v223, s[12:15], s23 offen offset:1024 nt lds
    v_cvt_pk_bf16_f32 v149, v138, v139
    v_cvt_pk_bf16_f32 v150, v140, v141
    v_cvt_pk_bf16_f32 v151, v142, v143
    s_add_u32 m0, s25, 128
    s_waitcnt lgkmcnt(1)
    buffer_store_dwordx4 v[168:171], v233, s[16:19], s31 offen offset:64
    buffer_store_dwordx4 v[172:175], v233, s[16:19], s42 offen offset:64
    s_nop 0
    ds_write_b128 v254, v[148:151]
    ds_read_b128 v[176:179], v255
    ds_read_b128 v[180:183], v255 offset:1024
    buffer_load_dwordx4 v223, s[12:15], s23 offen offset:2048 nt lds
    v_pk_mul_f32 v[128:129], v[48:49], v[244:245]
    v_pk_mul_f32 v[130:131], v[50:51], v[244:245]
    v_pk_mul_f32 v[132:133], v[52:53], v[244:245]
    s_add_u32 m0, s25, 192
    v_pk_mul_f32 v[134:135], v[54:55], v[244:245]
    v_cvt_pk_bf16_f32 v152, v128, v129
    v_cvt_pk_bf16_f32 v153, v130, v131
    s_nop 0
    v_cvt_pk_bf16_f32 v154, v132, v133
    v_cvt_pk_bf16_f32 v155, v134, v135
    ds_write_b128 v253, v[152:155]
    buffer_load_dwordx4 v223, s[12:15], s23 offen offset:3072 nt lds
    v_pk_mul_f32 v[136:137], v[56:57], v[244:245]
    v_pk_mul_f32 v[138:139], v[58:59], v[244:245]
    v_pk_mul_f32 v[140:141], v[60:61], v[244:245]
    s_add_u32 s23, s23, 16384
    v_pk_mul_f32 v[142:143], v[62:63], v[244:245]
    v_cvt_pk_bf16_f32 v156, v136, v137
    v_cvt_pk_bf16_f32 v157, v138, v139
    s_add_u32 s25, s25, 17408
    s_cmp_ge_u32 s25, s34
    s_cselect_b32 s36, 87040, 0
    s_sub_u32 s25, s25, s36
    v_cvt_pk_bf16_f32 v158, v140, v141
    v_cvt_pk_bf16_f32 v159, v142, v143
    s_waitcnt lgkmcnt(1)
    s_add_u32 m0, s24, 0
    buffer_store_dwordx4 v[176:179], v233, s[16:19], s31 offen offset:128
    buffer_store_dwordx4 v[180:183], v233, s[16:19], s42 offen offset:128
    ds_write_b128 v254, v[156:159]
    s_nop 0
    ds_read_b128 v[160:163], v255
    ds_read_b128 v[164:167], v255 offset:1024
    v_pk_mul_f32 v[128:129], v[64:65], v[244:245]
    buffer_load_dwordx4 v222, s[8:11], s22 offen offset:0 nt lds
    v_pk_mul_f32 v[130:131], v[66:67], v[244:245]
    v_pk_mul_f32 v[132:133], v[68:69], v[244:245]
    v_pk_mul_f32 v[134:135], v[70:71], v[244:245]
    s_add_u32 m0, s24, 32
    v_cvt_pk_bf16_f32 v144, v128, v129
    v_cvt_pk_bf16_f32 v145, v130, v131
    v_cvt_pk_bf16_f32 v146, v132, v133
    s_nop 0
    v_cvt_pk_bf16_f32 v147, v134, v135
    ds_write_b128 v253, v[144:147]
    v_pk_mul_f32 v[136:137], v[72:73], v[244:245]
    buffer_load_dwordx4 v222, s[8:11], s22 offen offset:1024 nt lds
    v_pk_mul_f32 v[138:139], v[74:75], v[244:245]
    v_pk_mul_f32 v[140:141], v[76:77], v[244:245]
    v_pk_mul_f32 v[142:143], v[78:79], v[244:245]
    s_add_u32 m0, s24, 64
    v_cvt_pk_bf16_f32 v148, v136, v137
    v_cvt_pk_bf16_f32 v149, v138, v139
    v_cvt_pk_bf16_f32 v150, v140, v141
    s_nop 0
    v_cvt_pk_bf16_f32 v151, v142, v143
    s_waitcnt lgkmcnt(1)
    buffer_store_dwordx4 v[160:163], v233, s[16:19], s31 offen offset:192
    buffer_load_dwordx4 v222, s[8:11], s22 offen offset:2048 nt lds
    buffer_store_dwordx4 v[164:167], v233, s[16:19], s42 offen offset:192
    ds_write_b128 v254, v[148:151]
    ds_read_b128 v[168:171], v255
    s_add_u32 m0, s24, 96
    ds_read_b128 v[172:175], v255 offset:1024
    v_pk_mul_f32 v[128:129], v[80:81], v[244:245]
    v_pk_mul_f32 v[130:131], v[82:83], v[244:245]
    s_nop 0
    v_pk_mul_f32 v[132:133], v[84:85], v[244:245]
    v_pk_mul_f32 v[134:135], v[86:87], v[244:245]
    v_cvt_pk_bf16_f32 v152, v128, v129
    buffer_load_dwordx4 v222, s[8:11], s22 offen offset:3072 nt lds
    v_cvt_pk_bf16_f32 v153, v130, v131
    v_cvt_pk_bf16_f32 v154, v132, v133
    v_cvt_pk_bf16_f32 v155, v134, v135
    s_add_u32 s22, s22, 16384
    ds_write_b128 v253, v[152:155]
    v_pk_mul_f32 v[136:137], v[88:89], v[244:245]
    v_pk_mul_f32 v[138:139], v[90:91], v[244:245]
    s_add_u32 s24, s24, 16896
    s_cmp_ge_u32 s24, s33
    s_cselect_b32 s36, 67584, 0
    s_sub_u32 s24, s24, s36
    v_pk_mul_f32 v[140:141], v[92:93], v[244:245]
    v_pk_mul_f32 v[142:143], v[94:95], v[244:245]
    v_cvt_pk_bf16_f32 v156, v136, v137
    v_cvt_pk_bf16_f32 v157, v138, v139
    v_cvt_pk_bf16_f32 v158, v140, v141
    v_cvt_pk_bf16_f32 v159, v142, v143
    s_waitcnt vmcnt(32)
    s_waitcnt lgkmcnt(1)
    buffer_store_dwordx4 v[168:171], v233, s[16:19], s31 offen offset:256
    buffer_store_dwordx4 v[172:175], v233, s[16:19], s42 offen offset:256
    ds_write_b128 v254, v[156:159]
    ds_read_b128 v[176:179], v255
    ds_read_b128 v[180:183], v255 offset:1024
    s_add_u32 s38, s53, 137216
    v_pk_mul_f32 v[128:129], v[96:97], v[244:245]
    v_pk_mul_f32 v[130:131], v[98:99], v[244:245]
    v_pk_mul_f32 v[132:133], v[100:101], v[244:245]
    v_xor_b32 v248, 0, v250
    v_add_u32 v248, s38, v248
    v_pk_mul_f32 v[134:135], v[102:103], v[244:245]
    v_cvt_pk_bf16_f32 v144, v128, v129
    v_cvt_pk_bf16_f32 v145, v130, v131
    ds_read_b128 a[240:243], v248
    v_cvt_pk_bf16_f32 v146, v132, v133
    v_cvt_pk_bf16_f32 v147, v134, v135
    ds_write_b128 v253, v[144:147]
    v_xor_b32 v249, 32, v250
    v_add_u32 v249, s38, v249
    v_pk_mul_f32 v[136:137], v[104:105], v[244:245]
    v_pk_mul_f32 v[138:139], v[106:107], v[244:245]
    v_pk_mul_f32 v[140:141], v[108:109], v[244:245]
    ds_read_b128 a[244:247], v249
    v_pk_mul_f32 v[142:143], v[110:111], v[244:245]
    v_cvt_pk_bf16_f32 v148, v136, v137
    v_cvt_pk_bf16_f32 v149, v138, v139
    v_xor_b32 v251, 64, v250
    v_add_u32 v251, s38, v251
    v_cvt_pk_bf16_f32 v150, v140, v141
    v_cvt_pk_bf16_f32 v151, v142, v143
    s_waitcnt lgkmcnt(3)
    ds_read_b128 a[248:251], v251
    buffer_store_dwordx4 v[176:179], v233, s[16:19], s31 offen offset:320
    buffer_store_dwordx4 v[180:183], v233, s[16:19], s42 offen offset:320
    ds_write_b128 v254, v[148:151]
    v_xor_b32 v252, 96, v250
    v_add_u32 v252, s38, v252
    ds_read_b128 v[160:163], v255
    ds_read_b128 v[164:167], v255 offset:1024
    v_pk_mul_f32 v[128:129], v[112:113], v[244:245]
    ds_read_b128 a[252:255], v252
    v_pk_mul_f32 v[130:131], v[114:115], v[244:245]
    v_pk_mul_f32 v[132:133], v[116:117], v[244:245]
    v_pk_mul_f32 v[134:135], v[118:119], v[244:245]
    v_cvt_pk_bf16_f32 v152, v128, v129
    v_cvt_pk_bf16_f32 v153, v130, v131
    v_cvt_pk_bf16_f32 v154, v132, v133
    v_cvt_pk_bf16_f32 v155, v134, v135
    ds_write_b128 v253, v[152:155]
    v_pk_mul_f32 v[136:137], v[120:121], v[244:245]
    v_pk_mul_f32 v[138:139], v[122:123], v[244:245]
    v_pk_mul_f32 v[140:141], v[124:125], v[244:245]
    v_pk_mul_f32 v[142:143], v[126:127], v[244:245]
    v_cvt_pk_bf16_f32 v156, v136, v137
    v_cvt_pk_bf16_f32 v157, v138, v139
    v_cvt_pk_bf16_f32 v158, v140, v141
    v_cvt_pk_bf16_f32 v159, v142, v143
    s_waitcnt lgkmcnt(2)
    buffer_store_dwordx4 v[160:163], v233, s[16:19], s31 offen offset:384
    buffer_store_dwordx4 v[164:167], v233, s[16:19], s42 offen offset:384
    ds_write_b128 v254, v[156:159]
    ds_read_b128 v[168:171], v255
    ds_read_b128 v[172:175], v255 offset:1024
    s_waitcnt lgkmcnt(0)
    buffer_store_dwordx4 v[168:171], v233, s[16:19], s31 offen offset:448
    buffer_store_dwordx4 v[172:175], v233, s[16:19], s42 offen offset:448
    s_cmp_eq_u32 s29, 1
    s_cbranch_scc1 LAST_EPI
    v_add_u32 v219, s26, v216
    s_add_u32 s26, s26, 16896
    s_cmp_ge_u32 s26, 67584
    s_cselect_b32 s26, 0, s26
    s_mov_b32 s30, 0
    s_waitcnt vmcnt(44)
    s_waitcnt lgkmcnt(0)
    s_barrier
    ds_read_b128 v[200:203], v219 offset:0
    ds_read_b128 v[204:207], v219 offset:32
    ds_read_b128 v[208:211], v219 offset:64
    s_waitcnt lgkmcnt(2)
    v_mfma_f32_32x32x16_bf16 v[176:191], v[200:203], a[128:131], 0
    ds_read_b128 v[212:215], v219 offset:96
    v_accvgpr_read_b32 v0, a0
    v_accvgpr_read_b32 v1, a1
    v_accvgpr_read_b32 v2, a2
    v_accvgpr_read_b32 v3, a3
    v_accvgpr_read_b32 v4, a4
    v_accvgpr_read_b32 v5, a5
    v_accvgpr_read_b32 v6, a6
    v_accvgpr_read_b32 v7, a7
    v_pk_mul_f32 v[0:1], v[0:1], v[246:247]
    v_pk_mul_f32 v[2:3], v[2:3], v[246:247]
    v_mfma_f32_32x32x16_bf16 v[144:159], v[200:203], a[192:195], 0
    v_pk_mul_f32 v[4:5], v[4:5], v[246:247]
    v_pk_mul_f32 v[6:7], v[6:7], v[246:247]
    v_cvt_pk_bf16_f32 v16, v0, v1
    v_cvt_pk_bf16_f32 v17, v2, v3
    v_cvt_pk_bf16_f32 v18, v4, v5
    v_cvt_pk_bf16_f32 v19, v6, v7
    ds_write_b128 v253, v[16:19]
    v_accvgpr_read_b32 v8, a8
    v_accvgpr_read_b32 v9, a9
    v_accvgpr_read_b32 v10, a10
    s_waitcnt lgkmcnt(3)
    v_mfma_f32_32x32x16_bf16 v[176:191], v[204:207], a[132:135], v[176:191]
    ds_read_b128 v[200:203], v219 offset:128
    v_accvgpr_read_b32 v11, a11
    v_accvgpr_read_b32 v12, a12
    v_accvgpr_read_b32 v13, a13
    v_accvgpr_read_b32 v14, a14
    v_accvgpr_read_b32 v15, a15
    v_pk_mul_f32 v[8:9], v[8:9], v[246:247]
    v_pk_mul_f32 v[10:11], v[10:11], v[246:247]
    v_pk_mul_f32 v[12:13], v[12:13], v[246:247]
    v_pk_mul_f32 v[14:15], v[14:15], v[246:247]
    v_cvt_pk_bf16_f32 v20, v8, v9
    v_mfma_f32_32x32x16_bf16 v[144:159], v[204:207], a[196:199], v[144:159]
    v_cvt_pk_bf16_f32 v21, v10, v11
    v_cvt_pk_bf16_f32 v22, v12, v13
    v_cvt_pk_bf16_f32 v23, v14, v15
    ds_write_b128 v254, v[20:23]
    ds_read_b128 v[32:35], v255
    ds_read_b128 v[36:39], v255 offset:1024
    v_accvgpr_read_b32 v0, a16
    v_accvgpr_read_b32 v1, a17
    v_accvgpr_read_b32 v2, a18
    v_accvgpr_read_b32 v3, a19
    s_waitcnt lgkmcnt(6)
    v_mfma_f32_32x32x16_bf16 v[176:191], v[208:211], a[136:139], v[176:191]
    ds_read_b128 v[204:207], v219 offset:160
    v_accvgpr_read_b32 v4, a20
    v_accvgpr_read_b32 v5, a21
    v_accvgpr_read_b32 v6, a22
    v_accvgpr_read_b32 v7, a23
    v_pk_mul_f32 v[0:1], v[0:1], v[246:247]
    v_pk_mul_f32 v[2:3], v[2:3], v[246:247]
    v_pk_mul_f32 v[4:5], v[4:5], v[246:247]
    v_pk_mul_f32 v[6:7], v[6:7], v[246:247]
    v_cvt_pk_bf16_f32 v24, v0, v1
    v_cvt_pk_bf16_f32 v25, v2, v3
    v_mfma_f32_32x32x16_bf16 v[144:159], v[208:211], a[200:203], v[144:159]
    v_cvt_pk_bf16_f32 v26, v4, v5
    v_cvt_pk_bf16_f32 v27, v6, v7
    ds_write_b128 v253, v[24:27]
    v_accvgpr_read_b32 v8, a24
    v_accvgpr_read_b32 v9, a25
    v_accvgpr_read_b32 v10, a26
    v_accvgpr_read_b32 v11, a27
    v_accvgpr_read_b32 v12, a28
    v_accvgpr_read_b32 v13, a29
    v_accvgpr_read_b32 v14, a30
    s_waitcnt lgkmcnt(7)
    v_mfma_f32_32x32x16_bf16 v[176:191], v[212:215], a[140:143], v[176:191]
    ds_read_b128 v[208:211], v219 offset:192
    v_accvgpr_read_b32 v15, a31
    v_pk_mul_f32 v[8:9], v[8:9], v[246:247]
    v_pk_mul_f32 v[10:11], v[10:11], v[246:247]
    v_pk_mul_f32 v[12:13], v[12:13], v[246:247]
    v_pk_mul_f32 v[14:15], v[14:15], v[246:247]
    v_cvt_pk_bf16_f32 v28, v8, v9
    v_cvt_pk_bf16_f32 v29, v10, v11
    v_cvt_pk_bf16_f32 v30, v12, v13
    v_cvt_pk_bf16_f32 v31, v14, v15
    s_waitcnt lgkmcnt(3)
    v_mfma_f32_32x32x16_bf16 v[144:159], v[212:215], a[204:207], v[144:159]
    buffer_store_dwordx4 v[32:35], v233, s[16:19], s32 offen offset:0
    buffer_store_dwordx4 v[36:39], v233, s[16:19], s43 offen offset:0
    ds_write_b128 v254, v[28:31]
    ds_read_b128 v[40:43], v255
    ds_read_b128 v[44:47], v255 offset:1024
    v_accvgpr_read_b32 v0, a32
    v_accvgpr_read_b32 v1, a33
    v_accvgpr_read_b32 v2, a34
    v_accvgpr_read_b32 v3, a35
    v_mfma_f32_32x32x16_bf16 v[176:191], v[200:203], a[144:147], v[176:191]
    ds_read_b128 v[212:215], v219 offset:224
    v_accvgpr_read_b32 v4, a36
    v_accvgpr_read_b32 v5, a37
    v_accvgpr_read_b32 v6, a38
    v_accvgpr_read_b32 v7, a39
    v_pk_mul_f32 v[0:1], v[0:1], v[246:247]
    v_pk_mul_f32 v[2:3], v[2:3], v[246:247]
    v_pk_mul_f32 v[4:5], v[4:5], v[246:247]
    v_pk_mul_f32 v[6:7], v[6:7], v[246:247]
    v_cvt_pk_bf16_f32 v16, v0, v1
    v_cvt_pk_bf16_f32 v17, v2, v3
    v_mfma_f32_32x32x16_bf16 v[144:159], v[200:203], a[208:211], v[144:159]
    v_cvt_pk_bf16_f32 v18, v4, v5
    v_cvt_pk_bf16_f32 v19, v6, v7
    ds_write_b128 v253, v[16:19]
    v_accvgpr_read_b32 v8, a40
    v_accvgpr_read_b32 v9, a41
    v_accvgpr_read_b32 v10, a42
    v_accvgpr_read_b32 v11, a43
    v_accvgpr_read_b32 v12, a44
    v_accvgpr_read_b32 v13, a45
    v_accvgpr_read_b32 v14, a46
    s_waitcnt lgkmcnt(7)
    v_mfma_f32_32x32x16_bf16 v[176:191], v[204:207], a[148:151], v[176:191]
    ds_read_b128 v[200:203], v219 offset:256
    v_accvgpr_read_b32 v15, a47
    v_pk_mul_f32 v[8:9], v[8:9], v[246:247]
    v_pk_mul_f32 v[10:11], v[10:11], v[246:247]
    v_pk_mul_f32 v[12:13], v[12:13], v[246:247]
    v_pk_mul_f32 v[14:15], v[14:15], v[246:247]
    v_cvt_pk_bf16_f32 v20, v8, v9
    v_cvt_pk_bf16_f32 v21, v10, v11
    v_cvt_pk_bf16_f32 v22, v12, v13
    v_cvt_pk_bf16_f32 v23, v14, v15
    s_waitcnt lgkmcnt(3)
    v_mfma_f32_32x32x16_bf16 v[144:159], v[204:207], a[212:215], v[144:159]
    buffer_store_dwordx4 v[40:43], v233, s[16:19], s32 offen offset:64
    buffer_store_dwordx4 v[44:47], v233, s[16:19], s43 offen offset:64
    ds_write_b128 v254, v[20:23]
    ds_read_b128 v[48:51], v255
    ds_read_b128 v[52:55], v255 offset:1024
    v_accvgpr_read_b32 v0, a48
    v_accvgpr_read_b32 v1, a49
    v_accvgpr_read_b32 v2, a50
    v_accvgpr_read_b32 v3, a51
    v_mfma_f32_32x32x16_bf16 v[176:191], v[208:211], a[152:155], v[176:191]
    ds_read_b128 v[204:207], v219 offset:288
    v_accvgpr_read_b32 v4, a52
    v_accvgpr_read_b32 v5, a53
    v_accvgpr_read_b32 v6, a54
    v_accvgpr_read_b32 v7, a55
    v_pk_mul_f32 v[0:1], v[0:1], v[246:247]
    v_pk_mul_f32 v[2:3], v[2:3], v[246:247]
    v_pk_mul_f32 v[4:5], v[4:5], v[246:247]
    v_pk_mul_f32 v[6:7], v[6:7], v[246:247]
    v_cvt_pk_bf16_f32 v24, v0, v1
    v_cvt_pk_bf16_f32 v25, v2, v3
    v_mfma_f32_32x32x16_bf16 v[144:159], v[208:211], a[216:219], v[144:159]
    v_cvt_pk_bf16_f32 v26, v4, v5
    v_cvt_pk_bf16_f32 v27, v6, v7
    ds_write_b128 v253, v[24:27]
    v_accvgpr_read_b32 v8, a56
    v_accvgpr_read_b32 v9, a57
    v_accvgpr_read_b32 v10, a58
    v_accvgpr_read_b32 v11, a59
    v_accvgpr_read_b32 v12, a60
    v_accvgpr_read_b32 v13, a61
    v_accvgpr_read_b32 v14, a62
    s_waitcnt lgkmcnt(7)
    v_mfma_f32_32x32x16_bf16 v[176:191], v[212:215], a[156:159], v[176:191]
    ds_read_b128 v[208:211], v219 offset:320
    v_accvgpr_read_b32 v15, a63
    v_pk_mul_f32 v[8:9], v[8:9], v[246:247]
    v_pk_mul_f32 v[10:11], v[10:11], v[246:247]
    v_pk_mul_f32 v[12:13], v[12:13], v[246:247]
    v_pk_mul_f32 v[14:15], v[14:15], v[246:247]
    v_cvt_pk_bf16_f32 v28, v8, v9
    v_cvt_pk_bf16_f32 v29, v10, v11
    v_cvt_pk_bf16_f32 v30, v12, v13
    v_cvt_pk_bf16_f32 v31, v14, v15
    s_waitcnt lgkmcnt(3)
    v_mfma_f32_32x32x16_bf16 v[144:159], v[212:215], a[220:223], v[144:159]
    buffer_store_dwordx4 v[48:51], v233, s[16:19], s32 offen offset:128
    buffer_store_dwordx4 v[52:55], v233, s[16:19], s43 offen offset:128
    ds_write_b128 v254, v[28:31]
    ds_read_b128 v[32:35], v255
    ds_read_b128 v[36:39], v255 offset:1024
    v_accvgpr_read_b32 v0, a64
    v_accvgpr_read_b32 v1, a65
    v_accvgpr_read_b32 v2, a66
    v_accvgpr_read_b32 v3, a67
    v_mfma_f32_32x32x16_bf16 v[176:191], v[200:203], a[160:163], v[176:191]
    ds_read_b128 v[212:215], v219 offset:352
    v_accvgpr_read_b32 v4, a68
    v_accvgpr_read_b32 v5, a69
    v_accvgpr_read_b32 v6, a70
    v_accvgpr_read_b32 v7, a71
    v_pk_mul_f32 v[0:1], v[0:1], v[246:247]
    v_pk_mul_f32 v[2:3], v[2:3], v[246:247]
    v_pk_mul_f32 v[4:5], v[4:5], v[246:247]
    v_pk_mul_f32 v[6:7], v[6:7], v[246:247]
    v_cvt_pk_bf16_f32 v16, v0, v1
    v_cvt_pk_bf16_f32 v17, v2, v3
    v_mfma_f32_32x32x16_bf16 v[144:159], v[200:203], a[224:227], v[144:159]
    v_cvt_pk_bf16_f32 v18, v4, v5
    v_cvt_pk_bf16_f32 v19, v6, v7
    ds_write_b128 v253, v[16:19]
    v_accvgpr_read_b32 v8, a72
    v_accvgpr_read_b32 v9, a73
    v_accvgpr_read_b32 v10, a74
    v_accvgpr_read_b32 v11, a75
    v_accvgpr_read_b32 v12, a76
    v_accvgpr_read_b32 v13, a77
    v_accvgpr_read_b32 v14, a78
    s_waitcnt lgkmcnt(7)
    v_mfma_f32_32x32x16_bf16 v[176:191], v[204:207], a[164:167], v[176:191]
    ds_read_b128 v[200:203], v219 offset:384
    v_accvgpr_read_b32 v15, a79
    v_pk_mul_f32 v[8:9], v[8:9], v[246:247]
    v_pk_mul_f32 v[10:11], v[10:11], v[246:247]
    v_pk_mul_f32 v[12:13], v[12:13], v[246:247]
    v_pk_mul_f32 v[14:15], v[14:15], v[246:247]
    v_cvt_pk_bf16_f32 v20, v8, v9
    v_cvt_pk_bf16_f32 v21, v10, v11
    v_cvt_pk_bf16_f32 v22, v12, v13
    v_cvt_pk_bf16_f32 v23, v14, v15
    s_waitcnt lgkmcnt(3)
    v_mfma_f32_32x32x16_bf16 v[144:159], v[204:207], a[228:231], v[144:159]
    buffer_store_dwordx4 v[32:35], v233, s[16:19], s32 offen offset:192
    buffer_store_dwordx4 v[36:39], v233, s[16:19], s43 offen offset:192
    ds_write_b128 v254, v[20:23]
    ds_read_b128 v[40:43], v255
    ds_read_b128 v[44:47], v255 offset:1024
    v_accvgpr_read_b32 v0, a80
    v_accvgpr_read_b32 v1, a81
    v_accvgpr_read_b32 v2, a82
    v_accvgpr_read_b32 v3, a83
    v_mfma_f32_32x32x16_bf16 v[176:191], v[208:211], a[168:171], v[176:191]
    ds_read_b128 v[204:207], v219 offset:416
    v_accvgpr_read_b32 v4, a84
    v_accvgpr_read_b32 v5, a85
    v_accvgpr_read_b32 v6, a86
    v_accvgpr_read_b32 v7, a87
    v_pk_mul_f32 v[0:1], v[0:1], v[246:247]
    v_pk_mul_f32 v[2:3], v[2:3], v[246:247]
    v_pk_mul_f32 v[4:5], v[4:5], v[246:247]
    v_pk_mul_f32 v[6:7], v[6:7], v[246:247]
    v_cvt_pk_bf16_f32 v24, v0, v1
    v_cvt_pk_bf16_f32 v25, v2, v3
    v_mfma_f32_32x32x16_bf16 v[144:159], v[208:211], a[232:235], v[144:159]
    v_cvt_pk_bf16_f32 v26, v4, v5
    v_cvt_pk_bf16_f32 v27, v6, v7
    ds_write_b128 v253, v[24:27]
    v_accvgpr_read_b32 v8, a88
    v_accvgpr_read_b32 v9, a89
    v_accvgpr_read_b32 v10, a90
    v_accvgpr_read_b32 v11, a91
    v_accvgpr_read_b32 v12, a92
    v_accvgpr_read_b32 v13, a93
    v_accvgpr_read_b32 v14, a94
    s_waitcnt lgkmcnt(7)
    v_mfma_f32_32x32x16_bf16 v[176:191], v[212:215], a[172:175], v[176:191]
    ds_read_b128 v[208:211], v219 offset:448
    v_accvgpr_read_b32 v15, a95
    v_pk_mul_f32 v[8:9], v[8:9], v[246:247]
    v_pk_mul_f32 v[10:11], v[10:11], v[246:247]
    v_pk_mul_f32 v[12:13], v[12:13], v[246:247]
    v_pk_mul_f32 v[14:15], v[14:15], v[246:247]
    v_cvt_pk_bf16_f32 v28, v8, v9
    v_cvt_pk_bf16_f32 v29, v10, v11
    v_cvt_pk_bf16_f32 v30, v12, v13
    v_cvt_pk_bf16_f32 v31, v14, v15
    s_waitcnt lgkmcnt(3)
    v_mfma_f32_32x32x16_bf16 v[144:159], v[212:215], a[236:239], v[144:159]
    buffer_store_dwordx4 v[40:43], v233, s[16:19], s32 offen offset:256
    buffer_store_dwordx4 v[44:47], v233, s[16:19], s43 offen offset:256
    ds_write_b128 v254, v[28:31]
    ds_read_b128 v[48:51], v255
    ds_read_b128 v[52:55], v255 offset:1024
    v_accvgpr_read_b32 v0, a96
    v_accvgpr_read_b32 v1, a97
    v_accvgpr_read_b32 v2, a98
    v_accvgpr_read_b32 v3, a99
    v_mfma_f32_32x32x16_bf16 v[176:191], v[200:203], a[176:179], v[176:191]
    ds_read_b128 v[212:215], v219 offset:480
    v_accvgpr_read_b32 v4, a100
    v_accvgpr_read_b32 v5, a101
    v_accvgpr_read_b32 v6, a102
    v_accvgpr_read_b32 v7, a103
    v_pk_mul_f32 v[0:1], v[0:1], v[246:247]
    v_pk_mul_f32 v[2:3], v[2:3], v[246:247]
    v_pk_mul_f32 v[4:5], v[4:5], v[246:247]
    v_pk_mul_f32 v[6:7], v[6:7], v[246:247]
    v_cvt_pk_bf16_f32 v16, v0, v1
    v_cvt_pk_bf16_f32 v17, v2, v3
    v_mfma_f32_32x32x16_bf16 v[144:159], v[200:203], a[240:243], v[144:159]
    v_cvt_pk_bf16_f32 v18, v4, v5
    v_cvt_pk_bf16_f32 v19, v6, v7
    ds_write_b128 v253, v[16:19]
    v_accvgpr_read_b32 v8, a104
    v_accvgpr_read_b32 v9, a105
    v_accvgpr_read_b32 v10, a106
    v_accvgpr_read_b32 v11, a107
    v_accvgpr_read_b32 v12, a108
    v_accvgpr_read_b32 v13, a109
    v_accvgpr_read_b32 v14, a110
    s_waitcnt lgkmcnt(7)
    v_mfma_f32_32x32x16_bf16 v[176:191], v[204:207], a[180:183], v[176:191]
    v_accvgpr_read_b32 v15, a111
    v_pk_mul_f32 v[8:9], v[8:9], v[246:247]
    v_pk_mul_f32 v[10:11], v[10:11], v[246:247]
    v_pk_mul_f32 v[12:13], v[12:13], v[246:247]
    v_pk_mul_f32 v[14:15], v[14:15], v[246:247]
    v_cvt_pk_bf16_f32 v20, v8, v9
    v_cvt_pk_bf16_f32 v21, v10, v11
    v_cvt_pk_bf16_f32 v22, v12, v13
    v_cvt_pk_bf16_f32 v23, v14, v15
    s_waitcnt lgkmcnt(2)
    v_mfma_f32_32x32x16_bf16 v[144:159], v[204:207], a[244:247], v[144:159]
    buffer_store_dwordx4 v[48:51], v233, s[16:19], s32 offen offset:320
    buffer_store_dwordx4 v[52:55], v233, s[16:19], s43 offen offset:320
    ds_write_b128 v254, v[20:23]
    ds_read_b128 v[32:35], v255
    ds_read_b128 v[36:39], v255 offset:1024
    v_accvgpr_read_b32 v0, a112
    v_accvgpr_read_b32 v1, a113
    v_accvgpr_read_b32 v2, a114
    v_accvgpr_read_b32 v3, a115
    v_mfma_f32_32x32x16_bf16 v[176:191], v[208:211], a[184:187], v[176:191]
    v_accvgpr_read_b32 v4, a116
    v_accvgpr_read_b32 v5, a117
    v_accvgpr_read_b32 v6, a118
    v_accvgpr_read_b32 v7, a119
    v_pk_mul_f32 v[0:1], v[0:1], v[246:247]
    v_pk_mul_f32 v[2:3], v[2:3], v[246:247]
    v_pk_mul_f32 v[4:5], v[4:5], v[246:247]
    v_pk_mul_f32 v[6:7], v[6:7], v[246:247]
    v_cvt_pk_bf16_f32 v24, v0, v1
    v_cvt_pk_bf16_f32 v25, v2, v3
    v_mfma_f32_32x32x16_bf16 v[144:159], v[208:211], a[248:251], v[144:159]
    v_cvt_pk_bf16_f32 v26, v4, v5
    v_cvt_pk_bf16_f32 v27, v6, v7
    ds_write_b128 v253, v[24:27]
    v_accvgpr_read_b32 v8, a120
    v_accvgpr_read_b32 v9, a121
    v_accvgpr_read_b32 v10, a122
    v_accvgpr_read_b32 v11, a123
    v_accvgpr_read_b32 v12, a124
    v_accvgpr_read_b32 v13, a125
    v_accvgpr_read_b32 v14, a126
    s_waitcnt lgkmcnt(5)
    v_mfma_f32_32x32x16_bf16 v[176:191], v[212:215], a[188:191], v[176:191]
    v_accvgpr_read_b32 v15, a127
    v_pk_mul_f32 v[8:9], v[8:9], v[246:247]
    v_pk_mul_f32 v[10:11], v[10:11], v[246:247]
    v_pk_mul_f32 v[12:13], v[12:13], v[246:247]
    v_pk_mul_f32 v[14:15], v[14:15], v[246:247]
    v_cvt_pk_bf16_f32 v28, v8, v9
    v_cvt_pk_bf16_f32 v29, v10, v11
    v_cvt_pk_bf16_f32 v30, v12, v13
    v_cvt_pk_bf16_f32 v31, v14, v15
    s_waitcnt lgkmcnt(1)
    v_mfma_f32_32x32x16_bf16 v[144:159], v[212:215], a[252:255], v[144:159]
    buffer_store_dwordx4 v[32:35], v233, s[16:19], s32 offen offset:384
    buffer_store_dwordx4 v[36:39], v233, s[16:19], s43 offen offset:384
    ds_write_b128 v254, v[28:31]
    ds_read_b128 v[40:43], v255
    ds_read_b128 v[44:47], v255 offset:1024
    s_waitcnt lgkmcnt(0)
    buffer_store_dwordx4 v[40:43], v233, s[16:19], s32 offen offset:448
    buffer_store_dwordx4 v[44:47], v233, s[16:19], s43 offen offset:448
    s_mov_b32 s29, 1
    s_add_u32 s31, s31, 262144
    s_add_u32 s32, s32, 262144
    s_mov_b32 s41, 0x7f000000
    s_waitcnt lgkmcnt(0)
    s_branch AFTER_QK0
LAST_EPI:
    v_accvgpr_read_b32 v0, a0
    v_accvgpr_read_b32 v1, a1
    v_accvgpr_read_b32 v2, a2
    v_accvgpr_read_b32 v3, a3
    v_accvgpr_read_b32 v4, a4
    v_accvgpr_read_b32 v5, a5
    v_accvgpr_read_b32 v6, a6
    v_accvgpr_read_b32 v7, a7
    v_pk_mul_f32 v[0:1], v[0:1], v[246:247]
    v_pk_mul_f32 v[2:3], v[2:3], v[246:247]
    v_pk_mul_f32 v[4:5], v[4:5], v[246:247]
    v_pk_mul_f32 v[6:7], v[6:7], v[246:247]
    v_cvt_pk_bf16_f32 v16, v0, v1
    v_cvt_pk_bf16_f32 v17, v2, v3
    v_cvt_pk_bf16_f32 v18, v4, v5
    v_cvt_pk_bf16_f32 v19, v6, v7
    ds_write_b128 v253, v[16:19]
    v_accvgpr_read_b32 v8, a8
    v_accvgpr_read_b32 v9, a9
    v_accvgpr_read_b32 v10, a10
    v_accvgpr_read_b32 v11, a11
    v_accvgpr_read_b32 v12, a12
    v_accvgpr_read_b32 v13, a13
    v_accvgpr_read_b32 v14, a14
    v_accvgpr_read_b32 v15, a15
    v_pk_mul_f32 v[8:9], v[8:9], v[246:247]
    v_pk_mul_f32 v[10:11], v[10:11], v[246:247]
    v_pk_mul_f32 v[12:13], v[12:13], v[246:247]
    v_pk_mul_f32 v[14:15], v[14:15], v[246:247]
    v_cvt_pk_bf16_f32 v20, v8, v9
    v_cvt_pk_bf16_f32 v21, v10, v11
    v_cvt_pk_bf16_f32 v22, v12, v13
    v_cvt_pk_bf16_f32 v23, v14, v15
    ds_write_b128 v254, v[20:23]
    ds_read_b128 v[32:35], v255
    ds_read_b128 v[36:39], v255 offset:1024
    v_accvgpr_read_b32 v0, a16
    v_accvgpr_read_b32 v1, a17
    v_accvgpr_read_b32 v2, a18
    v_accvgpr_read_b32 v3, a19
    v_accvgpr_read_b32 v4, a20
    v_accvgpr_read_b32 v5, a21
    v_accvgpr_read_b32 v6, a22
    v_accvgpr_read_b32 v7, a23
    v_pk_mul_f32 v[0:1], v[0:1], v[246:247]
    v_pk_mul_f32 v[2:3], v[2:3], v[246:247]
    v_pk_mul_f32 v[4:5], v[4:5], v[246:247]
    v_pk_mul_f32 v[6:7], v[6:7], v[246:247]
    v_cvt_pk_bf16_f32 v24, v0, v1
    v_cvt_pk_bf16_f32 v25, v2, v3
    v_cvt_pk_bf16_f32 v26, v4, v5
    v_cvt_pk_bf16_f32 v27, v6, v7
    ds_write_b128 v253, v[24:27]
    v_accvgpr_read_b32 v8, a24
    v_accvgpr_read_b32 v9, a25
    v_accvgpr_read_b32 v10, a26
    v_accvgpr_read_b32 v11, a27
    v_accvgpr_read_b32 v12, a28
    v_accvgpr_read_b32 v13, a29
    v_accvgpr_read_b32 v14, a30
    v_accvgpr_read_b32 v15, a31
    v_pk_mul_f32 v[8:9], v[8:9], v[246:247]
    v_pk_mul_f32 v[10:11], v[10:11], v[246:247]
    v_pk_mul_f32 v[12:13], v[12:13], v[246:247]
    v_pk_mul_f32 v[14:15], v[14:15], v[246:247]
    v_cvt_pk_bf16_f32 v28, v8, v9
    v_cvt_pk_bf16_f32 v29, v10, v11
    v_cvt_pk_bf16_f32 v30, v12, v13
    v_cvt_pk_bf16_f32 v31, v14, v15
    s_waitcnt lgkmcnt(1)
    buffer_store_dwordx4 v[32:35], v233, s[16:19], s32 offen offset:0
    buffer_store_dwordx4 v[36:39], v233, s[16:19], s43 offen offset:0
    ds_write_b128 v254, v[28:31]
    ds_read_b128 v[40:43], v255
    ds_read_b128 v[44:47], v255 offset:1024
    v_accvgpr_read_b32 v0, a32
    v_accvgpr_read_b32 v1, a33
    v_accvgpr_read_b32 v2, a34
    v_accvgpr_read_b32 v3, a35
    v_accvgpr_read_b32 v4, a36
    v_accvgpr_read_b32 v5, a37
    v_accvgpr_read_b32 v6, a38
    v_accvgpr_read_b32 v7, a39
    v_pk_mul_f32 v[0:1], v[0:1], v[246:247]
    v_pk_mul_f32 v[2:3], v[2:3], v[246:247]
    v_pk_mul_f32 v[4:5], v[4:5], v[246:247]
    v_pk_mul_f32 v[6:7], v[6:7], v[246:247]
    v_cvt_pk_bf16_f32 v16, v0, v1
    v_cvt_pk_bf16_f32 v17, v2, v3
    v_cvt_pk_bf16_f32 v18, v4, v5
    v_cvt_pk_bf16_f32 v19, v6, v7
    ds_write_b128 v253, v[16:19]
    v_accvgpr_read_b32 v8, a40
    v_accvgpr_read_b32 v9, a41
    v_accvgpr_read_b32 v10, a42
    v_accvgpr_read_b32 v11, a43
    v_accvgpr_read_b32 v12, a44
    v_accvgpr_read_b32 v13, a45
    v_accvgpr_read_b32 v14, a46
    v_accvgpr_read_b32 v15, a47
    v_pk_mul_f32 v[8:9], v[8:9], v[246:247]
    v_pk_mul_f32 v[10:11], v[10:11], v[246:247]
    v_pk_mul_f32 v[12:13], v[12:13], v[246:247]
    v_pk_mul_f32 v[14:15], v[14:15], v[246:247]
    v_cvt_pk_bf16_f32 v20, v8, v9
    v_cvt_pk_bf16_f32 v21, v10, v11
    v_cvt_pk_bf16_f32 v22, v12, v13
    v_cvt_pk_bf16_f32 v23, v14, v15
    s_waitcnt lgkmcnt(1)
    buffer_store_dwordx4 v[40:43], v233, s[16:19], s32 offen offset:64
    buffer_store_dwordx4 v[44:47], v233, s[16:19], s43 offen offset:64
    ds_write_b128 v254, v[20:23]
    ds_read_b128 v[48:51], v255
    ds_read_b128 v[52:55], v255 offset:1024
    v_accvgpr_read_b32 v0, a48
    v_accvgpr_read_b32 v1, a49
    v_accvgpr_read_b32 v2, a50
    v_accvgpr_read_b32 v3, a51
    v_accvgpr_read_b32 v4, a52
    v_accvgpr_read_b32 v5, a53
    v_accvgpr_read_b32 v6, a54
    v_accvgpr_read_b32 v7, a55
    v_pk_mul_f32 v[0:1], v[0:1], v[246:247]
    v_pk_mul_f32 v[2:3], v[2:3], v[246:247]
    v_pk_mul_f32 v[4:5], v[4:5], v[246:247]
    v_pk_mul_f32 v[6:7], v[6:7], v[246:247]
    v_cvt_pk_bf16_f32 v24, v0, v1
    v_cvt_pk_bf16_f32 v25, v2, v3
    v_cvt_pk_bf16_f32 v26, v4, v5
    v_cvt_pk_bf16_f32 v27, v6, v7
    ds_write_b128 v253, v[24:27]
    v_accvgpr_read_b32 v8, a56
    v_accvgpr_read_b32 v9, a57
    v_accvgpr_read_b32 v10, a58
    v_accvgpr_read_b32 v11, a59
    v_accvgpr_read_b32 v12, a60
    v_accvgpr_read_b32 v13, a61
    v_accvgpr_read_b32 v14, a62
    v_accvgpr_read_b32 v15, a63
    v_pk_mul_f32 v[8:9], v[8:9], v[246:247]
    v_pk_mul_f32 v[10:11], v[10:11], v[246:247]
    v_pk_mul_f32 v[12:13], v[12:13], v[246:247]
    v_pk_mul_f32 v[14:15], v[14:15], v[246:247]
    v_cvt_pk_bf16_f32 v28, v8, v9
    v_cvt_pk_bf16_f32 v29, v10, v11
    v_cvt_pk_bf16_f32 v30, v12, v13
    v_cvt_pk_bf16_f32 v31, v14, v15
    s_waitcnt lgkmcnt(1)
    buffer_store_dwordx4 v[48:51], v233, s[16:19], s32 offen offset:128
    buffer_store_dwordx4 v[52:55], v233, s[16:19], s43 offen offset:128
    ds_write_b128 v254, v[28:31]
    ds_read_b128 v[32:35], v255
    ds_read_b128 v[36:39], v255 offset:1024
    v_accvgpr_read_b32 v0, a64
    v_accvgpr_read_b32 v1, a65
    v_accvgpr_read_b32 v2, a66
    v_accvgpr_read_b32 v3, a67
    v_accvgpr_read_b32 v4, a68
    v_accvgpr_read_b32 v5, a69
    v_accvgpr_read_b32 v6, a70
    v_accvgpr_read_b32 v7, a71
    v_pk_mul_f32 v[0:1], v[0:1], v[246:247]
    v_pk_mul_f32 v[2:3], v[2:3], v[246:247]
    v_pk_mul_f32 v[4:5], v[4:5], v[246:247]
    v_pk_mul_f32 v[6:7], v[6:7], v[246:247]
    v_cvt_pk_bf16_f32 v16, v0, v1
    v_cvt_pk_bf16_f32 v17, v2, v3
    v_cvt_pk_bf16_f32 v18, v4, v5
    v_cvt_pk_bf16_f32 v19, v6, v7
    ds_write_b128 v253, v[16:19]
    v_accvgpr_read_b32 v8, a72
    v_accvgpr_read_b32 v9, a73
    v_accvgpr_read_b32 v10, a74
    v_accvgpr_read_b32 v11, a75
    v_accvgpr_read_b32 v12, a76
    v_accvgpr_read_b32 v13, a77
    v_accvgpr_read_b32 v14, a78
    v_accvgpr_read_b32 v15, a79
    v_pk_mul_f32 v[8:9], v[8:9], v[246:247]
    v_pk_mul_f32 v[10:11], v[10:11], v[246:247]
    v_pk_mul_f32 v[12:13], v[12:13], v[246:247]
    v_pk_mul_f32 v[14:15], v[14:15], v[246:247]
    v_cvt_pk_bf16_f32 v20, v8, v9
    v_cvt_pk_bf16_f32 v21, v10, v11
    v_cvt_pk_bf16_f32 v22, v12, v13
    v_cvt_pk_bf16_f32 v23, v14, v15
    s_waitcnt lgkmcnt(1)
    buffer_store_dwordx4 v[32:35], v233, s[16:19], s32 offen offset:192
    buffer_store_dwordx4 v[36:39], v233, s[16:19], s43 offen offset:192
    ds_write_b128 v254, v[20:23]
    ds_read_b128 v[40:43], v255
    ds_read_b128 v[44:47], v255 offset:1024
    v_accvgpr_read_b32 v0, a80
    v_accvgpr_read_b32 v1, a81
    v_accvgpr_read_b32 v2, a82
    v_accvgpr_read_b32 v3, a83
    v_accvgpr_read_b32 v4, a84
    v_accvgpr_read_b32 v5, a85
    v_accvgpr_read_b32 v6, a86
    v_accvgpr_read_b32 v7, a87
    v_pk_mul_f32 v[0:1], v[0:1], v[246:247]
    v_pk_mul_f32 v[2:3], v[2:3], v[246:247]
    v_pk_mul_f32 v[4:5], v[4:5], v[246:247]
    v_pk_mul_f32 v[6:7], v[6:7], v[246:247]
    v_cvt_pk_bf16_f32 v24, v0, v1
    v_cvt_pk_bf16_f32 v25, v2, v3
    v_cvt_pk_bf16_f32 v26, v4, v5
    v_cvt_pk_bf16_f32 v27, v6, v7
    ds_write_b128 v253, v[24:27]
    v_accvgpr_read_b32 v8, a88
    v_accvgpr_read_b32 v9, a89
    v_accvgpr_read_b32 v10, a90
    v_accvgpr_read_b32 v11, a91
    v_accvgpr_read_b32 v12, a92
    v_accvgpr_read_b32 v13, a93
    v_accvgpr_read_b32 v14, a94
    v_accvgpr_read_b32 v15, a95
    v_pk_mul_f32 v[8:9], v[8:9], v[246:247]
    v_pk_mul_f32 v[10:11], v[10:11], v[246:247]
    v_pk_mul_f32 v[12:13], v[12:13], v[246:247]
    v_pk_mul_f32 v[14:15], v[14:15], v[246:247]
    v_cvt_pk_bf16_f32 v28, v8, v9
    v_cvt_pk_bf16_f32 v29, v10, v11
    v_cvt_pk_bf16_f32 v30, v12, v13
    v_cvt_pk_bf16_f32 v31, v14, v15
    s_waitcnt lgkmcnt(1)
    buffer_store_dwordx4 v[40:43], v233, s[16:19], s32 offen offset:256
    buffer_store_dwordx4 v[44:47], v233, s[16:19], s43 offen offset:256
    ds_write_b128 v254, v[28:31]
    ds_read_b128 v[48:51], v255
    ds_read_b128 v[52:55], v255 offset:1024
    v_accvgpr_read_b32 v0, a96
    v_accvgpr_read_b32 v1, a97
    v_accvgpr_read_b32 v2, a98
    v_accvgpr_read_b32 v3, a99
    v_accvgpr_read_b32 v4, a100
    v_accvgpr_read_b32 v5, a101
    v_accvgpr_read_b32 v6, a102
    v_accvgpr_read_b32 v7, a103
    v_pk_mul_f32 v[0:1], v[0:1], v[246:247]
    v_pk_mul_f32 v[2:3], v[2:3], v[246:247]
    v_pk_mul_f32 v[4:5], v[4:5], v[246:247]
    v_pk_mul_f32 v[6:7], v[6:7], v[246:247]
    v_cvt_pk_bf16_f32 v16, v0, v1
    v_cvt_pk_bf16_f32 v17, v2, v3
    v_cvt_pk_bf16_f32 v18, v4, v5
    v_cvt_pk_bf16_f32 v19, v6, v7
    ds_write_b128 v253, v[16:19]
    v_accvgpr_read_b32 v8, a104
    v_accvgpr_read_b32 v9, a105
    v_accvgpr_read_b32 v10, a106
    v_accvgpr_read_b32 v11, a107
    v_accvgpr_read_b32 v12, a108
    v_accvgpr_read_b32 v13, a109
    v_accvgpr_read_b32 v14, a110
    v_accvgpr_read_b32 v15, a111
    v_pk_mul_f32 v[8:9], v[8:9], v[246:247]
    v_pk_mul_f32 v[10:11], v[10:11], v[246:247]
    v_pk_mul_f32 v[12:13], v[12:13], v[246:247]
    v_pk_mul_f32 v[14:15], v[14:15], v[246:247]
    v_cvt_pk_bf16_f32 v20, v8, v9
    v_cvt_pk_bf16_f32 v21, v10, v11
    v_cvt_pk_bf16_f32 v22, v12, v13
    v_cvt_pk_bf16_f32 v23, v14, v15
    s_waitcnt lgkmcnt(1)
    buffer_store_dwordx4 v[48:51], v233, s[16:19], s32 offen offset:320
    buffer_store_dwordx4 v[52:55], v233, s[16:19], s43 offen offset:320
    ds_write_b128 v254, v[20:23]
    ds_read_b128 v[32:35], v255
    ds_read_b128 v[36:39], v255 offset:1024
    v_accvgpr_read_b32 v0, a112
    v_accvgpr_read_b32 v1, a113
    v_accvgpr_read_b32 v2, a114
    v_accvgpr_read_b32 v3, a115
    v_accvgpr_read_b32 v4, a116
    v_accvgpr_read_b32 v5, a117
    v_accvgpr_read_b32 v6, a118
    v_accvgpr_read_b32 v7, a119
    v_pk_mul_f32 v[0:1], v[0:1], v[246:247]
    v_pk_mul_f32 v[2:3], v[2:3], v[246:247]
    v_pk_mul_f32 v[4:5], v[4:5], v[246:247]
    v_pk_mul_f32 v[6:7], v[6:7], v[246:247]
    v_cvt_pk_bf16_f32 v24, v0, v1
    v_cvt_pk_bf16_f32 v25, v2, v3
    v_cvt_pk_bf16_f32 v26, v4, v5
    v_cvt_pk_bf16_f32 v27, v6, v7
    ds_write_b128 v253, v[24:27]
    v_accvgpr_read_b32 v8, a120
    v_accvgpr_read_b32 v9, a121
    v_accvgpr_read_b32 v10, a122
    v_accvgpr_read_b32 v11, a123
    v_accvgpr_read_b32 v12, a124
    v_accvgpr_read_b32 v13, a125
    v_accvgpr_read_b32 v14, a126
    v_accvgpr_read_b32 v15, a127
    v_pk_mul_f32 v[8:9], v[8:9], v[246:247]
    v_pk_mul_f32 v[10:11], v[10:11], v[246:247]
    v_pk_mul_f32 v[12:13], v[12:13], v[246:247]
    v_pk_mul_f32 v[14:15], v[14:15], v[246:247]
    v_cvt_pk_bf16_f32 v28, v8, v9
    v_cvt_pk_bf16_f32 v29, v10, v11
    v_cvt_pk_bf16_f32 v30, v12, v13
    v_cvt_pk_bf16_f32 v31, v14, v15
    s_waitcnt lgkmcnt(1)
    buffer_store_dwordx4 v[32:35], v233, s[16:19], s32 offen offset:384
    buffer_store_dwordx4 v[36:39], v233, s[16:19], s43 offen offset:384
    ds_write_b128 v254, v[28:31]
    ds_read_b128 v[40:43], v255
    ds_read_b128 v[44:47], v255 offset:1024
    s_waitcnt lgkmcnt(0)
    buffer_store_dwordx4 v[40:43], v233, s[16:19], s32 offen offset:448
    buffer_store_dwordx4 v[44:47], v233, s[16:19], s43 offen offset:448
    s_branch DONE
LAST_TAIL:
    s_cmp_lg_u32 s30, 0
    s_cbranch_scc1 RESC_25
RBACK_25:
    s_waitcnt lgkmcnt(4)
    v_mfma_f32_32x32x16_bf16 v[0:15], v[200:203], v[176:179], v[0:15]
    ds_read_b64_tr_b16 v[212:213], v220 offset:8768
    ds_read_b64_tr_b16 v[214:215], v220 offset:13120
    v_mfma_f32_32x32x16_bf16 a[0:15], v[200:203], v[192:195], a[0:15]
    s_waitcnt vmcnt(16)
    s_barrier
    s_waitcnt lgkmcnt(4)
    v_mfma_f32_32x32x16_bf16 v[0:15], v[204:207], v[180:183], v[0:15]
    ds_read_b64_tr_b16 v[200:201], v221 offset:128
    ds_read_b64_tr_b16 v[202:203], v221 offset:4480
    v_mfma_f32_32x32x16_bf16 a[0:15], v[204:207], v[196:199], a[0:15]
    s_waitcnt lgkmcnt(4)
    v_mfma_f32_32x32x16_bf16 v[16:31], v[208:211], v[176:179], v[16:31]
    ds_read_b64_tr_b16 v[204:205], v221 offset:8832
    ds_read_b64_tr_b16 v[206:207], v221 offset:13184
    v_mfma_f32_32x32x16_bf16 a[16:31], v[208:211], v[192:195], a[16:31]
    v_fma_f32 v234, v128, s20, v226
    v_fma_f32 v235, v129, s20, v226
    s_waitcnt lgkmcnt(4)
    v_mfma_f32_32x32x16_bf16 v[16:31], v[212:215], v[180:183], v[16:31]
    ds_read_b64_tr_b16 v[208:209], v221 offset:192
    ds_read_b64_tr_b16 v[210:211], v221 offset:4544
    v_exp_f32 v234, v234
    v_fma_f32 v236, v130, s20, v226
    v_mfma_f32_32x32x16_bf16 a[16:31], v[212:215], v[196:199], a[16:31]
    v_exp_f32 v235, v235
    v_fma_f32 v237, v131, s20, v226
    s_waitcnt lgkmcnt(4)
    v_mfma_f32_32x32x16_bf16 v[32:47], v[200:203], v[176:179], v[32:47]
    ds_read_b64_tr_b16 v[212:213], v221 offset:8896
    ds_read_b64_tr_b16 v[214:215], v221 offset:13248
    v_exp_f32 v236, v236
    v_mov_b32 v232, v234
    v_fma_f32 v238, v132, s20, v226
    v_mfma_f32_32x32x16_bf16 a[32:47], v[200:203], v[192:195], a[32:47]
    v_exp_f32 v237, v237
    v_mov_b32 v233, v235
    s_waitcnt lgkmcnt(4)
    v_mfma_f32_32x32x16_bf16 v[32:47], v[204:207], v[180:183], v[32:47]
    ds_read_b64_tr_b16 v[200:201], v220 offset:256
    ds_read_b64_tr_b16 v[202:203], v220 offset:4608
    v_cvt_pk_bf16_f32 v184, v234, v235
    v_fma_f32 v239, v133, s20, v226
    v_mfma_f32_32x32x16_bf16 a[32:47], v[204:207], v[196:199], a[32:47]
    v_exp_f32 v238, v238
    v_add_f32 v232, v232, v236
    s_waitcnt lgkmcnt(4)
    v_mfma_f32_32x32x16_bf16 v[48:63], v[208:211], v[176:179], v[48:63]
    ds_read_b64_tr_b16 v[204:205], v220 offset:8960
    ds_read_b64_tr_b16 v[206:207], v220 offset:13312
    v_fma_f32 v240, v134, s20, v226
    v_exp_f32 v239, v239
    v_mfma_f32_32x32x16_bf16 a[48:63], v[208:211], v[192:195], a[48:63]
    v_add_f32 v233, v233, v237
    v_cvt_pk_bf16_f32 v185, v236, v237
    v_fma_f32 v241, v135, s20, v226
    s_waitcnt lgkmcnt(4)
    v_mfma_f32_32x32x16_bf16 v[48:63], v[212:215], v[180:183], v[48:63]
    ds_read_b64_tr_b16 v[208:209], v220 offset:320
    ds_read_b64_tr_b16 v[210:211], v220 offset:4672
    v_exp_f32 v240, v240
    v_add_f32 v232, v232, v238
    v_mfma_f32_32x32x16_bf16 a[48:63], v[212:215], v[196:199], a[48:63]
    v_fma_f32 v234, v136, s20, v226
    v_exp_f32 v241, v241
    s_waitcnt lgkmcnt(4)
    v_mfma_f32_32x32x16_bf16 v[64:79], v[200:203], v[176:179], v[64:79]
    ds_read_b64_tr_b16 v[212:213], v220 offset:9024
    ds_read_b64_tr_b16 v[214:215], v220 offset:13376
    v_add_f32 v233, v233, v239
    v_cvt_pk_bf16_f32 v186, v238, v239
    v_fma_f32 v235, v137, s20, v226
    v_mfma_f32_32x32x16_bf16 a[64:79], v[200:203], v[192:195], a[64:79]
    v_exp_f32 v234, v234
    v_add_f32 v232, v232, v240
    s_waitcnt lgkmcnt(4)
    v_mfma_f32_32x32x16_bf16 v[64:79], v[204:207], v[180:183], v[64:79]
    ds_read_b64_tr_b16 v[200:201], v221 offset:384
    ds_read_b64_tr_b16 v[202:203], v221 offset:4736
    v_fma_f32 v236, v138, s20, v226
    v_exp_f32 v235, v235
    v_mfma_f32_32x32x16_bf16 a[64:79], v[204:207], v[196:199], a[64:79]
    v_add_f32 v233, v233, v241
    v_cvt_pk_bf16_f32 v187, v240, v241
    v_fma_f32 v237, v139, s20, v226
    s_waitcnt lgkmcnt(4)
    v_mfma_f32_32x32x16_bf16 v[80:95], v[208:211], v[176:179], v[80:95]
    ds_read_b64_tr_b16 v[204:205], v221 offset:9088
    ds_read_b64_tr_b16 v[206:207], v221 offset:13440
    v_exp_f32 v236, v236
    v_add_f32 v232, v232, v234
    v_mfma_f32_32x32x16_bf16 a[80:95], v[208:211], v[192:195], a[80:95]
    v_fma_f32 v238, v140, s20, v226
    v_exp_f32 v237, v237
    s_waitcnt lgkmcnt(4)
    v_mfma_f32_32x32x16_bf16 v[80:95], v[212:215], v[180:183], v[80:95]
    ds_read_b64_tr_b16 v[208:209], v221 offset:448
    ds_read_b64_tr_b16 v[210:211], v221 offset:4800
    v_add_f32 v233, v233, v235
    v_cvt_pk_bf16_f32 v188, v234, v235
    v_mfma_f32_32x32x16_bf16 a[80:95], v[212:215], v[196:199], a[80:95]
    v_fma_f32 v239, v141, s20, v226
    v_exp_f32 v238, v238
    s_waitcnt lgkmcnt(4)
    v_mfma_f32_32x32x16_bf16 v[96:111], v[200:203], v[176:179], v[96:111]
    ds_read_b64_tr_b16 v[212:213], v221 offset:9152
    ds_read_b64_tr_b16 v[214:215], v221 offset:13504
    v_add_f32 v232, v232, v236
    v_fma_f32 v240, v142, s20, v226
    v_exp_f32 v239, v239
    v_add_u32 v220, s27, v217
    v_add_u32 v221, s27, v218
    s_add_u32 s27, s27, 17408
    s_cmp_ge_u32 s27, 154624
    s_cselect_b32 s27, 67584, s27
    v_mfma_f32_32x32x16_bf16 a[96:111], v[200:203], v[192:195], a[96:111]
    v_add_f32 v233, v233, v237
    v_cvt_pk_bf16_f32 v189, v236, v237
    s_waitcnt lgkmcnt(4)
    v_mfma_f32_32x32x16_bf16 v[96:111], v[204:207], v[180:183], v[96:111]
    ds_read_b64_tr_b16 v[200:201], v220 offset:0
    ds_read_b64_tr_b16 v[202:203], v220 offset:4352
    v_fma_f32 v241, v143, s20, v226
    v_exp_f32 v240, v240
    v_mfma_f32_32x32x16_bf16 a[96:111], v[204:207], v[196:199], a[96:111]
    v_add_f32 v232, v232, v238
    v_exp_f32 v241, v241
    s_waitcnt lgkmcnt(4)
    v_mfma_f32_32x32x16_bf16 v[112:127], v[208:211], v[176:179], v[112:127]
    ds_read_b64_tr_b16 v[204:205], v220 offset:8704
    ds_read_b64_tr_b16 v[206:207], v220 offset:13056
    v_add_f32 v233, v233, v239
    v_cvt_pk_bf16_f32 v190, v238, v239
    v_add_f32 v232, v232, v240
    v_mfma_f32_32x32x16_bf16 a[112:127], v[208:211], v[192:195], a[112:127]
    v_add_f32 v233, v233, v241
    v_cvt_pk_bf16_f32 v191, v240, v241
    v_add_f32 v232, v232, v233
    s_waitcnt lgkmcnt(4)
    v_mfma_f32_32x32x16_bf16 v[112:127], v[212:215], v[180:183], v[112:127]
    ds_read_b64_tr_b16 v[208:209], v220 offset:64
    ds_read_b64_tr_b16 v[210:211], v220 offset:4416
    v_cmp_lt_f32 vcc, s40, v232
    s_cbranch_vccnz RARE_26
BACK_26:
    v_add_f32 v228, v228, v232
    v_mfma_f32_32x32x16_bf16 a[112:127], v[212:215], v[196:199], a[112:127]
    s_cmp_lg_u32 s30, 0
    s_cbranch_scc1 RESC_27
RBACK_27:
    s_waitcnt lgkmcnt(4)
    v_mfma_f32_32x32x16_bf16 v[0:15], v[200:203], v[184:187], v[0:15]
    ds_read_b64_tr_b16 v[212:213], v220 offset:8768
    ds_read_b64_tr_b16 v[214:215], v220 offset:13120
    s_barrier
    v_fma_f32 v234, v160, s20, v227
    v_fma_f32 v235, v161, s20, v227
    v_exp_f32 v234, v234
    v_fma_f32 v236, v162, s20, v227
    v_exp_f32 v235, v235
    s_waitcnt lgkmcnt(4)
    v_mfma_f32_32x32x16_bf16 v[0:15], v[204:207], v[188:191], v[0:15]
    ds_read_b64_tr_b16 v[200:201], v221 offset:128
    ds_read_b64_tr_b16 v[202:203], v221 offset:4480
    v_fma_f32 v237, v163, s20, v227
    v_exp_f32 v236, v236
    v_mov_b32 v232, v234
    v_fma_f32 v238, v164, s20, v227
    s_waitcnt lgkmcnt(4)
    v_mfma_f32_32x32x16_bf16 v[16:31], v[208:211], v[184:187], v[16:31]
    ds_read_b64_tr_b16 v[204:205], v221 offset:8832
    ds_read_b64_tr_b16 v[206:207], v221 offset:13184
    v_exp_f32 v237, v237
    v_mov_b32 v233, v235
    v_cvt_pk_bf16_f32 v192, v234, v235
    v_fma_f32 v239, v165, s20, v227
    v_exp_f32 v238, v238
    s_waitcnt lgkmcnt(4)
    v_mfma_f32_32x32x16_bf16 v[16:31], v[212:215], v[188:191], v[16:31]
    ds_read_b64_tr_b16 v[208:209], v221 offset:192
    ds_read_b64_tr_b16 v[210:211], v221 offset:4544
    v_add_f32 v232, v232, v236
    v_fma_f32 v240, v166, s20, v227
    v_exp_f32 v239, v239
    v_add_f32 v233, v233, v237
    v_cvt_pk_bf16_f32 v193, v236, v237
    s_waitcnt lgkmcnt(4)
    v_mfma_f32_32x32x16_bf16 v[32:47], v[200:203], v[184:187], v[32:47]
    ds_read_b64_tr_b16 v[212:213], v221 offset:8896
    ds_read_b64_tr_b16 v[214:215], v221 offset:13248
    v_fma_f32 v241, v167, s20, v227
    v_exp_f32 v240, v240
    v_add_f32 v232, v232, v238
    v_fma_f32 v234, v168, s20, v227
    v_exp_f32 v241, v241
    s_waitcnt lgkmcnt(4)
    v_mfma_f32_32x32x16_bf16 v[32:47], v[204:207], v[188:191], v[32:47]
    ds_read_b64_tr_b16 v[200:201], v220 offset:256
    ds_read_b64_tr_b16 v[202:203], v220 offset:4608
    v_add_f32 v233, v233, v239
    v_cvt_pk_bf16_f32 v194, v238, v239
    v_fma_f32 v235, v169, s20, v227
    v_exp_f32 v234, v234
    v_add_f32 v232, v232, v240
    s_waitcnt lgkmcnt(4)
    v_mfma_f32_32x32x16_bf16 v[48:63], v[208:211], v[184:187], v[48:63]
    ds_read_b64_tr_b16 v[204:205], v220 offset:8960
    ds_read_b64_tr_b16 v[206:207], v220 offset:13312
    v_fma_f32 v236, v170, s20, v227
    v_exp_f32 v235, v235
    v_add_f32 v233, v233, v241
    v_cvt_pk_bf16_f32 v195, v240, v241
    v_fma_f32 v237, v171, s20, v227
    s_waitcnt lgkmcnt(4)
    v_mfma_f32_32x32x16_bf16 v[48:63], v[212:215], v[188:191], v[48:63]
    ds_read_b64_tr_b16 v[208:209], v220 offset:320
    ds_read_b64_tr_b16 v[210:211], v220 offset:4672
    v_exp_f32 v236, v236
    v_add_f32 v232, v232, v234
    v_fma_f32 v238, v172, s20, v227
    v_exp_f32 v237, v237
    s_waitcnt lgkmcnt(4)
    v_mfma_f32_32x32x16_bf16 v[64:79], v[200:203], v[184:187], v[64:79]
    ds_read_b64_tr_b16 v[212:213], v220 offset:9024
    ds_read_b64_tr_b16 v[214:215], v220 offset:13376
    v_add_f32 v233, v233, v235
    v_cvt_pk_bf16_f32 v196, v234, v235
    v_fma_f32 v239, v173, s20, v227
    v_exp_f32 v238, v238
    v_add_f32 v232, v232, v236
    v_fma_f32 v240, v174, s20, v227
    s_waitcnt lgkmcnt(4)
    v_mfma_f32_32x32x16_bf16 v[64:79], v[204:207], v[188:191], v[64:79]
    ds_read_b64_tr_b16 v[200:201], v221 offset:384
    ds_read_b64_tr_b16 v[202:203], v221 offset:4736
    v_exp_f32 v239, v239
    v_add_f32 v233, v233, v237
    v_cvt_pk_bf16_f32 v197, v236, v237
    v_fma_f32 v241, v175, s20, v227
    s_waitcnt lgkmcnt(4)
    v_mfma_f32_32x32x16_bf16 v[80:95], v[208:211], v[184:187], v[80:95]
    ds_read_b64_tr_b16 v[204:205], v221 offset:9088
    ds_read_b64_tr_b16 v[206:207], v221 offset:13440
    v_exp_f32 v240, v240
    v_add_f32 v232, v232, v238
    v_exp_f32 v241, v241
    v_add_f32 v233, v233, v239
    v_cvt_pk_bf16_f32 v198, v238, v239
    s_waitcnt lgkmcnt(4)
    v_mfma_f32_32x32x16_bf16 v[80:95], v[212:215], v[188:191], v[80:95]
    ds_read_b64_tr_b16 v[208:209], v221 offset:448
    ds_read_b64_tr_b16 v[210:211], v221 offset:4800
    v_add_f32 v232, v232, v240
    v_add_f32 v233, v233, v241
    v_cvt_pk_bf16_f32 v199, v240, v241
    v_add_f32 v232, v232, v233
    v_cmp_lt_f32 vcc, s40, v232
    s_cbranch_vccnz RARE_28
BACK_28:
    v_add_f32 v229, v229, v232
    s_waitcnt lgkmcnt(4)
    v_mfma_f32_32x32x16_bf16 v[96:111], v[200:203], v[184:187], v[96:111]
    ds_read_b64_tr_b16 v[212:213], v221 offset:9152
    ds_read_b64_tr_b16 v[214:215], v221 offset:13504
    v_mbcnt_lo_u32_b32 v238, -1, 0
    v_mbcnt_hi_u32_b32 v238, -1, v238
    v_and_b32 v239, 7, v238
    v_mul_u32_u24 v239, 528, v239
    v_lshrrev_b32 v240, 5, v238
    v_lshl_add_u32 v239, v240, 5, v239
    v_mul_u32_u24 v255, 528, v240
    v_and_b32 v233, 31, v238
    v_lshl_add_u32 v255, v233, 4, v255
    s_waitcnt lgkmcnt(4)
    v_mfma_f32_32x32x16_bf16 v[96:111], v[204:207], v[188:191], v[96:111]
    ds_read_b64_tr_b16 v[200:201], v220 offset:0
    ds_read_b64_tr_b16 v[202:203], v220 offset:4352
    v_bfe_u32 v240, v238, 3, 2
    v_mul_u32_u24 v253, 16896, v240
    v_add3_u32 v253, v253, v239, s52
    v_min_u32 v233, 1, v240
    v_add_u32 v240, v240, v233
    v_mul_u32_u24 v254, 17408, v240
    s_add_u32 s38, s53, 67584
    v_add3_u32 v254, v254, v239, s38
    v_lshlrev_b32 v233, 4, v238
    s_waitcnt lgkmcnt(4)
    v_mfma_f32_32x32x16_bf16 v[112:127], v[208:211], v[184:187], v[112:127]
    ds_read_b64_tr_b16 v[204:205], v220 offset:8704
    ds_read_b64_tr_b16 v[206:207], v220 offset:13056
    s_lshl_b32 s39, s21, 15
    v_add_u32 v233, s39, v233
    v_mov_b32 v242, v228
    v_mov_b32 v243, v228
    s_nop 1
    v_permlane32_swap_b32 v242, v243
    s_nop 1
    v_add_f32 v242, v242, v243
    v_rcp_f32 v244, v242
    s_nop 0
    v_mov_b32 v245, v244
    s_waitcnt lgkmcnt(4)
    v_mfma_f32_32x32x16_bf16 v[112:127], v[212:215], v[188:191], v[112:127]
    ds_read_b64_tr_b16 v[208:209], v220 offset:64
    ds_read_b64_tr_b16 v[210:211], v220 offset:4416
    v_mov_b32 v242, v229
    v_mov_b32 v243, v229
    s_nop 1
    v_permlane32_swap_b32 v242, v243
    s_nop 1
    v_add_f32 v242, v242, v243
    v_rcp_f32 v246, v242
    s_nop 0
    v_mov_b32 v247, v246
    s_waitcnt vmcnt(0)
    s_cmp_lg_u32 s30, 0
    s_cbranch_scc1 RESC_29
RBACK_29:
    s_waitcnt lgkmcnt(4)
    v_mfma_f32_32x32x16_bf16 a[0:15], v[200:203], v[192:195], a[0:15]
    ds_read_b64_tr_b16 v[212:213], v220 offset:8768
    ds_read_b64_tr_b16 v[214:215], v220 offset:13120
    s_waitcnt lgkmcnt(4)
    v_mfma_f32_32x32x16_bf16 a[0:15], v[204:207], v[196:199], a[0:15]
    ds_read_b64_tr_b16 v[200:201], v221 offset:128
    ds_read_b64_tr_b16 v[202:203], v221 offset:4480
    s_waitcnt lgkmcnt(4)
    v_mfma_f32_32x32x16_bf16 a[16:31], v[208:211], v[192:195], a[16:31]
    ds_read_b64_tr_b16 v[204:205], v221 offset:8832
    ds_read_b64_tr_b16 v[206:207], v221 offset:13184
    s_waitcnt lgkmcnt(4)
    v_mfma_f32_32x32x16_bf16 a[16:31], v[212:215], v[196:199], a[16:31]
    ds_read_b64_tr_b16 v[208:209], v221 offset:192
    ds_read_b64_tr_b16 v[210:211], v221 offset:4544
    v_pk_mul_f32 v[128:129], v[0:1], v[244:245]
    v_pk_mul_f32 v[130:131], v[2:3], v[244:245]
    v_pk_mul_f32 v[132:133], v[4:5], v[244:245]
    v_pk_mul_f32 v[134:135], v[6:7], v[244:245]
    v_cvt_pk_bf16_f32 v144, v128, v129
    s_waitcnt lgkmcnt(4)
    v_mfma_f32_32x32x16_bf16 a[32:47], v[200:203], v[192:195], a[32:47]
    ds_read_b64_tr_b16 v[212:213], v221 offset:8896
    ds_read_b64_tr_b16 v[214:215], v221 offset:13248
    v_cvt_pk_bf16_f32 v145, v130, v131
    v_cvt_pk_bf16_f32 v146, v132, v133
    v_cvt_pk_bf16_f32 v147, v134, v135
    ds_write_b128 v253, v[144:147] offset:0
    v_pk_mul_f32 v[136:137], v[8:9], v[244:245]
    s_waitcnt lgkmcnt(5)
    v_mfma_f32_32x32x16_bf16 a[32:47], v[204:207], v[196:199], a[32:47]
    ds_read_b64_tr_b16 v[200:201], v220 offset:256
    ds_read_b64_tr_b16 v[202:203], v220 offset:4608
    v_pk_mul_f32 v[138:139], v[10:11], v[244:245]
    v_pk_mul_f32 v[140:141], v[12:13], v[244:245]
    v_pk_mul_f32 v[142:143], v[14:15], v[244:245]
    v_cvt_pk_bf16_f32 v148, v136, v137
    v_cvt_pk_bf16_f32 v149, v138, v139
    s_waitcnt lgkmcnt(5)
    v_mfma_f32_32x32x16_bf16 a[48:63], v[208:211], v[192:195], a[48:63]
    ds_read_b64_tr_b16 v[204:205], v220 offset:8960
    ds_read_b64_tr_b16 v[206:207], v220 offset:13312
    v_cvt_pk_bf16_f32 v150, v140, v141
    v_cvt_pk_bf16_f32 v151, v142, v143
    ds_write_b128 v253, v[148:151] offset:16
    v_pk_mul_f32 v[128:129], v[16:17], v[244:245]
    v_pk_mul_f32 v[130:131], v[18:19], v[244:245]
    s_waitcnt lgkmcnt(6)
    v_mfma_f32_32x32x16_bf16 a[48:63], v[212:215], v[196:199], a[48:63]
    ds_read_b64_tr_b16 v[208:209], v220 offset:320
    ds_read_b64_tr_b16 v[210:211], v220 offset:4672
    v_pk_mul_f32 v[132:133], v[20:21], v[244:245]
    v_pk_mul_f32 v[134:135], v[22:23], v[244:245]
    v_cvt_pk_bf16_f32 v152, v128, v129
    v_cvt_pk_bf16_f32 v153, v130, v131
    v_cvt_pk_bf16_f32 v154, v132, v133
    s_waitcnt lgkmcnt(5)
    v_mfma_f32_32x32x16_bf16 a[64:79], v[200:203], v[192:195], a[64:79]
    ds_read_b64_tr_b16 v[212:213], v220 offset:9024
    ds_read_b64_tr_b16 v[214:215], v220 offset:13376
    v_cvt_pk_bf16_f32 v155, v134, v135
    ds_write_b128 v253, v[152:155] offset:64
    v_pk_mul_f32 v[136:137], v[24:25], v[244:245]
    v_pk_mul_f32 v[138:139], v[26:27], v[244:245]
    v_pk_mul_f32 v[140:141], v[28:29], v[244:245]
    s_waitcnt lgkmcnt(6)
    v_mfma_f32_32x32x16_bf16 a[64:79], v[204:207], v[196:199], a[64:79]
    ds_read_b64_tr_b16 v[200:201], v221 offset:384
    ds_read_b64_tr_b16 v[202:203], v221 offset:4736
    v_pk_mul_f32 v[142:143], v[30:31], v[244:245]
    v_cvt_pk_bf16_f32 v156, v136, v137
    v_cvt_pk_bf16_f32 v157, v138, v139
    v_cvt_pk_bf16_f32 v158, v140, v141
    v_cvt_pk_bf16_f32 v159, v142, v143
    s_waitcnt lgkmcnt(5)
    v_mfma_f32_32x32x16_bf16 a[80:95], v[208:211], v[192:195], a[80:95]
    ds_read_b64_tr_b16 v[204:205], v221 offset:9088
    ds_read_b64_tr_b16 v[206:207], v221 offset:13440
    ds_write_b128 v253, v[156:159] offset:80
    v_pk_mul_f32 v[128:129], v[32:33], v[244:245]
    v_pk_mul_f32 v[130:131], v[34:35], v[244:245]
    v_pk_mul_f32 v[132:133], v[36:37], v[244:245]
    v_pk_mul_f32 v[134:135], v[38:39], v[244:245]
    s_waitcnt lgkmcnt(6)
    v_mfma_f32_32x32x16_bf16 a[80:95], v[212:215], v[196:199], a[80:95]
    ds_read_b64_tr_b16 v[208:209], v221 offset:448
    ds_read_b64_tr_b16 v[210:211], v221 offset:4800
    v_cvt_pk_bf16_f32 v144, v128, v129
    v_cvt_pk_bf16_f32 v145, v130, v131
    v_cvt_pk_bf16_f32 v146, v132, v133
    v_cvt_pk_bf16_f32 v147, v134, v135
    ds_write_b128 v253, v[144:147] offset:128
    s_waitcnt lgkmcnt(6)
    v_mfma_f32_32x32x16_bf16 a[96:111], v[200:203], v[192:195], a[96:111]
    ds_read_b64_tr_b16 v[212:213], v221 offset:9152
    ds_read_b64_tr_b16 v[214:215], v221 offset:13504
    v_pk_mul_f32 v[136:137], v[40:41], v[244:245]
    v_pk_mul_f32 v[138:139], v[42:43], v[244:245]
    v_pk_mul_f32 v[140:141], v[44:45], v[244:245]
    v_pk_mul_f32 v[142:143], v[46:47], v[244:245]
    v_cvt_pk_bf16_f32 v148, v136, v137
    s_waitcnt lgkmcnt(6)
    v_mfma_f32_32x32x16_bf16 a[96:111], v[204:207], v[196:199], a[96:111]
    v_cvt_pk_bf16_f32 v149, v138, v139
    v_cvt_pk_bf16_f32 v150, v140, v141
    v_cvt_pk_bf16_f32 v151, v142, v143
    ds_write_b128 v253, v[148:151] offset:144
    v_pk_mul_f32 v[128:129], v[48:49], v[244:245]
    s_waitcnt lgkmcnt(4)
    v_mfma_f32_32x32x16_bf16 a[112:127], v[208:211], v[192:195], a[112:127]
    v_pk_mul_f32 v[130:131], v[50:51], v[244:245]
    v_pk_mul_f32 v[132:133], v[52:53], v[244:245]
    v_pk_mul_f32 v[134:135], v[54:55], v[244:245]
    v_cvt_pk_bf16_f32 v152, v128, v129
    v_cvt_pk_bf16_f32 v153, v130, v131
    s_waitcnt lgkmcnt(1)
    v_mfma_f32_32x32x16_bf16 a[112:127], v[212:215], v[196:199], a[112:127]
    v_cvt_pk_bf16_f32 v154, v132, v133
    v_cvt_pk_bf16_f32 v155, v134, v135
    ds_write_b128 v253, v[152:155] offset:192
    v_pk_mul_f32 v[136:137], v[56:57], v[244:245]
    v_pk_mul_f32 v[138:139], v[58:59], v[244:245]
    v_pk_mul_f32 v[140:141], v[60:61], v[244:245]
    v_pk_mul_f32 v[142:143], v[62:63], v[244:245]
    v_cvt_pk_bf16_f32 v156, v136, v137
    v_cvt_pk_bf16_f32 v157, v138, v139
    v_cvt_pk_bf16_f32 v158, v140, v141
    v_cvt_pk_bf16_f32 v159, v142, v143
    ds_write_b128 v253, v[156:159] offset:208
    v_pk_mul_f32 v[128:129], v[64:65], v[244:245]
    v_pk_mul_f32 v[130:131], v[66:67], v[244:245]
    v_pk_mul_f32 v[132:133], v[68:69], v[244:245]
    v_pk_mul_f32 v[134:135], v[70:71], v[244:245]
    v_cvt_pk_bf16_f32 v144, v128, v129
    v_cvt_pk_bf16_f32 v145, v130, v131
    v_cvt_pk_bf16_f32 v146, v132, v133
    v_cvt_pk_bf16_f32 v147, v134, v135
    ds_write_b128 v253, v[144:147] offset:256
    v_pk_mul_f32 v[136:137], v[72:73], v[244:245]
    v_pk_mul_f32 v[138:139], v[74:75], v[244:245]
    v_pk_mul_f32 v[140:141], v[76:77], v[244:245]
    v_pk_mul_f32 v[142:143], v[78:79], v[244:245]
    v_cvt_pk_bf16_f32 v148, v136, v137
    v_cvt_pk_bf16_f32 v149, v138, v139
    v_cvt_pk_bf16_f32 v150, v140, v141
    v_cvt_pk_bf16_f32 v151, v142, v143
    ds_write_b128 v253, v[148:151] offset:272
    v_pk_mul_f32 v[128:129], v[80:81], v[244:245]
    v_pk_mul_f32 v[130:131], v[82:83], v[244:245]
    v_pk_mul_f32 v[132:133], v[84:85], v[244:245]
    v_pk_mul_f32 v[134:135], v[86:87], v[244:245]
    v_cvt_pk_bf16_f32 v152, v128, v129
    v_cvt_pk_bf16_f32 v153, v130, v131
    v_cvt_pk_bf16_f32 v154, v132, v133
    v_cvt_pk_bf16_f32 v155, v134, v135
    ds_write_b128 v253, v[152:155] offset:320
    v_pk_mul_f32 v[136:137], v[88:89], v[244:245]
    v_pk_mul_f32 v[138:139], v[90:91], v[244:245]
    v_pk_mul_f32 v[140:141], v[92:93], v[244:245]
    v_pk_mul_f32 v[142:143], v[94:95], v[244:245]
    v_cvt_pk_bf16_f32 v156, v136, v137
    v_cvt_pk_bf16_f32 v157, v138, v139
    v_cvt_pk_bf16_f32 v158, v140, v141
    v_cvt_pk_bf16_f32 v159, v142, v143
    ds_write_b128 v253, v[156:159] offset:336
    v_pk_mul_f32 v[128:129], v[96:97], v[244:245]
    v_pk_mul_f32 v[130:131], v[98:99], v[244:245]
    v_pk_mul_f32 v[132:133], v[100:101], v[244:245]
    v_pk_mul_f32 v[134:135], v[102:103], v[244:245]
    v_cvt_pk_bf16_f32 v144, v128, v129
    v_cvt_pk_bf16_f32 v145, v130, v131
    v_cvt_pk_bf16_f32 v146, v132, v133
    v_cvt_pk_bf16_f32 v147, v134, v135
    ds_write_b128 v253, v[144:147] offset:384
    v_pk_mul_f32 v[136:137], v[104:105], v[244:245]
    v_pk_mul_f32 v[138:139], v[106:107], v[244:245]
    v_pk_mul_f32 v[140:141], v[108:109], v[244:245]
    v_pk_mul_f32 v[142:143], v[110:111], v[244:245]
    v_cvt_pk_bf16_f32 v148, v136, v137
    v_cvt_pk_bf16_f32 v149, v138, v139
    v_cvt_pk_bf16_f32 v150, v140, v141
    v_cvt_pk_bf16_f32 v151, v142, v143
    ds_write_b128 v253, v[148:151] offset:400
    v_pk_mul_f32 v[128:129], v[112:113], v[244:245]
    v_pk_mul_f32 v[130:131], v[114:115], v[244:245]
    v_pk_mul_f32 v[132:133], v[116:117], v[244:245]
    v_pk_mul_f32 v[134:135], v[118:119], v[244:245]
    v_cvt_pk_bf16_f32 v152, v128, v129
    v_cvt_pk_bf16_f32 v153, v130, v131
    v_cvt_pk_bf16_f32 v154, v132, v133
    v_cvt_pk_bf16_f32 v155, v134, v135
    ds_write_b128 v253, v[152:155] offset:448
    v_pk_mul_f32 v[136:137], v[120:121], v[244:245]
    v_pk_mul_f32 v[138:139], v[122:123], v[244:245]
    v_pk_mul_f32 v[140:141], v[124:125], v[244:245]
    v_pk_mul_f32 v[142:143], v[126:127], v[244:245]
    v_cvt_pk_bf16_f32 v156, v136, v137
    v_cvt_pk_bf16_f32 v157, v138, v139
    v_cvt_pk_bf16_f32 v158, v140, v141
    v_cvt_pk_bf16_f32 v159, v142, v143
    ds_write_b128 v253, v[156:159] offset:464
    v_accvgpr_read_b32 v128, a0
    v_accvgpr_read_b32 v129, a1
    v_accvgpr_read_b32 v130, a2
    v_accvgpr_read_b32 v131, a3
    v_accvgpr_read_b32 v132, a4
    v_accvgpr_read_b32 v133, a5
    s_add_u32 s38, s52, 0
    v_add_u32 v248, s38, v255
    v_accvgpr_read_b32 v134, a6
    v_accvgpr_read_b32 v135, a7
    v_pk_mul_f32 v[128:129], v[128:129], v[246:247]
    v_pk_mul_f32 v[130:131], v[130:131], v[246:247]
    v_pk_mul_f32 v[132:133], v[132:133], v[246:247]
    v_pk_mul_f32 v[134:135], v[134:135], v[246:247]
    ds_read_b128 v[160:163], v248 offset:0
    v_cvt_pk_bf16_f32 v144, v128, v129
    v_cvt_pk_bf16_f32 v145, v130, v131
    v_cvt_pk_bf16_f32 v146, v132, v133
    v_cvt_pk_bf16_f32 v147, v134, v135
    ds_write_b128 v254, v[144:147] offset:0
    v_accvgpr_read_b32 v136, a8
    ds_read_b128 v[164:167], v248 offset:1056
    v_accvgpr_read_b32 v137, a9
    v_accvgpr_read_b32 v138, a10
    v_accvgpr_read_b32 v139, a11
    v_accvgpr_read_b32 v140, a12
    v_accvgpr_read_b32 v141, a13
    v_accvgpr_read_b32 v142, a14
    ds_read_b128 v[168:171], v248 offset:2112
    v_accvgpr_read_b32 v143, a15
    v_pk_mul_f32 v[136:137], v[136:137], v[246:247]
    v_pk_mul_f32 v[138:139], v[138:139], v[246:247]
    v_pk_mul_f32 v[140:141], v[140:141], v[246:247]
    v_pk_mul_f32 v[142:143], v[142:143], v[246:247]
    v_cvt_pk_bf16_f32 v148, v136, v137
    ds_read_b128 v[172:175], v248 offset:3168
    v_cvt_pk_bf16_f32 v149, v138, v139
    v_cvt_pk_bf16_f32 v150, v140, v141
    v_cvt_pk_bf16_f32 v151, v142, v143
    ds_write_b128 v254, v[148:151] offset:16
    v_accvgpr_read_b32 v128, a16
    v_accvgpr_read_b32 v129, a17
    s_waitcnt lgkmcnt(5)
    v_accvgpr_read_b32 v130, a18
    v_accvgpr_read_b32 v131, a19
    v_accvgpr_read_b32 v132, a20
    v_accvgpr_read_b32 v133, a21
    v_accvgpr_read_b32 v134, a22
    v_accvgpr_read_b32 v135, a23
    s_add_u32 s37, s31, 0
    v_pk_mul_f32 v[128:129], v[128:129], v[246:247]
    v_pk_mul_f32 v[130:131], v[130:131], v[246:247]
    v_pk_mul_f32 v[132:133], v[132:133], v[246:247]
    v_pk_mul_f32 v[134:135], v[134:135], v[246:247]
    v_cvt_pk_bf16_f32 v152, v128, v129
    v_cvt_pk_bf16_f32 v153, v130, v131
    buffer_store_dwordx4 v[160:163], v233, s[16:19], s37 offen offset:0
    v_cvt_pk_bf16_f32 v154, v132, v133
    v_cvt_pk_bf16_f32 v155, v134, v135
    ds_write_b128 v254, v[152:155] offset:64
    v_accvgpr_read_b32 v136, a24
    v_accvgpr_read_b32 v137, a25
    v_accvgpr_read_b32 v138, a26
    s_add_u32 s38, s52, 16896
    v_add_u32 v248, s38, v255
    v_accvgpr_read_b32 v139, a27
    v_accvgpr_read_b32 v140, a28
    v_accvgpr_read_b32 v141, a29
    v_accvgpr_read_b32 v142, a30
    v_accvgpr_read_b32 v143, a31
    v_pk_mul_f32 v[136:137], v[136:137], v[246:247]
    ds_read_b128 v[176:179], v248 offset:0
    v_pk_mul_f32 v[138:139], v[138:139], v[246:247]
    v_pk_mul_f32 v[140:141], v[140:141], v[246:247]
    v_pk_mul_f32 v[142:143], v[142:143], v[246:247]
    v_cvt_pk_bf16_f32 v156, v136, v137
    v_cvt_pk_bf16_f32 v157, v138, v139
    v_cvt_pk_bf16_f32 v158, v140, v141
    s_waitcnt lgkmcnt(5)
    v_cvt_pk_bf16_f32 v159, v142, v143
    ds_write_b128 v254, v[156:159] offset:80
    v_accvgpr_read_b32 v128, a32
    v_accvgpr_read_b32 v129, a33
    v_accvgpr_read_b32 v130, a34
    v_accvgpr_read_b32 v131, a35
    buffer_store_dwordx4 v[164:167], v233, s[16:19], s37 offen offset:1024
    v_accvgpr_read_b32 v132, a36
    v_accvgpr_read_b32 v133, a37
    v_accvgpr_read_b32 v134, a38
    v_accvgpr_read_b32 v135, a39
    v_pk_mul_f32 v[128:129], v[128:129], v[246:247]
    v_pk_mul_f32 v[130:131], v[130:131], v[246:247]
    ds_read_b128 v[180:183], v248 offset:1056
    v_pk_mul_f32 v[132:133], v[132:133], v[246:247]
    v_pk_mul_f32 v[134:135], v[134:135], v[246:247]
    v_cvt_pk_bf16_f32 v144, v128, v129
    v_cvt_pk_bf16_f32 v145, v130, v131
    v_cvt_pk_bf16_f32 v146, v132, v133
    v_cvt_pk_bf16_f32 v147, v134, v135
    s_waitcnt lgkmcnt(6)
    ds_write_b128 v254, v[144:147] offset:128
    v_accvgpr_read_b32 v136, a40
    v_accvgpr_read_b32 v137, a41
    v_accvgpr_read_b32 v138, a42
    v_accvgpr_read_b32 v139, a43
    v_accvgpr_read_b32 v140, a44
    buffer_store_dwordx4 v[168:171], v233, s[16:19], s37 offen offset:2048
    v_accvgpr_read_b32 v141, a45
    v_accvgpr_read_b32 v142, a46
    v_accvgpr_read_b32 v143, a47
    v_pk_mul_f32 v[136:137], v[136:137], v[246:247]
    v_pk_mul_f32 v[138:139], v[138:139], v[246:247]
    v_pk_mul_f32 v[140:141], v[140:141], v[246:247]
    ds_read_b128 v[184:187], v248 offset:2112
    v_pk_mul_f32 v[142:143], v[142:143], v[246:247]
    v_cvt_pk_bf16_f32 v148, v136, v137
    v_cvt_pk_bf16_f32 v149, v138, v139
    v_cvt_pk_bf16_f32 v150, v140, v141
    v_cvt_pk_bf16_f32 v151, v142, v143
    ds_write_b128 v254, v[148:151] offset:144
    s_waitcnt lgkmcnt(8)
    v_accvgpr_read_b32 v128, a48
    v_accvgpr_read_b32 v129, a49
    v_accvgpr_read_b32 v130, a50
    v_accvgpr_read_b32 v131, a51
    v_accvgpr_read_b32 v132, a52
    v_accvgpr_read_b32 v133, a53
    buffer_store_dwordx4 v[172:175], v233, s[16:19], s37 offen offset:3072
    v_accvgpr_read_b32 v134, a54
    v_accvgpr_read_b32 v135, a55
    v_pk_mul_f32 v[128:129], v[128:129], v[246:247]
    v_pk_mul_f32 v[130:131], v[130:131], v[246:247]
    v_pk_mul_f32 v[132:133], v[132:133], v[246:247]
    v_pk_mul_f32 v[134:135], v[134:135], v[246:247]
    ds_read_b128 v[188:191], v248 offset:3168
    v_cvt_pk_bf16_f32 v152, v128, v129
    v_cvt_pk_bf16_f32 v153, v130, v131
    v_cvt_pk_bf16_f32 v154, v132, v133
    v_cvt_pk_bf16_f32 v155, v134, v135
    ds_write_b128 v254, v[152:155] offset:192
    v_accvgpr_read_b32 v136, a56
    s_waitcnt lgkmcnt(7)
    v_accvgpr_read_b32 v137, a57
    v_accvgpr_read_b32 v138, a58
    v_accvgpr_read_b32 v139, a59
    v_accvgpr_read_b32 v140, a60
    v_accvgpr_read_b32 v141, a61
    v_accvgpr_read_b32 v142, a62
    s_add_u32 s37, s31, 4096
    v_accvgpr_read_b32 v143, a63
    v_pk_mul_f32 v[136:137], v[136:137], v[246:247]
    v_pk_mul_f32 v[138:139], v[138:139], v[246:247]
    v_pk_mul_f32 v[140:141], v[140:141], v[246:247]
    v_pk_mul_f32 v[142:143], v[142:143], v[246:247]
    v_cvt_pk_bf16_f32 v156, v136, v137
    buffer_store_dwordx4 v[176:179], v233, s[16:19], s37 offen offset:0
    v_cvt_pk_bf16_f32 v157, v138, v139
    v_cvt_pk_bf16_f32 v158, v140, v141
    v_cvt_pk_bf16_f32 v159, v142, v143
    ds_write_b128 v254, v[156:159] offset:208
    v_accvgpr_read_b32 v128, a64
    v_accvgpr_read_b32 v129, a65
    s_add_u32 s38, s52, 33792
    v_add_u32 v248, s38, v255
    v_accvgpr_read_b32 v130, a66
    v_accvgpr_read_b32 v131, a67
    v_accvgpr_read_b32 v132, a68
    v_accvgpr_read_b32 v133, a69
    v_accvgpr_read_b32 v134, a70
    v_accvgpr_read_b32 v135, a71
    ds_read_b128 v[160:163], v248 offset:0
    v_pk_mul_f32 v[128:129], v[128:129], v[246:247]
    v_pk_mul_f32 v[130:131], v[130:131], v[246:247]
    v_pk_mul_f32 v[132:133], v[132:133], v[246:247]
    v_pk_mul_f32 v[134:135], v[134:135], v[246:247]
    v_cvt_pk_bf16_f32 v144, v128, v129
    v_cvt_pk_bf16_f32 v145, v130, v131
    s_waitcnt lgkmcnt(7)
    v_cvt_pk_bf16_f32 v146, v132, v133
    v_cvt_pk_bf16_f32 v147, v134, v135
    ds_write_b128 v254, v[144:147] offset:256
    v_accvgpr_read_b32 v136, a72
    v_accvgpr_read_b32 v137, a73
    v_accvgpr_read_b32 v138, a74
    buffer_store_dwordx4 v[180:183], v233, s[16:19], s37 offen offset:1024
    v_accvgpr_read_b32 v139, a75
    v_accvgpr_read_b32 v140, a76
    v_accvgpr_read_b32 v141, a77
    v_accvgpr_read_b32 v142, a78
    v_accvgpr_read_b32 v143, a79
    v_pk_mul_f32 v[136:137], v[136:137], v[246:247]
    ds_read_b128 v[164:167], v248 offset:1056
    v_pk_mul_f32 v[138:139], v[138:139], v[246:247]
    v_pk_mul_f32 v[140:141], v[140:141], v[246:247]
    v_pk_mul_f32 v[142:143], v[142:143], v[246:247]
    v_cvt_pk_bf16_f32 v148, v136, v137
    v_cvt_pk_bf16_f32 v149, v138, v139
    v_cvt_pk_bf16_f32 v150, v140, v141
    s_waitcnt lgkmcnt(7)
    v_cvt_pk_bf16_f32 v151, v142, v143
    ds_write_b128 v254, v[148:151] offset:272
    v_accvgpr_read_b32 v128, a80
    v_accvgpr_read_b32 v129, a81
    v_accvgpr_read_b32 v130, a82
    v_accvgpr_read_b32 v131, a83
    buffer_store_dwordx4 v[184:187], v233, s[16:19], s37 offen offset:2048
    v_accvgpr_read_b32 v132, a84
    v_accvgpr_read_b32 v133, a85
    v_accvgpr_read_b32 v134, a86
    v_accvgpr_read_b32 v135, a87
    v_pk_mul_f32 v[128:129], v[128:129], v[246:247]
    v_pk_mul_f32 v[130:131], v[130:131], v[246:247]
    ds_read_b128 v[168:171], v248 offset:2112
    v_pk_mul_f32 v[132:133], v[132:133], v[246:247]
    v_pk_mul_f32 v[134:135], v[134:135], v[246:247]
    v_cvt_pk_bf16_f32 v152, v128, v129
    v_cvt_pk_bf16_f32 v153, v130, v131
    v_cvt_pk_bf16_f32 v154, v132, v133
    v_cvt_pk_bf16_f32 v155, v134, v135
    s_waitcnt lgkmcnt(7)
    ds_write_b128 v254, v[152:155] offset:320
    v_accvgpr_read_b32 v136, a88
    v_accvgpr_read_b32 v137, a89
    v_accvgpr_read_b32 v138, a90
    v_accvgpr_read_b32 v139, a91
    v_accvgpr_read_b32 v140, a92
    buffer_store_dwordx4 v[188:191], v233, s[16:19], s37 offen offset:3072
    v_accvgpr_read_b32 v141, a93
    v_accvgpr_read_b32 v142, a94
    v_accvgpr_read_b32 v143, a95
    v_pk_mul_f32 v[136:137], v[136:137], v[246:247]
    v_pk_mul_f32 v[138:139], v[138:139], v[246:247]
    v_pk_mul_f32 v[140:141], v[140:141], v[246:247]
    ds_read_b128 v[172:175], v248 offset:3168
    v_pk_mul_f32 v[142:143], v[142:143], v[246:247]
    v_cvt_pk_bf16_f32 v156, v136, v137
    v_cvt_pk_bf16_f32 v157, v138, v139
    v_cvt_pk_bf16_f32 v158, v140, v141
    v_cvt_pk_bf16_f32 v159, v142, v143
    ds_write_b128 v254, v[156:159] offset:336
    s_waitcnt lgkmcnt(7)
    v_accvgpr_read_b32 v128, a96
    v_accvgpr_read_b32 v129, a97
    v_accvgpr_read_b32 v130, a98
    v_accvgpr_read_b32 v131, a99
    v_accvgpr_read_b32 v132, a100
    v_accvgpr_read_b32 v133, a101
    s_add_u32 s37, s31, 8192
    v_accvgpr_read_b32 v134, a102
    v_accvgpr_read_b32 v135, a103
    v_pk_mul_f32 v[128:129], v[128:129], v[246:247]
    v_pk_mul_f32 v[130:131], v[130:131], v[246:247]
    v_pk_mul_f32 v[132:133], v[132:133], v[246:247]
    v_pk_mul_f32 v[134:135], v[134:135], v[246:247]
    buffer_store_dwordx4 v[160:163], v233, s[16:19], s37 offen offset:0
    v_cvt_pk_bf16_f32 v144, v128, v129
    v_cvt_pk_bf16_f32 v145, v130, v131
    v_cvt_pk_bf16_f32 v146, v132, v133
    v_cvt_pk_bf16_f32 v147, v134, v135
    ds_write_b128 v254, v[144:147] offset:384
    v_accvgpr_read_b32 v136, a104
    s_add_u32 s38, s52, 50688
    v_add_u32 v248, s38, v255
    v_accvgpr_read_b32 v137, a105
    v_accvgpr_read_b32 v138, a106
    v_accvgpr_read_b32 v139, a107
    v_accvgpr_read_b32 v140, a108
    v_accvgpr_read_b32 v141, a109
    v_accvgpr_read_b32 v142, a110
    ds_read_b128 v[176:179], v248 offset:0
    v_accvgpr_read_b32 v143, a111
    v_pk_mul_f32 v[136:137], v[136:137], v[246:247]
    v_pk_mul_f32 v[138:139], v[138:139], v[246:247]
    v_pk_mul_f32 v[140:141], v[140:141], v[246:247]
    v_pk_mul_f32 v[142:143], v[142:143], v[246:247]
    v_cvt_pk_bf16_f32 v148, v136, v137
    s_waitcnt lgkmcnt(7)
    v_cvt_pk_bf16_f32 v149, v138, v139
    v_cvt_pk_bf16_f32 v150, v140, v141
    v_cvt_pk_bf16_f32 v151, v142, v143
    ds_write_b128 v254, v[148:151] offset:400
    v_accvgpr_read_b32 v128, a112
    v_accvgpr_read_b32 v129, a113
    buffer_store_dwordx4 v[164:167], v233, s[16:19], s37 offen offset:1024
    v_accvgpr_read_b32 v130, a114
    v_accvgpr_read_b32 v131, a115
    v_accvgpr_read_b32 v132, a116
    v_accvgpr_read_b32 v133, a117
    v_accvgpr_read_b32 v134, a118
    v_accvgpr_read_b32 v135, a119
    ds_read_b128 v[180:183], v248 offset:1056
    v_pk_mul_f32 v[128:129], v[128:129], v[246:247]
    v_pk_mul_f32 v[130:131], v[130:131], v[246:247]
    v_pk_mul_f32 v[132:133], v[132:133], v[246:247]
    v_pk_mul_f32 v[134:135], v[134:135], v[246:247]
    v_cvt_pk_bf16_f32 v152, v128, v129
    v_cvt_pk_bf16_f32 v153, v130, v131
    s_waitcnt lgkmcnt(7)
    v_cvt_pk_bf16_f32 v154, v132, v133
    v_cvt_pk_bf16_f32 v155, v134, v135
    ds_write_b128 v254, v[152:155] offset:448
    v_accvgpr_read_b32 v136, a120
    v_accvgpr_read_b32 v137, a121
    v_accvgpr_read_b32 v138, a122
    buffer_store_dwordx4 v[168:171], v233, s[16:19], s37 offen offset:2048
    v_accvgpr_read_b32 v139, a123
    v_accvgpr_read_b32 v140, a124
    v_accvgpr_read_b32 v141, a125
    v_accvgpr_read_b32 v142, a126
    v_accvgpr_read_b32 v143, a127
    v_pk_mul_f32 v[136:137], v[136:137], v[246:247]
    ds_read_b128 v[184:187], v248 offset:2112
    v_pk_mul_f32 v[138:139], v[138:139], v[246:247]
    v_pk_mul_f32 v[140:141], v[140:141], v[246:247]
    v_pk_mul_f32 v[142:143], v[142:143], v[246:247]
    v_cvt_pk_bf16_f32 v156, v136, v137
    v_cvt_pk_bf16_f32 v157, v138, v139
    v_cvt_pk_bf16_f32 v158, v140, v141
    s_waitcnt lgkmcnt(7)
    v_cvt_pk_bf16_f32 v159, v142, v143
    ds_write_b128 v254, v[156:159] offset:464
    buffer_store_dwordx4 v[172:175], v233, s[16:19], s37 offen offset:3072
    ds_read_b128 v[188:191], v248 offset:3168
    s_waitcnt lgkmcnt(6)
    s_add_u32 s37, s31, 12288
    buffer_store_dwordx4 v[176:179], v233, s[16:19], s37 offen offset:0
    s_waitcnt lgkmcnt(4)
    buffer_store_dwordx4 v[180:183], v233, s[16:19], s37 offen offset:1024
    s_waitcnt lgkmcnt(2)
    buffer_store_dwordx4 v[184:187], v233, s[16:19], s37 offen offset:2048
    s_waitcnt lgkmcnt(0)
    buffer_store_dwordx4 v[188:191], v233, s[16:19], s37 offen offset:3072
    s_add_u32 s38, s53, 67584
    v_add_u32 v249, s38, v255
    ds_read_b128 v[160:163], v249 offset:0
    ds_read_b128 v[164:167], v249 offset:1056
    ds_read_b128 v[168:171], v249 offset:2112
    ds_read_b128 v[172:175], v249 offset:3168
    s_waitcnt lgkmcnt(3)
    s_add_u32 s37, s32, 0
    buffer_store_dwordx4 v[160:163], v233, s[16:19], s37 offen offset:0
    s_add_u32 s38, s53, 102400
    v_add_u32 v249, s38, v255
    ds_read_b128 v[176:179], v249 offset:0
    s_waitcnt lgkmcnt(3)
    buffer_store_dwordx4 v[164:167], v233, s[16:19], s37 offen offset:1024
    ds_read_b128 v[180:183], v249 offset:1056
    s_waitcnt lgkmcnt(3)
    buffer_store_dwordx4 v[168:171], v233, s[16:19], s37 offen offset:2048
    ds_read_b128 v[184:187], v249 offset:2112
    s_waitcnt lgkmcnt(3)
    buffer_store_dwordx4 v[172:175], v233, s[16:19], s37 offen offset:3072
    ds_read_b128 v[188:191], v249 offset:3168
    s_waitcnt lgkmcnt(3)
    s_add_u32 s37, s32, 4096
    buffer_store_dwordx4 v[176:179], v233, s[16:19], s37 offen offset:0
    s_add_u32 s38, s53, 119808
    v_add_u32 v249, s38, v255
    ds_read_b128 v[160:163], v249 offset:0
    s_waitcnt lgkmcnt(3)
    buffer_store_dwordx4 v[180:183], v233, s[16:19], s37 offen offset:1024
    ds_read_b128 v[164:167], v249 offset:1056
    s_waitcnt lgkmcnt(3)
    buffer_store_dwordx4 v[184:187], v233, s[16:19], s37 offen offset:2048
    ds_read_b128 v[168:171], v249 offset:2112
    s_waitcnt lgkmcnt(3)
    buffer_store_dwordx4 v[188:191], v233, s[16:19], s37 offen offset:3072
    ds_read_b128 v[172:175], v249 offset:3168
    s_waitcnt lgkmcnt(3)
    s_add_u32 s37, s32, 8192
    buffer_store_dwordx4 v[160:163], v233, s[16:19], s37 offen offset:0
    s_add_u32 s38, s53, 137216
    v_add_u32 v249, s38, v255
    ds_read_b128 v[176:179], v249 offset:0
    s_waitcnt lgkmcnt(3)
    buffer_store_dwordx4 v[164:167], v233, s[16:19], s37 offen offset:1024
    ds_read_b128 v[180:183], v249 offset:1056
    s_waitcnt lgkmcnt(3)
    buffer_store_dwordx4 v[168:171], v233, s[16:19], s37 offen offset:2048
    ds_read_b128 v[184:187], v249 offset:2112
    s_waitcnt lgkmcnt(3)
    buffer_store_dwordx4 v[172:175], v233, s[16:19], s37 offen offset:3072
    ds_read_b128 v[188:191], v249 offset:3168
    s_waitcnt lgkmcnt(3)
    s_add_u32 s37, s32, 12288
    buffer_store_dwordx4 v[176:179], v233, s[16:19], s37 offen offset:0
    s_waitcnt lgkmcnt(2)
    buffer_store_dwordx4 v[180:183], v233, s[16:19], s37 offen offset:1024
    s_waitcnt lgkmcnt(1)
    buffer_store_dwordx4 v[184:187], v233, s[16:19], s37 offen offset:2048
    s_waitcnt lgkmcnt(0)
    buffer_store_dwordx4 v[188:191], v233, s[16:19], s37 offen offset:3072
DONE:
EXIT:
    s_endpgm
RARE_3:
    v_max3_f32 v242, v128, v129, v130
    v_max3_f32 v243, v131, v132, v133
    v_max3_f32 v242, v242, v134, v135
    v_max3_f32 v243, v243, v136, v137
    v_max3_f32 v242, v242, v138, v139
    v_max3_f32 v243, v243, v140, v141
    v_max3_f32 v242, v242, v142, v143
    v_max_f32 v242, v242, v243
    v_mov_b32 v243, v242
    s_nop 1
    v_permlane32_swap_b32 v242, v243
    s_nop 1
    v_max_f32 v242, v242, v243
    v_mul_f32 v242, s20, v242
    v_max_f32_e64 v242, v242, -v226
    v_add_f32 v243, v226, v242
    v_exp_f32_e64 v243, -v243
    v_sub_f32 v226, 0, v242
    v_mul_f32 v228, v228, v243
    v_mul_f32 v230, v230, v243
    s_mov_b32 s30, 1
    v_fma_f32 v234, v128, s20, v226
    v_fma_f32 v235, v129, s20, v226
    v_exp_f32 v234, v234
    v_fma_f32 v236, v130, s20, v226
    v_exp_f32 v235, v235
    v_fma_f32 v237, v131, s20, v226
    v_exp_f32 v236, v236
    v_mov_b32 v232, v234
    v_fma_f32 v238, v132, s20, v226
    v_exp_f32 v237, v237
    v_mov_b32 v233, v235
    v_cvt_pk_bf16_f32 v184, v234, v235
    v_fma_f32 v239, v133, s20, v226
    v_exp_f32 v238, v238
    v_add_f32 v232, v232, v236
    v_fma_f32 v240, v134, s20, v226
    v_exp_f32 v239, v239
    v_add_f32 v233, v233, v237
    v_cvt_pk_bf16_f32 v185, v236, v237
    v_fma_f32 v241, v135, s20, v226
    v_exp_f32 v240, v240
    v_add_f32 v232, v232, v238
    v_fma_f32 v234, v136, s20, v226
    v_exp_f32 v241, v241
    v_add_f32 v233, v233, v239
    v_cvt_pk_bf16_f32 v186, v238, v239
    v_fma_f32 v235, v137, s20, v226
    v_exp_f32 v234, v234
    v_add_f32 v232, v232, v240
    v_fma_f32 v236, v138, s20, v226
    v_exp_f32 v235, v235
    v_add_f32 v233, v233, v241
    v_cvt_pk_bf16_f32 v187, v240, v241
    v_fma_f32 v237, v139, s20, v226
    v_exp_f32 v236, v236
    v_add_f32 v232, v232, v234
    v_fma_f32 v238, v140, s20, v226
    v_exp_f32 v237, v237
    v_add_f32 v233, v233, v235
    v_cvt_pk_bf16_f32 v188, v234, v235
    v_fma_f32 v239, v141, s20, v226
    v_exp_f32 v238, v238
    v_add_f32 v232, v232, v236
    v_fma_f32 v240, v142, s20, v226
    v_exp_f32 v239, v239
    v_add_f32 v233, v233, v237
    v_cvt_pk_bf16_f32 v189, v236, v237
    v_fma_f32 v241, v143, s20, v226
    v_exp_f32 v240, v240
    v_add_f32 v232, v232, v238
    v_exp_f32 v241, v241
    v_add_f32 v233, v233, v239
    v_cvt_pk_bf16_f32 v190, v238, v239
    v_add_f32 v232, v232, v240
    v_add_f32 v233, v233, v241
    v_cvt_pk_bf16_f32 v191, v240, v241
    v_add_f32 v232, v232, v233
    s_branch BACK_3
RARE_4:
    v_max3_f32 v242, v160, v161, v162
    v_max3_f32 v243, v163, v164, v165
    v_max3_f32 v242, v242, v166, v167
    v_max3_f32 v243, v243, v168, v169
    v_max3_f32 v242, v242, v170, v171
    v_max3_f32 v243, v243, v172, v173
    v_max3_f32 v242, v242, v174, v175
    v_max_f32 v242, v242, v243
    v_mov_b32 v243, v242
    s_nop 1
    v_permlane32_swap_b32 v242, v243
    s_nop 1
    v_max_f32 v242, v242, v243
    v_mul_f32 v242, s20, v242
    v_max_f32_e64 v242, v242, -v227
    v_add_f32 v243, v227, v242
    v_exp_f32_e64 v243, -v243
    v_sub_f32 v227, 0, v242
    v_mul_f32 v229, v229, v243
    v_mul_f32 v231, v231, v243
    s_mov_b32 s30, 1
    v_fma_f32 v234, v160, s20, v227
    v_fma_f32 v235, v161, s20, v227
    v_exp_f32 v234, v234
    v_fma_f32 v236, v162, s20, v227
    v_exp_f32 v235, v235
    v_fma_f32 v237, v163, s20, v227
    v_exp_f32 v236, v236
    v_mov_b32 v232, v234
    v_fma_f32 v238, v164, s20, v227
    v_exp_f32 v237, v237
    v_mov_b32 v233, v235
    v_cvt_pk_bf16_f32 v192, v234, v235
    v_fma_f32 v239, v165, s20, v227
    v_exp_f32 v238, v238
    v_add_f32 v232, v232, v236
    v_fma_f32 v240, v166, s20, v227
    v_exp_f32 v239, v239
    v_add_f32 v233, v233, v237
    v_cvt_pk_bf16_f32 v193, v236, v237
    v_fma_f32 v241, v167, s20, v227
    v_exp_f32 v240, v240
    v_add_f32 v232, v232, v238
    v_fma_f32 v234, v168, s20, v227
    v_exp_f32 v241, v241
    v_add_f32 v233, v233, v239
    v_cvt_pk_bf16_f32 v194, v238, v239
    v_fma_f32 v235, v169, s20, v227
    v_exp_f32 v234, v234
    v_add_f32 v232, v232, v240
    v_fma_f32 v236, v170, s20, v227
    v_exp_f32 v235, v235
    v_add_f32 v233, v233, v241
    v_cvt_pk_bf16_f32 v195, v240, v241
    v_fma_f32 v237, v171, s20, v227
    v_exp_f32 v236, v236
    v_add_f32 v232, v232, v234
    v_fma_f32 v238, v172, s20, v227
    v_exp_f32 v237, v237
    v_add_f32 v233, v233, v235
    v_cvt_pk_bf16_f32 v196, v234, v235
    v_fma_f32 v239, v173, s20, v227
    v_exp_f32 v238, v238
    v_add_f32 v232, v232, v236
    v_fma_f32 v240, v174, s20, v227
    v_exp_f32 v239, v239
    v_add_f32 v233, v233, v237
    v_cvt_pk_bf16_f32 v197, v236, v237
    v_fma_f32 v241, v175, s20, v227
    v_exp_f32 v240, v240
    v_add_f32 v232, v232, v238
    v_exp_f32 v241, v241
    v_add_f32 v233, v233, v239
    v_cvt_pk_bf16_f32 v198, v238, v239
    v_add_f32 v232, v232, v240
    v_add_f32 v233, v233, v241
    v_cvt_pk_bf16_f32 v199, v240, v241
    v_add_f32 v232, v232, v233
    s_branch BACK_4
RESC_5:
    s_nop 7
    s_nop 7
    v_mul_f32 v0, v0, v230
    v_mul_f32 v1, v1, v230
    v_mul_f32 v2, v2, v230
    v_mul_f32 v3, v3, v230
    v_mul_f32 v4, v4, v230
    v_mul_f32 v5, v5, v230
    v_mul_f32 v6, v6, v230
    v_mul_f32 v7, v7, v230
    v_mul_f32 v8, v8, v230
    v_mul_f32 v9, v9, v230
    v_mul_f32 v10, v10, v230
    v_mul_f32 v11, v11, v230
    v_mul_f32 v12, v12, v230
    v_mul_f32 v13, v13, v230
    v_mul_f32 v14, v14, v230
    v_mul_f32 v15, v15, v230
    v_mul_f32 v16, v16, v230
    v_mul_f32 v17, v17, v230
    v_mul_f32 v18, v18, v230
    v_mul_f32 v19, v19, v230
    v_mul_f32 v20, v20, v230
    v_mul_f32 v21, v21, v230
    v_mul_f32 v22, v22, v230
    v_mul_f32 v23, v23, v230
    v_mul_f32 v24, v24, v230
    v_mul_f32 v25, v25, v230
    v_mul_f32 v26, v26, v230
    v_mul_f32 v27, v27, v230
    v_mul_f32 v28, v28, v230
    v_mul_f32 v29, v29, v230
    v_mul_f32 v30, v30, v230
    v_mul_f32 v31, v31, v230
    v_mul_f32 v32, v32, v230
    v_mul_f32 v33, v33, v230
    v_mul_f32 v34, v34, v230
    v_mul_f32 v35, v35, v230
    v_mul_f32 v36, v36, v230
    v_mul_f32 v37, v37, v230
    v_mul_f32 v38, v38, v230
    v_mul_f32 v39, v39, v230
    v_mul_f32 v40, v40, v230
    v_mul_f32 v41, v41, v230
    v_mul_f32 v42, v42, v230
    v_mul_f32 v43, v43, v230
    v_mul_f32 v44, v44, v230
    v_mul_f32 v45, v45, v230
    v_mul_f32 v46, v46, v230
    v_mul_f32 v47, v47, v230
    v_mul_f32 v48, v48, v230
    v_mul_f32 v49, v49, v230
    v_mul_f32 v50, v50, v230
    v_mul_f32 v51, v51, v230
    v_mul_f32 v52, v52, v230
    v_mul_f32 v53, v53, v230
    v_mul_f32 v54, v54, v230
    v_mul_f32 v55, v55, v230
    v_mul_f32 v56, v56, v230
    v_mul_f32 v57, v57, v230
    v_mul_f32 v58, v58, v230
    v_mul_f32 v59, v59, v230
    v_mul_f32 v60, v60, v230
    v_mul_f32 v61, v61, v230
    v_mul_f32 v62, v62, v230
    v_mul_f32 v63, v63, v230
    v_mul_f32 v64, v64, v230
    v_mul_f32 v65, v65, v230
    v_mul_f32 v66, v66, v230
    v_mul_f32 v67, v67, v230
    v_mul_f32 v68, v68, v230
    v_mul_f32 v69, v69, v230
    v_mul_f32 v70, v70, v230
    v_mul_f32 v71, v71, v230
    v_mul_f32 v72, v72, v230
    v_mul_f32 v73, v73, v230
    v_mul_f32 v74, v74, v230
    v_mul_f32 v75, v75, v230
    v_mul_f32 v76, v76, v230
    v_mul_f32 v77, v77, v230
    v_mul_f32 v78, v78, v230
    v_mul_f32 v79, v79, v230
    v_mul_f32 v80, v80, v230
    v_mul_f32 v81, v81, v230
    v_mul_f32 v82, v82, v230
    v_mul_f32 v83, v83, v230
    v_mul_f32 v84, v84, v230
    v_mul_f32 v85, v85, v230
    v_mul_f32 v86, v86, v230
    v_mul_f32 v87, v87, v230
    v_mul_f32 v88, v88, v230
    v_mul_f32 v89, v89, v230
    v_mul_f32 v90, v90, v230
    v_mul_f32 v91, v91, v230
    v_mul_f32 v92, v92, v230
    v_mul_f32 v93, v93, v230
    v_mul_f32 v94, v94, v230
    v_mul_f32 v95, v95, v230
    v_mul_f32 v96, v96, v230
    v_mul_f32 v97, v97, v230
    v_mul_f32 v98, v98, v230
    v_mul_f32 v99, v99, v230
    v_mul_f32 v100, v100, v230
    v_mul_f32 v101, v101, v230
    v_mul_f32 v102, v102, v230
    v_mul_f32 v103, v103, v230
    v_mul_f32 v104, v104, v230
    v_mul_f32 v105, v105, v230
    v_mul_f32 v106, v106, v230
    v_mul_f32 v107, v107, v230
    v_mul_f32 v108, v108, v230
    v_mul_f32 v109, v109, v230
    v_mul_f32 v110, v110, v230
    v_mul_f32 v111, v111, v230
    v_mul_f32 v112, v112, v230
    v_mul_f32 v113, v113, v230
    v_mul_f32 v114, v114, v230
    v_mul_f32 v115, v115, v230
    v_mul_f32 v116, v116, v230
    v_mul_f32 v117, v117, v230
    v_mul_f32 v118, v118, v230
    v_mul_f32 v119, v119, v230
    v_mul_f32 v120, v120, v230
    v_mul_f32 v121, v121, v230
    v_mul_f32 v122, v122, v230
    v_mul_f32 v123, v123, v230
    v_mul_f32 v124, v124, v230
    v_mul_f32 v125, v125, v230
    v_mul_f32 v126, v126, v230
    v_mul_f32 v127, v127, v230
    v_accvgpr_read_b32 v234, a0
    v_accvgpr_read_b32 v235, a1
    v_accvgpr_read_b32 v236, a2
    v_accvgpr_read_b32 v237, a3
    v_mul_f32 v234, v234, v231
    v_mul_f32 v235, v235, v231
    v_mul_f32 v236, v236, v231
    v_mul_f32 v237, v237, v231
    v_accvgpr_write_b32 a0, v234
    v_accvgpr_write_b32 a1, v235
    v_accvgpr_write_b32 a2, v236
    v_accvgpr_write_b32 a3, v237
    v_accvgpr_read_b32 v234, a4
    v_accvgpr_read_b32 v235, a5
    v_accvgpr_read_b32 v236, a6
    v_accvgpr_read_b32 v237, a7
    v_mul_f32 v234, v234, v231
    v_mul_f32 v235, v235, v231
    v_mul_f32 v236, v236, v231
    v_mul_f32 v237, v237, v231
    v_accvgpr_write_b32 a4, v234
    v_accvgpr_write_b32 a5, v235
    v_accvgpr_write_b32 a6, v236
    v_accvgpr_write_b32 a7, v237
    v_accvgpr_read_b32 v234, a8
    v_accvgpr_read_b32 v235, a9
    v_accvgpr_read_b32 v236, a10
    v_accvgpr_read_b32 v237, a11
    v_mul_f32 v234, v234, v231
    v_mul_f32 v235, v235, v231
    v_mul_f32 v236, v236, v231
    v_mul_f32 v237, v237, v231
    v_accvgpr_write_b32 a8, v234
    v_accvgpr_write_b32 a9, v235
    v_accvgpr_write_b32 a10, v236
    v_accvgpr_write_b32 a11, v237
    v_accvgpr_read_b32 v234, a12
    v_accvgpr_read_b32 v235, a13
    v_accvgpr_read_b32 v236, a14
    v_accvgpr_read_b32 v237, a15
    v_mul_f32 v234, v234, v231
    v_mul_f32 v235, v235, v231
    v_mul_f32 v236, v236, v231
    v_mul_f32 v237, v237, v231
    v_accvgpr_write_b32 a12, v234
    v_accvgpr_write_b32 a13, v235
    v_accvgpr_write_b32 a14, v236
    v_accvgpr_write_b32 a15, v237
    v_accvgpr_read_b32 v234, a16
    v_accvgpr_read_b32 v235, a17
    v_accvgpr_read_b32 v236, a18
    v_accvgpr_read_b32 v237, a19
    v_mul_f32 v234, v234, v231
    v_mul_f32 v235, v235, v231
    v_mul_f32 v236, v236, v231
    v_mul_f32 v237, v237, v231
    v_accvgpr_write_b32 a16, v234
    v_accvgpr_write_b32 a17, v235
    v_accvgpr_write_b32 a18, v236
    v_accvgpr_write_b32 a19, v237
    v_accvgpr_read_b32 v234, a20
    v_accvgpr_read_b32 v235, a21
    v_accvgpr_read_b32 v236, a22
    v_accvgpr_read_b32 v237, a23
    v_mul_f32 v234, v234, v231
    v_mul_f32 v235, v235, v231
    v_mul_f32 v236, v236, v231
    v_mul_f32 v237, v237, v231
    v_accvgpr_write_b32 a20, v234
    v_accvgpr_write_b32 a21, v235
    v_accvgpr_write_b32 a22, v236
    v_accvgpr_write_b32 a23, v237
    v_accvgpr_read_b32 v234, a24
    v_accvgpr_read_b32 v235, a25
    v_accvgpr_read_b32 v236, a26
    v_accvgpr_read_b32 v237, a27
    v_mul_f32 v234, v234, v231
    v_mul_f32 v235, v235, v231
    v_mul_f32 v236, v236, v231
    v_mul_f32 v237, v237, v231
    v_accvgpr_write_b32 a24, v234
    v_accvgpr_write_b32 a25, v235
    v_accvgpr_write_b32 a26, v236
    v_accvgpr_write_b32 a27, v237
    v_accvgpr_read_b32 v234, a28
    v_accvgpr_read_b32 v235, a29
    v_accvgpr_read_b32 v236, a30
    v_accvgpr_read_b32 v237, a31
    v_mul_f32 v234, v234, v231
    v_mul_f32 v235, v235, v231
    v_mul_f32 v236, v236, v231
    v_mul_f32 v237, v237, v231
    v_accvgpr_write_b32 a28, v234
    v_accvgpr_write_b32 a29, v235
    v_accvgpr_write_b32 a30, v236
    v_accvgpr_write_b32 a31, v237
    v_accvgpr_read_b32 v234, a32
    v_accvgpr_read_b32 v235, a33
    v_accvgpr_read_b32 v236, a34
    v_accvgpr_read_b32 v237, a35
    v_mul_f32 v234, v234, v231
    v_mul_f32 v235, v235, v231
    v_mul_f32 v236, v236, v231
    v_mul_f32 v237, v237, v231
    v_accvgpr_write_b32 a32, v234
    v_accvgpr_write_b32 a33, v235
    v_accvgpr_write_b32 a34, v236
    v_accvgpr_write_b32 a35, v237
    v_accvgpr_read_b32 v234, a36
    v_accvgpr_read_b32 v235, a37
    v_accvgpr_read_b32 v236, a38
    v_accvgpr_read_b32 v237, a39
    v_mul_f32 v234, v234, v231
    v_mul_f32 v235, v235, v231
    v_mul_f32 v236, v236, v231
    v_mul_f32 v237, v237, v231
    v_accvgpr_write_b32 a36, v234
    v_accvgpr_write_b32 a37, v235
    v_accvgpr_write_b32 a38, v236
    v_accvgpr_write_b32 a39, v237
    v_accvgpr_read_b32 v234, a40
    v_accvgpr_read_b32 v235, a41
    v_accvgpr_read_b32 v236, a42
    v_accvgpr_read_b32 v237, a43
    v_mul_f32 v234, v234, v231
    v_mul_f32 v235, v235, v231
    v_mul_f32 v236, v236, v231
    v_mul_f32 v237, v237, v231
    v_accvgpr_write_b32 a40, v234
    v_accvgpr_write_b32 a41, v235
    v_accvgpr_write_b32 a42, v236
    v_accvgpr_write_b32 a43, v237
    v_accvgpr_read_b32 v234, a44
    v_accvgpr_read_b32 v235, a45
    v_accvgpr_read_b32 v236, a46
    v_accvgpr_read_b32 v237, a47
    v_mul_f32 v234, v234, v231
    v_mul_f32 v235, v235, v231
    v_mul_f32 v236, v236, v231
    v_mul_f32 v237, v237, v231
    v_accvgpr_write_b32 a44, v234
    v_accvgpr_write_b32 a45, v235
    v_accvgpr_write_b32 a46, v236
    v_accvgpr_write_b32 a47, v237
    v_accvgpr_read_b32 v234, a48
    v_accvgpr_read_b32 v235, a49
    v_accvgpr_read_b32 v236, a50
    v_accvgpr_read_b32 v237, a51
    v_mul_f32 v234, v234, v231
    v_mul_f32 v235, v235, v231
    v_mul_f32 v236, v236, v231
    v_mul_f32 v237, v237, v231
    v_accvgpr_write_b32 a48, v234
    v_accvgpr_write_b32 a49, v235
    v_accvgpr_write_b32 a50, v236
    v_accvgpr_write_b32 a51, v237
    v_accvgpr_read_b32 v234, a52
    v_accvgpr_read_b32 v235, a53
    v_accvgpr_read_b32 v236, a54
    v_accvgpr_read_b32 v237, a55
    v_mul_f32 v234, v234, v231
    v_mul_f32 v235, v235, v231
    v_mul_f32 v236, v236, v231
    v_mul_f32 v237, v237, v231
    v_accvgpr_write_b32 a52, v234
    v_accvgpr_write_b32 a53, v235
    v_accvgpr_write_b32 a54, v236
    v_accvgpr_write_b32 a55, v237
    v_accvgpr_read_b32 v234, a56
    v_accvgpr_read_b32 v235, a57
    v_accvgpr_read_b32 v236, a58
    v_accvgpr_read_b32 v237, a59
    v_mul_f32 v234, v234, v231
    v_mul_f32 v235, v235, v231
    v_mul_f32 v236, v236, v231
    v_mul_f32 v237, v237, v231
    v_accvgpr_write_b32 a56, v234
    v_accvgpr_write_b32 a57, v235
    v_accvgpr_write_b32 a58, v236
    v_accvgpr_write_b32 a59, v237
    v_accvgpr_read_b32 v234, a60
    v_accvgpr_read_b32 v235, a61
    v_accvgpr_read_b32 v236, a62
    v_accvgpr_read_b32 v237, a63
    v_mul_f32 v234, v234, v231
    v_mul_f32 v235, v235, v231
    v_mul_f32 v236, v236, v231
    v_mul_f32 v237, v237, v231
    v_accvgpr_write_b32 a60, v234
    v_accvgpr_write_b32 a61, v235
    v_accvgpr_write_b32 a62, v236
    v_accvgpr_write_b32 a63, v237
    v_accvgpr_read_b32 v234, a64
    v_accvgpr_read_b32 v235, a65
    v_accvgpr_read_b32 v236, a66
    v_accvgpr_read_b32 v237, a67
    v_mul_f32 v234, v234, v231
    v_mul_f32 v235, v235, v231
    v_mul_f32 v236, v236, v231
    v_mul_f32 v237, v237, v231
    v_accvgpr_write_b32 a64, v234
    v_accvgpr_write_b32 a65, v235
    v_accvgpr_write_b32 a66, v236
    v_accvgpr_write_b32 a67, v237
    v_accvgpr_read_b32 v234, a68
    v_accvgpr_read_b32 v235, a69
    v_accvgpr_read_b32 v236, a70
    v_accvgpr_read_b32 v237, a71
    v_mul_f32 v234, v234, v231
    v_mul_f32 v235, v235, v231
    v_mul_f32 v236, v236, v231
    v_mul_f32 v237, v237, v231
    v_accvgpr_write_b32 a68, v234
    v_accvgpr_write_b32 a69, v235
    v_accvgpr_write_b32 a70, v236
    v_accvgpr_write_b32 a71, v237
    v_accvgpr_read_b32 v234, a72
    v_accvgpr_read_b32 v235, a73
    v_accvgpr_read_b32 v236, a74
    v_accvgpr_read_b32 v237, a75
    v_mul_f32 v234, v234, v231
    v_mul_f32 v235, v235, v231
    v_mul_f32 v236, v236, v231
    v_mul_f32 v237, v237, v231
    v_accvgpr_write_b32 a72, v234
    v_accvgpr_write_b32 a73, v235
    v_accvgpr_write_b32 a74, v236
    v_accvgpr_write_b32 a75, v237
    v_accvgpr_read_b32 v234, a76
    v_accvgpr_read_b32 v235, a77
    v_accvgpr_read_b32 v236, a78
    v_accvgpr_read_b32 v237, a79
    v_mul_f32 v234, v234, v231
    v_mul_f32 v235, v235, v231
    v_mul_f32 v236, v236, v231
    v_mul_f32 v237, v237, v231
    v_accvgpr_write_b32 a76, v234
    v_accvgpr_write_b32 a77, v235
    v_accvgpr_write_b32 a78, v236
    v_accvgpr_write_b32 a79, v237
    v_accvgpr_read_b32 v234, a80
    v_accvgpr_read_b32 v235, a81
    v_accvgpr_read_b32 v236, a82
    v_accvgpr_read_b32 v237, a83
    v_mul_f32 v234, v234, v231
    v_mul_f32 v235, v235, v231
    v_mul_f32 v236, v236, v231
    v_mul_f32 v237, v237, v231
    v_accvgpr_write_b32 a80, v234
    v_accvgpr_write_b32 a81, v235
    v_accvgpr_write_b32 a82, v236
    v_accvgpr_write_b32 a83, v237
    v_accvgpr_read_b32 v234, a84
    v_accvgpr_read_b32 v235, a85
    v_accvgpr_read_b32 v236, a86
    v_accvgpr_read_b32 v237, a87
    v_mul_f32 v234, v234, v231
    v_mul_f32 v235, v235, v231
    v_mul_f32 v236, v236, v231
    v_mul_f32 v237, v237, v231
    v_accvgpr_write_b32 a84, v234
    v_accvgpr_write_b32 a85, v235
    v_accvgpr_write_b32 a86, v236
    v_accvgpr_write_b32 a87, v237
    v_accvgpr_read_b32 v234, a88
    v_accvgpr_read_b32 v235, a89
    v_accvgpr_read_b32 v236, a90
    v_accvgpr_read_b32 v237, a91
    v_mul_f32 v234, v234, v231
    v_mul_f32 v235, v235, v231
    v_mul_f32 v236, v236, v231
    v_mul_f32 v237, v237, v231
    v_accvgpr_write_b32 a88, v234
    v_accvgpr_write_b32 a89, v235
    v_accvgpr_write_b32 a90, v236
    v_accvgpr_write_b32 a91, v237
    v_accvgpr_read_b32 v234, a92
    v_accvgpr_read_b32 v235, a93
    v_accvgpr_read_b32 v236, a94
    v_accvgpr_read_b32 v237, a95
    v_mul_f32 v234, v234, v231
    v_mul_f32 v235, v235, v231
    v_mul_f32 v236, v236, v231
    v_mul_f32 v237, v237, v231
    v_accvgpr_write_b32 a92, v234
    v_accvgpr_write_b32 a93, v235
    v_accvgpr_write_b32 a94, v236
    v_accvgpr_write_b32 a95, v237
    v_accvgpr_read_b32 v234, a96
    v_accvgpr_read_b32 v235, a97
    v_accvgpr_read_b32 v236, a98
    v_accvgpr_read_b32 v237, a99
    v_mul_f32 v234, v234, v231
    v_mul_f32 v235, v235, v231
    v_mul_f32 v236, v236, v231
    v_mul_f32 v237, v237, v231
    v_accvgpr_write_b32 a96, v234
    v_accvgpr_write_b32 a97, v235
    v_accvgpr_write_b32 a98, v236
    v_accvgpr_write_b32 a99, v237
    v_accvgpr_read_b32 v234, a100
    v_accvgpr_read_b32 v235, a101
    v_accvgpr_read_b32 v236, a102
    v_accvgpr_read_b32 v237, a103
    v_mul_f32 v234, v234, v231
    v_mul_f32 v235, v235, v231
    v_mul_f32 v236, v236, v231
    v_mul_f32 v237, v237, v231
    v_accvgpr_write_b32 a100, v234
    v_accvgpr_write_b32 a101, v235
    v_accvgpr_write_b32 a102, v236
    v_accvgpr_write_b32 a103, v237
    v_accvgpr_read_b32 v234, a104
    v_accvgpr_read_b32 v235, a105
    v_accvgpr_read_b32 v236, a106
    v_accvgpr_read_b32 v237, a107
    v_mul_f32 v234, v234, v231
    v_mul_f32 v235, v235, v231
    v_mul_f32 v236, v236, v231
    v_mul_f32 v237, v237, v231
    v_accvgpr_write_b32 a104, v234
    v_accvgpr_write_b32 a105, v235
    v_accvgpr_write_b32 a106, v236
    v_accvgpr_write_b32 a107, v237
    v_accvgpr_read_b32 v234, a108
    v_accvgpr_read_b32 v235, a109
    v_accvgpr_read_b32 v236, a110
    v_accvgpr_read_b32 v237, a111
    v_mul_f32 v234, v234, v231
    v_mul_f32 v235, v235, v231
    v_mul_f32 v236, v236, v231
    v_mul_f32 v237, v237, v231
    v_accvgpr_write_b32 a108, v234
    v_accvgpr_write_b32 a109, v235
    v_accvgpr_write_b32 a110, v236
    v_accvgpr_write_b32 a111, v237
    v_accvgpr_read_b32 v234, a112
    v_accvgpr_read_b32 v235, a113
    v_accvgpr_read_b32 v236, a114
    v_accvgpr_read_b32 v237, a115
    v_mul_f32 v234, v234, v231
    v_mul_f32 v235, v235, v231
    v_mul_f32 v236, v236, v231
    v_mul_f32 v237, v237, v231
    v_accvgpr_write_b32 a112, v234
    v_accvgpr_write_b32 a113, v235
    v_accvgpr_write_b32 a114, v236
    v_accvgpr_write_b32 a115, v237
    v_accvgpr_read_b32 v234, a116
    v_accvgpr_read_b32 v235, a117
    v_accvgpr_read_b32 v236, a118
    v_accvgpr_read_b32 v237, a119
    v_mul_f32 v234, v234, v231
    v_mul_f32 v235, v235, v231
    v_mul_f32 v236, v236, v231
    v_mul_f32 v237, v237, v231
    v_accvgpr_write_b32 a116, v234
    v_accvgpr_write_b32 a117, v235
    v_accvgpr_write_b32 a118, v236
    v_accvgpr_write_b32 a119, v237
    v_accvgpr_read_b32 v234, a120
    v_accvgpr_read_b32 v235, a121
    v_accvgpr_read_b32 v236, a122
    v_accvgpr_read_b32 v237, a123
    v_mul_f32 v234, v234, v231
    v_mul_f32 v235, v235, v231
    v_mul_f32 v236, v236, v231
    v_mul_f32 v237, v237, v231
    v_accvgpr_write_b32 a120, v234
    v_accvgpr_write_b32 a121, v235
    v_accvgpr_write_b32 a122, v236
    v_accvgpr_write_b32 a123, v237
    v_accvgpr_read_b32 v234, a124
    v_accvgpr_read_b32 v235, a125
    v_accvgpr_read_b32 v236, a126
    v_accvgpr_read_b32 v237, a127
    v_mul_f32 v234, v234, v231
    v_mul_f32 v235, v235, v231
    v_mul_f32 v236, v236, v231
    v_mul_f32 v237, v237, v231
    v_accvgpr_write_b32 a124, v234
    v_accvgpr_write_b32 a125, v235
    v_accvgpr_write_b32 a126, v236
    v_accvgpr_write_b32 a127, v237
    v_mov_b32 v230, 1.0
    v_mov_b32 v231, 1.0
    s_mov_b32 s30, 0
    s_nop 1
    s_branch RBACK_5
RARE_6:
    v_max3_f32 v242, v128, v129, v130
    v_max3_f32 v243, v131, v132, v133
    v_max3_f32 v242, v242, v134, v135
    v_max3_f32 v243, v243, v136, v137
    v_max3_f32 v242, v242, v138, v139
    v_max3_f32 v243, v243, v140, v141
    v_max3_f32 v242, v242, v142, v143
    v_max_f32 v242, v242, v243
    v_mov_b32 v243, v242
    s_nop 1
    v_permlane32_swap_b32 v242, v243
    s_nop 1
    v_max_f32 v242, v242, v243
    v_mul_f32 v242, s20, v242
    v_max_f32_e64 v242, v242, -v226
    v_add_f32 v243, v226, v242
    v_exp_f32_e64 v243, -v243
    v_sub_f32 v226, 0, v242
    v_mul_f32 v228, v228, v243
    v_mul_f32 v230, v230, v243
    s_mov_b32 s30, 1
    v_fma_f32 v234, v128, s20, v226
    v_fma_f32 v235, v129, s20, v226
    v_exp_f32 v234, v234
    v_fma_f32 v236, v130, s20, v226
    v_exp_f32 v235, v235
    v_fma_f32 v237, v131, s20, v226
    v_exp_f32 v236, v236
    v_mov_b32 v232, v234
    v_fma_f32 v238, v132, s20, v226
    v_exp_f32 v237, v237
    v_mov_b32 v233, v235
    v_cvt_pk_bf16_f32 v176, v234, v235
    v_fma_f32 v239, v133, s20, v226
    v_exp_f32 v238, v238
    v_add_f32 v232, v232, v236
    v_fma_f32 v240, v134, s20, v226
    v_exp_f32 v239, v239
    v_add_f32 v233, v233, v237
    v_cvt_pk_bf16_f32 v177, v236, v237
    v_fma_f32 v241, v135, s20, v226
    v_exp_f32 v240, v240
    v_add_f32 v232, v232, v238
    v_fma_f32 v234, v136, s20, v226
    v_exp_f32 v241, v241
    v_add_f32 v233, v233, v239
    v_cvt_pk_bf16_f32 v178, v238, v239
    v_fma_f32 v235, v137, s20, v226
    v_exp_f32 v234, v234
    v_add_f32 v232, v232, v240
    v_fma_f32 v236, v138, s20, v226
    v_exp_f32 v235, v235
    v_add_f32 v233, v233, v241
    v_cvt_pk_bf16_f32 v179, v240, v241
    v_fma_f32 v237, v139, s20, v226
    v_exp_f32 v236, v236
    v_add_f32 v232, v232, v234
    v_fma_f32 v238, v140, s20, v226
    v_exp_f32 v237, v237
    v_add_f32 v233, v233, v235
    v_cvt_pk_bf16_f32 v180, v234, v235
    v_fma_f32 v239, v141, s20, v226
    v_exp_f32 v238, v238
    v_add_f32 v232, v232, v236
    v_fma_f32 v240, v142, s20, v226
    v_exp_f32 v239, v239
    v_add_f32 v233, v233, v237
    v_cvt_pk_bf16_f32 v181, v236, v237
    v_fma_f32 v241, v143, s20, v226
    v_exp_f32 v240, v240
    v_add_f32 v232, v232, v238
    v_exp_f32 v241, v241
    v_add_f32 v233, v233, v239
    v_cvt_pk_bf16_f32 v182, v238, v239
    v_add_f32 v232, v232, v240
    v_add_f32 v233, v233, v241
    v_cvt_pk_bf16_f32 v183, v240, v241
    v_add_f32 v232, v232, v233
    s_branch BACK_6
RARE_7:
    v_max3_f32 v242, v144, v145, v146
    v_max3_f32 v243, v147, v148, v149
    v_max3_f32 v242, v242, v150, v151
    v_max3_f32 v243, v243, v152, v153
    v_max3_f32 v242, v242, v154, v155
    v_max3_f32 v243, v243, v156, v157
    v_max3_f32 v242, v242, v158, v159
    v_max_f32 v242, v242, v243
    v_mov_b32 v243, v242
    s_nop 1
    v_permlane32_swap_b32 v242, v243
    s_nop 1
    v_max_f32 v242, v242, v243
    v_mul_f32 v242, s20, v242
    v_max_f32_e64 v242, v242, -v227
    v_add_f32 v243, v227, v242
    v_exp_f32_e64 v243, -v243
    v_sub_f32 v227, 0, v242
    v_mul_f32 v229, v229, v243
    v_mul_f32 v231, v231, v243
    s_mov_b32 s30, 1
    v_fma_f32 v234, v144, s20, v227
    v_fma_f32 v235, v145, s20, v227
    v_exp_f32 v234, v234
    v_fma_f32 v236, v146, s20, v227
    v_exp_f32 v235, v235
    v_fma_f32 v237, v147, s20, v227
    v_exp_f32 v236, v236
    v_mov_b32 v232, v234
    v_fma_f32 v238, v148, s20, v227
    v_exp_f32 v237, v237
    v_mov_b32 v233, v235
    v_cvt_pk_bf16_f32 v192, v234, v235
    v_fma_f32 v239, v149, s20, v227
    v_exp_f32 v238, v238
    v_add_f32 v232, v232, v236
    v_fma_f32 v240, v150, s20, v227
    v_exp_f32 v239, v239
    v_add_f32 v233, v233, v237
    v_cvt_pk_bf16_f32 v193, v236, v237
    v_fma_f32 v241, v151, s20, v227
    v_exp_f32 v240, v240
    v_add_f32 v232, v232, v238
    v_fma_f32 v234, v152, s20, v227
    v_exp_f32 v241, v241
    v_add_f32 v233, v233, v239
    v_cvt_pk_bf16_f32 v194, v238, v239
    v_fma_f32 v235, v153, s20, v227
    v_exp_f32 v234, v234
    v_add_f32 v232, v232, v240
    v_fma_f32 v236, v154, s20, v227
    v_exp_f32 v235, v235
    v_add_f32 v233, v233, v241
    v_cvt_pk_bf16_f32 v195, v240, v241
    v_fma_f32 v237, v155, s20, v227
    v_exp_f32 v236, v236
    v_add_f32 v232, v232, v234
    v_fma_f32 v238, v156, s20, v227
    v_exp_f32 v237, v237
    v_add_f32 v233, v233, v235
    v_cvt_pk_bf16_f32 v196, v234, v235
    v_fma_f32 v239, v157, s20, v227
    v_exp_f32 v238, v238
    v_add_f32 v232, v232, v236
    v_fma_f32 v240, v158, s20, v227
    v_exp_f32 v239, v239
    v_add_f32 v233, v233, v237
    v_cvt_pk_bf16_f32 v197, v236, v237
    v_fma_f32 v241, v159, s20, v227
    v_exp_f32 v240, v240
    v_add_f32 v232, v232, v238
    v_exp_f32 v241, v241
    v_add_f32 v233, v233, v239
    v_cvt_pk_bf16_f32 v198, v238, v239
    v_add_f32 v232, v232, v240
    v_add_f32 v233, v233, v241
    v_cvt_pk_bf16_f32 v199, v240, v241
    v_add_f32 v232, v232, v233
    s_branch BACK_7
RESC_8:
    s_nop 7
    s_nop 7
    v_mul_f32 v0, v0, v230
    v_mul_f32 v1, v1, v230
    v_mul_f32 v2, v2, v230
    v_mul_f32 v3, v3, v230
    v_mul_f32 v4, v4, v230
    v_mul_f32 v5, v5, v230
    v_mul_f32 v6, v6, v230
    v_mul_f32 v7, v7, v230
    v_mul_f32 v8, v8, v230
    v_mul_f32 v9, v9, v230
    v_mul_f32 v10, v10, v230
    v_mul_f32 v11, v11, v230
    v_mul_f32 v12, v12, v230
    v_mul_f32 v13, v13, v230
    v_mul_f32 v14, v14, v230
    v_mul_f32 v15, v15, v230
    v_mul_f32 v16, v16, v230
    v_mul_f32 v17, v17, v230
    v_mul_f32 v18, v18, v230
    v_mul_f32 v19, v19, v230
    v_mul_f32 v20, v20, v230
    v_mul_f32 v21, v21, v230
    v_mul_f32 v22, v22, v230
    v_mul_f32 v23, v23, v230
    v_mul_f32 v24, v24, v230
    v_mul_f32 v25, v25, v230
    v_mul_f32 v26, v26, v230
    v_mul_f32 v27, v27, v230
    v_mul_f32 v28, v28, v230
    v_mul_f32 v29, v29, v230
    v_mul_f32 v30, v30, v230
    v_mul_f32 v31, v31, v230
    v_mul_f32 v32, v32, v230
    v_mul_f32 v33, v33, v230
    v_mul_f32 v34, v34, v230
    v_mul_f32 v35, v35, v230
    v_mul_f32 v36, v36, v230
    v_mul_f32 v37, v37, v230
    v_mul_f32 v38, v38, v230
    v_mul_f32 v39, v39, v230
    v_mul_f32 v40, v40, v230
    v_mul_f32 v41, v41, v230
    v_mul_f32 v42, v42, v230
    v_mul_f32 v43, v43, v230
    v_mul_f32 v44, v44, v230
    v_mul_f32 v45, v45, v230
    v_mul_f32 v46, v46, v230
    v_mul_f32 v47, v47, v230
    v_mul_f32 v48, v48, v230
    v_mul_f32 v49, v49, v230
    v_mul_f32 v50, v50, v230
    v_mul_f32 v51, v51, v230
    v_mul_f32 v52, v52, v230
    v_mul_f32 v53, v53, v230
    v_mul_f32 v54, v54, v230
    v_mul_f32 v55, v55, v230
    v_mul_f32 v56, v56, v230
    v_mul_f32 v57, v57, v230
    v_mul_f32 v58, v58, v230
    v_mul_f32 v59, v59, v230
    v_mul_f32 v60, v60, v230
    v_mul_f32 v61, v61, v230
    v_mul_f32 v62, v62, v230
    v_mul_f32 v63, v63, v230
    v_mul_f32 v64, v64, v230
    v_mul_f32 v65, v65, v230
    v_mul_f32 v66, v66, v230
    v_mul_f32 v67, v67, v230
    v_mul_f32 v68, v68, v230
    v_mul_f32 v69, v69, v230
    v_mul_f32 v70, v70, v230
    v_mul_f32 v71, v71, v230
    v_mul_f32 v72, v72, v230
    v_mul_f32 v73, v73, v230
    v_mul_f32 v74, v74, v230
    v_mul_f32 v75, v75, v230
    v_mul_f32 v76, v76, v230
    v_mul_f32 v77, v77, v230
    v_mul_f32 v78, v78, v230
    v_mul_f32 v79, v79, v230
    v_mul_f32 v80, v80, v230
    v_mul_f32 v81, v81, v230
    v_mul_f32 v82, v82, v230
    v_mul_f32 v83, v83, v230
    v_mul_f32 v84, v84, v230
    v_mul_f32 v85, v85, v230
    v_mul_f32 v86, v86, v230
    v_mul_f32 v87, v87, v230
    v_mul_f32 v88, v88, v230
    v_mul_f32 v89, v89, v230
    v_mul_f32 v90, v90, v230
    v_mul_f32 v91, v91, v230
    v_mul_f32 v92, v92, v230
    v_mul_f32 v93, v93, v230
    v_mul_f32 v94, v94, v230
    v_mul_f32 v95, v95, v230
    v_mul_f32 v96, v96, v230
    v_mul_f32 v97, v97, v230
    v_mul_f32 v98, v98, v230
    v_mul_f32 v99, v99, v230
    v_mul_f32 v100, v100, v230
    v_mul_f32 v101, v101, v230
    v_mul_f32 v102, v102, v230
    v_mul_f32 v103, v103, v230
    v_mul_f32 v104, v104, v230
    v_mul_f32 v105, v105, v230
    v_mul_f32 v106, v106, v230
    v_mul_f32 v107, v107, v230
    v_mul_f32 v108, v108, v230
    v_mul_f32 v109, v109, v230
    v_mul_f32 v110, v110, v230
    v_mul_f32 v111, v111, v230
    v_mul_f32 v112, v112, v230
    v_mul_f32 v113, v113, v230
    v_mul_f32 v114, v114, v230
    v_mul_f32 v115, v115, v230
    v_mul_f32 v116, v116, v230
    v_mul_f32 v117, v117, v230
    v_mul_f32 v118, v118, v230
    v_mul_f32 v119, v119, v230
    v_mul_f32 v120, v120, v230
    v_mul_f32 v121, v121, v230
    v_mul_f32 v122, v122, v230
    v_mul_f32 v123, v123, v230
    v_mul_f32 v124, v124, v230
    v_mul_f32 v125, v125, v230
    v_mul_f32 v126, v126, v230
    v_mul_f32 v127, v127, v230
    v_accvgpr_read_b32 v234, a0
    v_accvgpr_read_b32 v235, a1
    v_accvgpr_read_b32 v236, a2
    v_accvgpr_read_b32 v237, a3
    v_mul_f32 v234, v234, v231
    v_mul_f32 v235, v235, v231
    v_mul_f32 v236, v236, v231
    v_mul_f32 v237, v237, v231
    v_accvgpr_write_b32 a0, v234
    v_accvgpr_write_b32 a1, v235
    v_accvgpr_write_b32 a2, v236
    v_accvgpr_write_b32 a3, v237
    v_accvgpr_read_b32 v234, a4
    v_accvgpr_read_b32 v235, a5
    v_accvgpr_read_b32 v236, a6
    v_accvgpr_read_b32 v237, a7
    v_mul_f32 v234, v234, v231
    v_mul_f32 v235, v235, v231
    v_mul_f32 v236, v236, v231
    v_mul_f32 v237, v237, v231
    v_accvgpr_write_b32 a4, v234
    v_accvgpr_write_b32 a5, v235
    v_accvgpr_write_b32 a6, v236
    v_accvgpr_write_b32 a7, v237
    v_accvgpr_read_b32 v234, a8
    v_accvgpr_read_b32 v235, a9
    v_accvgpr_read_b32 v236, a10
    v_accvgpr_read_b32 v237, a11
    v_mul_f32 v234, v234, v231
    v_mul_f32 v235, v235, v231
    v_mul_f32 v236, v236, v231
    v_mul_f32 v237, v237, v231
    v_accvgpr_write_b32 a8, v234
    v_accvgpr_write_b32 a9, v235
    v_accvgpr_write_b32 a10, v236
    v_accvgpr_write_b32 a11, v237
    v_accvgpr_read_b32 v234, a12
    v_accvgpr_read_b32 v235, a13
    v_accvgpr_read_b32 v236, a14
    v_accvgpr_read_b32 v237, a15
    v_mul_f32 v234, v234, v231
    v_mul_f32 v235, v235, v231
    v_mul_f32 v236, v236, v231
    v_mul_f32 v237, v237, v231
    v_accvgpr_write_b32 a12, v234
    v_accvgpr_write_b32 a13, v235
    v_accvgpr_write_b32 a14, v236
    v_accvgpr_write_b32 a15, v237
    v_accvgpr_read_b32 v234, a16
    v_accvgpr_read_b32 v235, a17
    v_accvgpr_read_b32 v236, a18
    v_accvgpr_read_b32 v237, a19
    v_mul_f32 v234, v234, v231
    v_mul_f32 v235, v235, v231
    v_mul_f32 v236, v236, v231
    v_mul_f32 v237, v237, v231
    v_accvgpr_write_b32 a16, v234
    v_accvgpr_write_b32 a17, v235
    v_accvgpr_write_b32 a18, v236
    v_accvgpr_write_b32 a19, v237
    v_accvgpr_read_b32 v234, a20
    v_accvgpr_read_b32 v235, a21
    v_accvgpr_read_b32 v236, a22
    v_accvgpr_read_b32 v237, a23
    v_mul_f32 v234, v234, v231
    v_mul_f32 v235, v235, v231
    v_mul_f32 v236, v236, v231
    v_mul_f32 v237, v237, v231
    v_accvgpr_write_b32 a20, v234
    v_accvgpr_write_b32 a21, v235
    v_accvgpr_write_b32 a22, v236
    v_accvgpr_write_b32 a23, v237
    v_accvgpr_read_b32 v234, a24
    v_accvgpr_read_b32 v235, a25
    v_accvgpr_read_b32 v236, a26
    v_accvgpr_read_b32 v237, a27
    v_mul_f32 v234, v234, v231
    v_mul_f32 v235, v235, v231
    v_mul_f32 v236, v236, v231
    v_mul_f32 v237, v237, v231
    v_accvgpr_write_b32 a24, v234
    v_accvgpr_write_b32 a25, v235
    v_accvgpr_write_b32 a26, v236
    v_accvgpr_write_b32 a27, v237
    v_accvgpr_read_b32 v234, a28
    v_accvgpr_read_b32 v235, a29
    v_accvgpr_read_b32 v236, a30
    v_accvgpr_read_b32 v237, a31
    v_mul_f32 v234, v234, v231
    v_mul_f32 v235, v235, v231
    v_mul_f32 v236, v236, v231
    v_mul_f32 v237, v237, v231
    v_accvgpr_write_b32 a28, v234
    v_accvgpr_write_b32 a29, v235
    v_accvgpr_write_b32 a30, v236
    v_accvgpr_write_b32 a31, v237
    v_accvgpr_read_b32 v234, a32
    v_accvgpr_read_b32 v235, a33
    v_accvgpr_read_b32 v236, a34
    v_accvgpr_read_b32 v237, a35
    v_mul_f32 v234, v234, v231
    v_mul_f32 v235, v235, v231
    v_mul_f32 v236, v236, v231
    v_mul_f32 v237, v237, v231
    v_accvgpr_write_b32 a32, v234
    v_accvgpr_write_b32 a33, v235
    v_accvgpr_write_b32 a34, v236
    v_accvgpr_write_b32 a35, v237
    v_accvgpr_read_b32 v234, a36
    v_accvgpr_read_b32 v235, a37
    v_accvgpr_read_b32 v236, a38
    v_accvgpr_read_b32 v237, a39
    v_mul_f32 v234, v234, v231
    v_mul_f32 v235, v235, v231
    v_mul_f32 v236, v236, v231
    v_mul_f32 v237, v237, v231
    v_accvgpr_write_b32 a36, v234
    v_accvgpr_write_b32 a37, v235
    v_accvgpr_write_b32 a38, v236
    v_accvgpr_write_b32 a39, v237
    v_accvgpr_read_b32 v234, a40
    v_accvgpr_read_b32 v235, a41
    v_accvgpr_read_b32 v236, a42
    v_accvgpr_read_b32 v237, a43
    v_mul_f32 v234, v234, v231
    v_mul_f32 v235, v235, v231
    v_mul_f32 v236, v236, v231
    v_mul_f32 v237, v237, v231
    v_accvgpr_write_b32 a40, v234
    v_accvgpr_write_b32 a41, v235
    v_accvgpr_write_b32 a42, v236
    v_accvgpr_write_b32 a43, v237
    v_accvgpr_read_b32 v234, a44
    v_accvgpr_read_b32 v235, a45
    v_accvgpr_read_b32 v236, a46
    v_accvgpr_read_b32 v237, a47
    v_mul_f32 v234, v234, v231
    v_mul_f32 v235, v235, v231
    v_mul_f32 v236, v236, v231
    v_mul_f32 v237, v237, v231
    v_accvgpr_write_b32 a44, v234
    v_accvgpr_write_b32 a45, v235
    v_accvgpr_write_b32 a46, v236
    v_accvgpr_write_b32 a47, v237
    v_accvgpr_read_b32 v234, a48
    v_accvgpr_read_b32 v235, a49
    v_accvgpr_read_b32 v236, a50
    v_accvgpr_read_b32 v237, a51
    v_mul_f32 v234, v234, v231
    v_mul_f32 v235, v235, v231
    v_mul_f32 v236, v236, v231
    v_mul_f32 v237, v237, v231
    v_accvgpr_write_b32 a48, v234
    v_accvgpr_write_b32 a49, v235
    v_accvgpr_write_b32 a50, v236
    v_accvgpr_write_b32 a51, v237
    v_accvgpr_read_b32 v234, a52
    v_accvgpr_read_b32 v235, a53
    v_accvgpr_read_b32 v236, a54
    v_accvgpr_read_b32 v237, a55
    v_mul_f32 v234, v234, v231
    v_mul_f32 v235, v235, v231
    v_mul_f32 v236, v236, v231
    v_mul_f32 v237, v237, v231
    v_accvgpr_write_b32 a52, v234
    v_accvgpr_write_b32 a53, v235
    v_accvgpr_write_b32 a54, v236
    v_accvgpr_write_b32 a55, v237
    v_accvgpr_read_b32 v234, a56
    v_accvgpr_read_b32 v235, a57
    v_accvgpr_read_b32 v236, a58
    v_accvgpr_read_b32 v237, a59
    v_mul_f32 v234, v234, v231
    v_mul_f32 v235, v235, v231
    v_mul_f32 v236, v236, v231
    v_mul_f32 v237, v237, v231
    v_accvgpr_write_b32 a56, v234
    v_accvgpr_write_b32 a57, v235
    v_accvgpr_write_b32 a58, v236
    v_accvgpr_write_b32 a59, v237
    v_accvgpr_read_b32 v234, a60
    v_accvgpr_read_b32 v235, a61
    v_accvgpr_read_b32 v236, a62
    v_accvgpr_read_b32 v237, a63
    v_mul_f32 v234, v234, v231
    v_mul_f32 v235, v235, v231
    v_mul_f32 v236, v236, v231
    v_mul_f32 v237, v237, v231
    v_accvgpr_write_b32 a60, v234
    v_accvgpr_write_b32 a61, v235
    v_accvgpr_write_b32 a62, v236
    v_accvgpr_write_b32 a63, v237
    v_accvgpr_read_b32 v234, a64
    v_accvgpr_read_b32 v235, a65
    v_accvgpr_read_b32 v236, a66
    v_accvgpr_read_b32 v237, a67
    v_mul_f32 v234, v234, v231
    v_mul_f32 v235, v235, v231
    v_mul_f32 v236, v236, v231
    v_mul_f32 v237, v237, v231
    v_accvgpr_write_b32 a64, v234
    v_accvgpr_write_b32 a65, v235
    v_accvgpr_write_b32 a66, v236
    v_accvgpr_write_b32 a67, v237
    v_accvgpr_read_b32 v234, a68
    v_accvgpr_read_b32 v235, a69
    v_accvgpr_read_b32 v236, a70
    v_accvgpr_read_b32 v237, a71
    v_mul_f32 v234, v234, v231
    v_mul_f32 v235, v235, v231
    v_mul_f32 v236, v236, v231
    v_mul_f32 v237, v237, v231
    v_accvgpr_write_b32 a68, v234
    v_accvgpr_write_b32 a69, v235
    v_accvgpr_write_b32 a70, v236
    v_accvgpr_write_b32 a71, v237
    v_accvgpr_read_b32 v234, a72
    v_accvgpr_read_b32 v235, a73
    v_accvgpr_read_b32 v236, a74
    v_accvgpr_read_b32 v237, a75
    v_mul_f32 v234, v234, v231
    v_mul_f32 v235, v235, v231
    v_mul_f32 v236, v236, v231
    v_mul_f32 v237, v237, v231
    v_accvgpr_write_b32 a72, v234
    v_accvgpr_write_b32 a73, v235
    v_accvgpr_write_b32 a74, v236
    v_accvgpr_write_b32 a75, v237
    v_accvgpr_read_b32 v234, a76
    v_accvgpr_read_b32 v235, a77
    v_accvgpr_read_b32 v236, a78
    v_accvgpr_read_b32 v237, a79
    v_mul_f32 v234, v234, v231
    v_mul_f32 v235, v235, v231
    v_mul_f32 v236, v236, v231
    v_mul_f32 v237, v237, v231
    v_accvgpr_write_b32 a76, v234
    v_accvgpr_write_b32 a77, v235
    v_accvgpr_write_b32 a78, v236
    v_accvgpr_write_b32 a79, v237
    v_accvgpr_read_b32 v234, a80
    v_accvgpr_read_b32 v235, a81
    v_accvgpr_read_b32 v236, a82
    v_accvgpr_read_b32 v237, a83
    v_mul_f32 v234, v234, v231
    v_mul_f32 v235, v235, v231
    v_mul_f32 v236, v236, v231
    v_mul_f32 v237, v237, v231
    v_accvgpr_write_b32 a80, v234
    v_accvgpr_write_b32 a81, v235
    v_accvgpr_write_b32 a82, v236
    v_accvgpr_write_b32 a83, v237
    v_accvgpr_read_b32 v234, a84
    v_accvgpr_read_b32 v235, a85
    v_accvgpr_read_b32 v236, a86
    v_accvgpr_read_b32 v237, a87
    v_mul_f32 v234, v234, v231
    v_mul_f32 v235, v235, v231
    v_mul_f32 v236, v236, v231
    v_mul_f32 v237, v237, v231
    v_accvgpr_write_b32 a84, v234
    v_accvgpr_write_b32 a85, v235
    v_accvgpr_write_b32 a86, v236
    v_accvgpr_write_b32 a87, v237
    v_accvgpr_read_b32 v234, a88
    v_accvgpr_read_b32 v235, a89
    v_accvgpr_read_b32 v236, a90
    v_accvgpr_read_b32 v237, a91
    v_mul_f32 v234, v234, v231
    v_mul_f32 v235, v235, v231
    v_mul_f32 v236, v236, v231
    v_mul_f32 v237, v237, v231
    v_accvgpr_write_b32 a88, v234
    v_accvgpr_write_b32 a89, v235
    v_accvgpr_write_b32 a90, v236
    v_accvgpr_write_b32 a91, v237
    v_accvgpr_read_b32 v234, a92
    v_accvgpr_read_b32 v235, a93
    v_accvgpr_read_b32 v236, a94
    v_accvgpr_read_b32 v237, a95
    v_mul_f32 v234, v234, v231
    v_mul_f32 v235, v235, v231
    v_mul_f32 v236, v236, v231
    v_mul_f32 v237, v237, v231
    v_accvgpr_write_b32 a92, v234
    v_accvgpr_write_b32 a93, v235
    v_accvgpr_write_b32 a94, v236
    v_accvgpr_write_b32 a95, v237
    v_accvgpr_read_b32 v234, a96
    v_accvgpr_read_b32 v235, a97
    v_accvgpr_read_b32 v236, a98
    v_accvgpr_read_b32 v237, a99
    v_mul_f32 v234, v234, v231
    v_mul_f32 v235, v235, v231
    v_mul_f32 v236, v236, v231
    v_mul_f32 v237, v237, v231
    v_accvgpr_write_b32 a96, v234
    v_accvgpr_write_b32 a97, v235
    v_accvgpr_write_b32 a98, v236
    v_accvgpr_write_b32 a99, v237
    v_accvgpr_read_b32 v234, a100
    v_accvgpr_read_b32 v235, a101
    v_accvgpr_read_b32 v236, a102
    v_accvgpr_read_b32 v237, a103
    v_mul_f32 v234, v234, v231
    v_mul_f32 v235, v235, v231
    v_mul_f32 v236, v236, v231
    v_mul_f32 v237, v237, v231
    v_accvgpr_write_b32 a100, v234
    v_accvgpr_write_b32 a101, v235
    v_accvgpr_write_b32 a102, v236
    v_accvgpr_write_b32 a103, v237
    v_accvgpr_read_b32 v234, a104
    v_accvgpr_read_b32 v235, a105
    v_accvgpr_read_b32 v236, a106
    v_accvgpr_read_b32 v237, a107
    v_mul_f32 v234, v234, v231
    v_mul_f32 v235, v235, v231
    v_mul_f32 v236, v236, v231
    v_mul_f32 v237, v237, v231
    v_accvgpr_write_b32 a104, v234
    v_accvgpr_write_b32 a105, v235
    v_accvgpr_write_b32 a106, v236
    v_accvgpr_write_b32 a107, v237
    v_accvgpr_read_b32 v234, a108
    v_accvgpr_read_b32 v235, a109
    v_accvgpr_read_b32 v236, a110
    v_accvgpr_read_b32 v237, a111
    v_mul_f32 v234, v234, v231
    v_mul_f32 v235, v235, v231
    v_mul_f32 v236, v236, v231
    v_mul_f32 v237, v237, v231
    v_accvgpr_write_b32 a108, v234
    v_accvgpr_write_b32 a109, v235
    v_accvgpr_write_b32 a110, v236
    v_accvgpr_write_b32 a111, v237
    v_accvgpr_read_b32 v234, a112
    v_accvgpr_read_b32 v235, a113
    v_accvgpr_read_b32 v236, a114
    v_accvgpr_read_b32 v237, a115
    v_mul_f32 v234, v234, v231
    v_mul_f32 v235, v235, v231
    v_mul_f32 v236, v236, v231
    v_mul_f32 v237, v237, v231
    v_accvgpr_write_b32 a112, v234
    v_accvgpr_write_b32 a113, v235
    v_accvgpr_write_b32 a114, v236
    v_accvgpr_write_b32 a115, v237
    v_accvgpr_read_b32 v234, a116
    v_accvgpr_read_b32 v235, a117
    v_accvgpr_read_b32 v236, a118
    v_accvgpr_read_b32 v237, a119
    v_mul_f32 v234, v234, v231
    v_mul_f32 v235, v235, v231
    v_mul_f32 v236, v236, v231
    v_mul_f32 v237, v237, v231
    v_accvgpr_write_b32 a116, v234
    v_accvgpr_write_b32 a117, v235
    v_accvgpr_write_b32 a118, v236
    v_accvgpr_write_b32 a119, v237
    v_accvgpr_read_b32 v234, a120
    v_accvgpr_read_b32 v235, a121
    v_accvgpr_read_b32 v236, a122
    v_accvgpr_read_b32 v237, a123
    v_mul_f32 v234, v234, v231
    v_mul_f32 v235, v235, v231
    v_mul_f32 v236, v236, v231
    v_mul_f32 v237, v237, v231
    v_accvgpr_write_b32 a120, v234
    v_accvgpr_write_b32 a121, v235
    v_accvgpr_write_b32 a122, v236
    v_accvgpr_write_b32 a123, v237
    v_accvgpr_read_b32 v234, a124
    v_accvgpr_read_b32 v235, a125
    v_accvgpr_read_b32 v236, a126
    v_accvgpr_read_b32 v237, a127
    v_mul_f32 v234, v234, v231
    v_mul_f32 v235, v235, v231
    v_mul_f32 v236, v236, v231
    v_mul_f32 v237, v237, v231
    v_accvgpr_write_b32 a124, v234
    v_accvgpr_write_b32 a125, v235
    v_accvgpr_write_b32 a126, v236
    v_accvgpr_write_b32 a127, v237
    v_mov_b32 v230, 1.0
    v_mov_b32 v231, 1.0
    s_mov_b32 s30, 0
    s_nop 1
    s_branch RBACK_8
RARE_9:
    v_max3_f32 v242, v128, v129, v130
    v_max3_f32 v243, v131, v132, v133
    v_max3_f32 v242, v242, v134, v135
    v_max3_f32 v243, v243, v136, v137
    v_max3_f32 v242, v242, v138, v139
    v_max3_f32 v243, v243, v140, v141
    v_max3_f32 v242, v242, v142, v143
    v_max_f32 v242, v242, v243
    v_mov_b32 v243, v242
    s_nop 1
    v_permlane32_swap_b32 v242, v243
    s_nop 1
    v_max_f32 v242, v242, v243
    v_mul_f32 v242, s20, v242
    v_max_f32_e64 v242, v242, -v226
    v_add_f32 v243, v226, v242
    v_exp_f32_e64 v243, -v243
    v_sub_f32 v226, 0, v242
    v_mul_f32 v228, v228, v243
    v_mul_f32 v230, v230, v243
    s_mov_b32 s30, 1
    v_fma_f32 v234, v128, s20, v226
    v_fma_f32 v235, v129, s20, v226
    v_exp_f32 v234, v234
    v_fma_f32 v236, v130, s20, v226
    v_exp_f32 v235, v235
    v_fma_f32 v237, v131, s20, v226
    v_exp_f32 v236, v236
    v_mov_b32 v232, v234
    v_fma_f32 v238, v132, s20, v226
    v_exp_f32 v237, v237
    v_mov_b32 v233, v235
    v_cvt_pk_bf16_f32 v184, v234, v235
    v_fma_f32 v239, v133, s20, v226
    v_exp_f32 v238, v238
    v_add_f32 v232, v232, v236
    v_fma_f32 v240, v134, s20, v226
    v_exp_f32 v239, v239
    v_add_f32 v233, v233, v237
    v_cvt_pk_bf16_f32 v185, v236, v237
    v_fma_f32 v241, v135, s20, v226
    v_exp_f32 v240, v240
    v_add_f32 v232, v232, v238
    v_fma_f32 v234, v136, s20, v226
    v_exp_f32 v241, v241
    v_add_f32 v233, v233, v239
    v_cvt_pk_bf16_f32 v186, v238, v239
    v_fma_f32 v235, v137, s20, v226
    v_exp_f32 v234, v234
    v_add_f32 v232, v232, v240
    v_fma_f32 v236, v138, s20, v226
    v_exp_f32 v235, v235
    v_add_f32 v233, v233, v241
    v_cvt_pk_bf16_f32 v187, v240, v241
    v_fma_f32 v237, v139, s20, v226
    v_exp_f32 v236, v236
    v_add_f32 v232, v232, v234
    v_fma_f32 v238, v140, s20, v226
    v_exp_f32 v237, v237
    v_add_f32 v233, v233, v235
    v_cvt_pk_bf16_f32 v188, v234, v235
    v_fma_f32 v239, v141, s20, v226
    v_exp_f32 v238, v238
    v_add_f32 v232, v232, v236
    v_fma_f32 v240, v142, s20, v226
    v_exp_f32 v239, v239
    v_add_f32 v233, v233, v237
    v_cvt_pk_bf16_f32 v189, v236, v237
    v_fma_f32 v241, v143, s20, v226
    v_exp_f32 v240, v240
    v_add_f32 v232, v232, v238
    v_exp_f32 v241, v241
    v_add_f32 v233, v233, v239
    v_cvt_pk_bf16_f32 v190, v238, v239
    v_add_f32 v232, v232, v240
    v_add_f32 v233, v233, v241
    v_cvt_pk_bf16_f32 v191, v240, v241
    v_add_f32 v232, v232, v233
    s_branch BACK_9
RARE_10:
    v_max3_f32 v242, v160, v161, v162
    v_max3_f32 v243, v163, v164, v165
    v_max3_f32 v242, v242, v166, v167
    v_max3_f32 v243, v243, v168, v169
    v_max3_f32 v242, v242, v170, v171
    v_max3_f32 v243, v243, v172, v173
    v_max3_f32 v242, v242, v174, v175
    v_max_f32 v242, v242, v243
    v_mov_b32 v243, v242
    s_nop 1
    v_permlane32_swap_b32 v242, v243
    s_nop 1
    v_max_f32 v242, v242, v243
    v_mul_f32 v242, s20, v242
    v_max_f32_e64 v242, v242, -v227
    v_add_f32 v243, v227, v242
    v_exp_f32_e64 v243, -v243
    v_sub_f32 v227, 0, v242
    v_mul_f32 v229, v229, v243
    v_mul_f32 v231, v231, v243
    s_mov_b32 s30, 1
    v_fma_f32 v234, v160, s20, v227
    v_fma_f32 v235, v161, s20, v227
    v_exp_f32 v234, v234
    v_fma_f32 v236, v162, s20, v227
    v_exp_f32 v235, v235
    v_fma_f32 v237, v163, s20, v227
    v_exp_f32 v236, v236
    v_mov_b32 v232, v234
    v_fma_f32 v238, v164, s20, v227
    v_exp_f32 v237, v237
    v_mov_b32 v233, v235
    v_cvt_pk_bf16_f32 v192, v234, v235
    v_fma_f32 v239, v165, s20, v227
    v_exp_f32 v238, v238
    v_add_f32 v232, v232, v236
    v_fma_f32 v240, v166, s20, v227
    v_exp_f32 v239, v239
    v_add_f32 v233, v233, v237
    v_cvt_pk_bf16_f32 v193, v236, v237
    v_fma_f32 v241, v167, s20, v227
    v_exp_f32 v240, v240
    v_add_f32 v232, v232, v238
    v_fma_f32 v234, v168, s20, v227
    v_exp_f32 v241, v241
    v_add_f32 v233, v233, v239
    v_cvt_pk_bf16_f32 v194, v238, v239
    v_fma_f32 v235, v169, s20, v227
    v_exp_f32 v234, v234
    v_add_f32 v232, v232, v240
    v_fma_f32 v236, v170, s20, v227
    v_exp_f32 v235, v235
    v_add_f32 v233, v233, v241
    v_cvt_pk_bf16_f32 v195, v240, v241
    v_fma_f32 v237, v171, s20, v227
    v_exp_f32 v236, v236
    v_add_f32 v232, v232, v234
    v_fma_f32 v238, v172, s20, v227
    v_exp_f32 v237, v237
    v_add_f32 v233, v233, v235
    v_cvt_pk_bf16_f32 v196, v234, v235
    v_fma_f32 v239, v173, s20, v227
    v_exp_f32 v238, v238
    v_add_f32 v232, v232, v236
    v_fma_f32 v240, v174, s20, v227
    v_exp_f32 v239, v239
    v_add_f32 v233, v233, v237
    v_cvt_pk_bf16_f32 v197, v236, v237
    v_fma_f32 v241, v175, s20, v227
    v_exp_f32 v240, v240
    v_add_f32 v232, v232, v238
    v_exp_f32 v241, v241
    v_add_f32 v233, v233, v239
    v_cvt_pk_bf16_f32 v198, v238, v239
    v_add_f32 v232, v232, v240
    v_add_f32 v233, v233, v241
    v_cvt_pk_bf16_f32 v199, v240, v241
    v_add_f32 v232, v232, v233
    s_branch BACK_10
RESC_11:
    s_nop 7
    s_nop 7
    v_mul_f32 v0, v0, v230
    v_mul_f32 v1, v1, v230
    v_mul_f32 v2, v2, v230
    v_mul_f32 v3, v3, v230
    v_mul_f32 v4, v4, v230
    v_mul_f32 v5, v5, v230
    v_mul_f32 v6, v6, v230
    v_mul_f32 v7, v7, v230
    v_mul_f32 v8, v8, v230
    v_mul_f32 v9, v9, v230
    v_mul_f32 v10, v10, v230
    v_mul_f32 v11, v11, v230
    v_mul_f32 v12, v12, v230
    v_mul_f32 v13, v13, v230
    v_mul_f32 v14, v14, v230
    v_mul_f32 v15, v15, v230
    v_mul_f32 v16, v16, v230
    v_mul_f32 v17, v17, v230
    v_mul_f32 v18, v18, v230
    v_mul_f32 v19, v19, v230
    v_mul_f32 v20, v20, v230
    v_mul_f32 v21, v21, v230
    v_mul_f32 v22, v22, v230
    v_mul_f32 v23, v23, v230
    v_mul_f32 v24, v24, v230
    v_mul_f32 v25, v25, v230
    v_mul_f32 v26, v26, v230
    v_mul_f32 v27, v27, v230
    v_mul_f32 v28, v28, v230
    v_mul_f32 v29, v29, v230
    v_mul_f32 v30, v30, v230
    v_mul_f32 v31, v31, v230
    v_mul_f32 v32, v32, v230
    v_mul_f32 v33, v33, v230
    v_mul_f32 v34, v34, v230
    v_mul_f32 v35, v35, v230
    v_mul_f32 v36, v36, v230
    v_mul_f32 v37, v37, v230
    v_mul_f32 v38, v38, v230
    v_mul_f32 v39, v39, v230
    v_mul_f32 v40, v40, v230
    v_mul_f32 v41, v41, v230
    v_mul_f32 v42, v42, v230
    v_mul_f32 v43, v43, v230
    v_mul_f32 v44, v44, v230
    v_mul_f32 v45, v45, v230
    v_mul_f32 v46, v46, v230
    v_mul_f32 v47, v47, v230
    v_mul_f32 v48, v48, v230
    v_mul_f32 v49, v49, v230
    v_mul_f32 v50, v50, v230
    v_mul_f32 v51, v51, v230
    v_mul_f32 v52, v52, v230
    v_mul_f32 v53, v53, v230
    v_mul_f32 v54, v54, v230
    v_mul_f32 v55, v55, v230
    v_mul_f32 v56, v56, v230
    v_mul_f32 v57, v57, v230
    v_mul_f32 v58, v58, v230
    v_mul_f32 v59, v59, v230
    v_mul_f32 v60, v60, v230
    v_mul_f32 v61, v61, v230
    v_mul_f32 v62, v62, v230
    v_mul_f32 v63, v63, v230
    v_mul_f32 v64, v64, v230
    v_mul_f32 v65, v65, v230
    v_mul_f32 v66, v66, v230
    v_mul_f32 v67, v67, v230
    v_mul_f32 v68, v68, v230
    v_mul_f32 v69, v69, v230
    v_mul_f32 v70, v70, v230
    v_mul_f32 v71, v71, v230
    v_mul_f32 v72, v72, v230
    v_mul_f32 v73, v73, v230
    v_mul_f32 v74, v74, v230
    v_mul_f32 v75, v75, v230
    v_mul_f32 v76, v76, v230
    v_mul_f32 v77, v77, v230
    v_mul_f32 v78, v78, v230
    v_mul_f32 v79, v79, v230
    v_mul_f32 v80, v80, v230
    v_mul_f32 v81, v81, v230
    v_mul_f32 v82, v82, v230
    v_mul_f32 v83, v83, v230
    v_mul_f32 v84, v84, v230
    v_mul_f32 v85, v85, v230
    v_mul_f32 v86, v86, v230
    v_mul_f32 v87, v87, v230
    v_mul_f32 v88, v88, v230
    v_mul_f32 v89, v89, v230
    v_mul_f32 v90, v90, v230
    v_mul_f32 v91, v91, v230
    v_mul_f32 v92, v92, v230
    v_mul_f32 v93, v93, v230
    v_mul_f32 v94, v94, v230
    v_mul_f32 v95, v95, v230
    v_mul_f32 v96, v96, v230
    v_mul_f32 v97, v97, v230
    v_mul_f32 v98, v98, v230
    v_mul_f32 v99, v99, v230
    v_mul_f32 v100, v100, v230
    v_mul_f32 v101, v101, v230
    v_mul_f32 v102, v102, v230
    v_mul_f32 v103, v103, v230
    v_mul_f32 v104, v104, v230
    v_mul_f32 v105, v105, v230
    v_mul_f32 v106, v106, v230
    v_mul_f32 v107, v107, v230
    v_mul_f32 v108, v108, v230
    v_mul_f32 v109, v109, v230
    v_mul_f32 v110, v110, v230
    v_mul_f32 v111, v111, v230
    v_mul_f32 v112, v112, v230
    v_mul_f32 v113, v113, v230
    v_mul_f32 v114, v114, v230
    v_mul_f32 v115, v115, v230
    v_mul_f32 v116, v116, v230
    v_mul_f32 v117, v117, v230
    v_mul_f32 v118, v118, v230
    v_mul_f32 v119, v119, v230
    v_mul_f32 v120, v120, v230
    v_mul_f32 v121, v121, v230
    v_mul_f32 v122, v122, v230
    v_mul_f32 v123, v123, v230
    v_mul_f32 v124, v124, v230
    v_mul_f32 v125, v125, v230
    v_mul_f32 v126, v126, v230
    v_mul_f32 v127, v127, v230
    v_accvgpr_read_b32 v234, a0
    v_accvgpr_read_b32 v235, a1
    v_accvgpr_read_b32 v236, a2
    v_accvgpr_read_b32 v237, a3
    v_mul_f32 v234, v234, v231
    v_mul_f32 v235, v235, v231
    v_mul_f32 v236, v236, v231
    v_mul_f32 v237, v237, v231
    v_accvgpr_write_b32 a0, v234
    v_accvgpr_write_b32 a1, v235
    v_accvgpr_write_b32 a2, v236
    v_accvgpr_write_b32 a3, v237
    v_accvgpr_read_b32 v234, a4
    v_accvgpr_read_b32 v235, a5
    v_accvgpr_read_b32 v236, a6
    v_accvgpr_read_b32 v237, a7
    v_mul_f32 v234, v234, v231
    v_mul_f32 v235, v235, v231
    v_mul_f32 v236, v236, v231
    v_mul_f32 v237, v237, v231
    v_accvgpr_write_b32 a4, v234
    v_accvgpr_write_b32 a5, v235
    v_accvgpr_write_b32 a6, v236
    v_accvgpr_write_b32 a7, v237
    v_accvgpr_read_b32 v234, a8
    v_accvgpr_read_b32 v235, a9
    v_accvgpr_read_b32 v236, a10
    v_accvgpr_read_b32 v237, a11
    v_mul_f32 v234, v234, v231
    v_mul_f32 v235, v235, v231
    v_mul_f32 v236, v236, v231
    v_mul_f32 v237, v237, v231
    v_accvgpr_write_b32 a8, v234
    v_accvgpr_write_b32 a9, v235
    v_accvgpr_write_b32 a10, v236
    v_accvgpr_write_b32 a11, v237
    v_accvgpr_read_b32 v234, a12
    v_accvgpr_read_b32 v235, a13
    v_accvgpr_read_b32 v236, a14
    v_accvgpr_read_b32 v237, a15
    v_mul_f32 v234, v234, v231
    v_mul_f32 v235, v235, v231
    v_mul_f32 v236, v236, v231
    v_mul_f32 v237, v237, v231
    v_accvgpr_write_b32 a12, v234
    v_accvgpr_write_b32 a13, v235
    v_accvgpr_write_b32 a14, v236
    v_accvgpr_write_b32 a15, v237
    v_accvgpr_read_b32 v234, a16
    v_accvgpr_read_b32 v235, a17
    v_accvgpr_read_b32 v236, a18
    v_accvgpr_read_b32 v237, a19
    v_mul_f32 v234, v234, v231
    v_mul_f32 v235, v235, v231
    v_mul_f32 v236, v236, v231
    v_mul_f32 v237, v237, v231
    v_accvgpr_write_b32 a16, v234
    v_accvgpr_write_b32 a17, v235
    v_accvgpr_write_b32 a18, v236
    v_accvgpr_write_b32 a19, v237
    v_accvgpr_read_b32 v234, a20
    v_accvgpr_read_b32 v235, a21
    v_accvgpr_read_b32 v236, a22
    v_accvgpr_read_b32 v237, a23
    v_mul_f32 v234, v234, v231
    v_mul_f32 v235, v235, v231
    v_mul_f32 v236, v236, v231
    v_mul_f32 v237, v237, v231
    v_accvgpr_write_b32 a20, v234
    v_accvgpr_write_b32 a21, v235
    v_accvgpr_write_b32 a22, v236
    v_accvgpr_write_b32 a23, v237
    v_accvgpr_read_b32 v234, a24
    v_accvgpr_read_b32 v235, a25
    v_accvgpr_read_b32 v236, a26
    v_accvgpr_read_b32 v237, a27
    v_mul_f32 v234, v234, v231
    v_mul_f32 v235, v235, v231
    v_mul_f32 v236, v236, v231
    v_mul_f32 v237, v237, v231
    v_accvgpr_write_b32 a24, v234
    v_accvgpr_write_b32 a25, v235
    v_accvgpr_write_b32 a26, v236
    v_accvgpr_write_b32 a27, v237
    v_accvgpr_read_b32 v234, a28
    v_accvgpr_read_b32 v235, a29
    v_accvgpr_read_b32 v236, a30
    v_accvgpr_read_b32 v237, a31
    v_mul_f32 v234, v234, v231
    v_mul_f32 v235, v235, v231
    v_mul_f32 v236, v236, v231
    v_mul_f32 v237, v237, v231
    v_accvgpr_write_b32 a28, v234
    v_accvgpr_write_b32 a29, v235
    v_accvgpr_write_b32 a30, v236
    v_accvgpr_write_b32 a31, v237
    v_accvgpr_read_b32 v234, a32
    v_accvgpr_read_b32 v235, a33
    v_accvgpr_read_b32 v236, a34
    v_accvgpr_read_b32 v237, a35
    v_mul_f32 v234, v234, v231
    v_mul_f32 v235, v235, v231
    v_mul_f32 v236, v236, v231
    v_mul_f32 v237, v237, v231
    v_accvgpr_write_b32 a32, v234
    v_accvgpr_write_b32 a33, v235
    v_accvgpr_write_b32 a34, v236
    v_accvgpr_write_b32 a35, v237
    v_accvgpr_read_b32 v234, a36
    v_accvgpr_read_b32 v235, a37
    v_accvgpr_read_b32 v236, a38
    v_accvgpr_read_b32 v237, a39
    v_mul_f32 v234, v234, v231
    v_mul_f32 v235, v235, v231
    v_mul_f32 v236, v236, v231
    v_mul_f32 v237, v237, v231
    v_accvgpr_write_b32 a36, v234
    v_accvgpr_write_b32 a37, v235
    v_accvgpr_write_b32 a38, v236
    v_accvgpr_write_b32 a39, v237
    v_accvgpr_read_b32 v234, a40
    v_accvgpr_read_b32 v235, a41
    v_accvgpr_read_b32 v236, a42
    v_accvgpr_read_b32 v237, a43
    v_mul_f32 v234, v234, v231
    v_mul_f32 v235, v235, v231
    v_mul_f32 v236, v236, v231
    v_mul_f32 v237, v237, v231
    v_accvgpr_write_b32 a40, v234
    v_accvgpr_write_b32 a41, v235
    v_accvgpr_write_b32 a42, v236
    v_accvgpr_write_b32 a43, v237
    v_accvgpr_read_b32 v234, a44
    v_accvgpr_read_b32 v235, a45
    v_accvgpr_read_b32 v236, a46
    v_accvgpr_read_b32 v237, a47
    v_mul_f32 v234, v234, v231
    v_mul_f32 v235, v235, v231
    v_mul_f32 v236, v236, v231
    v_mul_f32 v237, v237, v231
    v_accvgpr_write_b32 a44, v234
    v_accvgpr_write_b32 a45, v235
    v_accvgpr_write_b32 a46, v236
    v_accvgpr_write_b32 a47, v237
    v_accvgpr_read_b32 v234, a48
    v_accvgpr_read_b32 v235, a49
    v_accvgpr_read_b32 v236, a50
    v_accvgpr_read_b32 v237, a51
    v_mul_f32 v234, v234, v231
    v_mul_f32 v235, v235, v231
    v_mul_f32 v236, v236, v231
    v_mul_f32 v237, v237, v231
    v_accvgpr_write_b32 a48, v234
    v_accvgpr_write_b32 a49, v235
    v_accvgpr_write_b32 a50, v236
    v_accvgpr_write_b32 a51, v237
    v_accvgpr_read_b32 v234, a52
    v_accvgpr_read_b32 v235, a53
    v_accvgpr_read_b32 v236, a54
    v_accvgpr_read_b32 v237, a55
    v_mul_f32 v234, v234, v231
    v_mul_f32 v235, v235, v231
    v_mul_f32 v236, v236, v231
    v_mul_f32 v237, v237, v231
    v_accvgpr_write_b32 a52, v234
    v_accvgpr_write_b32 a53, v235
    v_accvgpr_write_b32 a54, v236
    v_accvgpr_write_b32 a55, v237
    v_accvgpr_read_b32 v234, a56
    v_accvgpr_read_b32 v235, a57
    v_accvgpr_read_b32 v236, a58
    v_accvgpr_read_b32 v237, a59
    v_mul_f32 v234, v234, v231
    v_mul_f32 v235, v235, v231
    v_mul_f32 v236, v236, v231
    v_mul_f32 v237, v237, v231
    v_accvgpr_write_b32 a56, v234
    v_accvgpr_write_b32 a57, v235
    v_accvgpr_write_b32 a58, v236
    v_accvgpr_write_b32 a59, v237
    v_accvgpr_read_b32 v234, a60
    v_accvgpr_read_b32 v235, a61
    v_accvgpr_read_b32 v236, a62
    v_accvgpr_read_b32 v237, a63
    v_mul_f32 v234, v234, v231
    v_mul_f32 v235, v235, v231
    v_mul_f32 v236, v236, v231
    v_mul_f32 v237, v237, v231
    v_accvgpr_write_b32 a60, v234
    v_accvgpr_write_b32 a61, v235
    v_accvgpr_write_b32 a62, v236
    v_accvgpr_write_b32 a63, v237
    v_accvgpr_read_b32 v234, a64
    v_accvgpr_read_b32 v235, a65
    v_accvgpr_read_b32 v236, a66
    v_accvgpr_read_b32 v237, a67
    v_mul_f32 v234, v234, v231
    v_mul_f32 v235, v235, v231
    v_mul_f32 v236, v236, v231
    v_mul_f32 v237, v237, v231
    v_accvgpr_write_b32 a64, v234
    v_accvgpr_write_b32 a65, v235
    v_accvgpr_write_b32 a66, v236
    v_accvgpr_write_b32 a67, v237
    v_accvgpr_read_b32 v234, a68
    v_accvgpr_read_b32 v235, a69
    v_accvgpr_read_b32 v236, a70
    v_accvgpr_read_b32 v237, a71
    v_mul_f32 v234, v234, v231
    v_mul_f32 v235, v235, v231
    v_mul_f32 v236, v236, v231
    v_mul_f32 v237, v237, v231
    v_accvgpr_write_b32 a68, v234
    v_accvgpr_write_b32 a69, v235
    v_accvgpr_write_b32 a70, v236
    v_accvgpr_write_b32 a71, v237
    v_accvgpr_read_b32 v234, a72
    v_accvgpr_read_b32 v235, a73
    v_accvgpr_read_b32 v236, a74
    v_accvgpr_read_b32 v237, a75
    v_mul_f32 v234, v234, v231
    v_mul_f32 v235, v235, v231
    v_mul_f32 v236, v236, v231
    v_mul_f32 v237, v237, v231
    v_accvgpr_write_b32 a72, v234
    v_accvgpr_write_b32 a73, v235
    v_accvgpr_write_b32 a74, v236
    v_accvgpr_write_b32 a75, v237
    v_accvgpr_read_b32 v234, a76
    v_accvgpr_read_b32 v235, a77
    v_accvgpr_read_b32 v236, a78
    v_accvgpr_read_b32 v237, a79
    v_mul_f32 v234, v234, v231
    v_mul_f32 v235, v235, v231
    v_mul_f32 v236, v236, v231
    v_mul_f32 v237, v237, v231
    v_accvgpr_write_b32 a76, v234
    v_accvgpr_write_b32 a77, v235
    v_accvgpr_write_b32 a78, v236
    v_accvgpr_write_b32 a79, v237
    v_accvgpr_read_b32 v234, a80
    v_accvgpr_read_b32 v235, a81
    v_accvgpr_read_b32 v236, a82
    v_accvgpr_read_b32 v237, a83
    v_mul_f32 v234, v234, v231
    v_mul_f32 v235, v235, v231
    v_mul_f32 v236, v236, v231
    v_mul_f32 v237, v237, v231
    v_accvgpr_write_b32 a80, v234
    v_accvgpr_write_b32 a81, v235
    v_accvgpr_write_b32 a82, v236
    v_accvgpr_write_b32 a83, v237
    v_accvgpr_read_b32 v234, a84
    v_accvgpr_read_b32 v235, a85
    v_accvgpr_read_b32 v236, a86
    v_accvgpr_read_b32 v237, a87
    v_mul_f32 v234, v234, v231
    v_mul_f32 v235, v235, v231
    v_mul_f32 v236, v236, v231
    v_mul_f32 v237, v237, v231
    v_accvgpr_write_b32 a84, v234
    v_accvgpr_write_b32 a85, v235
    v_accvgpr_write_b32 a86, v236
    v_accvgpr_write_b32 a87, v237
    v_accvgpr_read_b32 v234, a88
    v_accvgpr_read_b32 v235, a89
    v_accvgpr_read_b32 v236, a90
    v_accvgpr_read_b32 v237, a91
    v_mul_f32 v234, v234, v231
    v_mul_f32 v235, v235, v231
    v_mul_f32 v236, v236, v231
    v_mul_f32 v237, v237, v231
    v_accvgpr_write_b32 a88, v234
    v_accvgpr_write_b32 a89, v235
    v_accvgpr_write_b32 a90, v236
    v_accvgpr_write_b32 a91, v237
    v_accvgpr_read_b32 v234, a92
    v_accvgpr_read_b32 v235, a93
    v_accvgpr_read_b32 v236, a94
    v_accvgpr_read_b32 v237, a95
    v_mul_f32 v234, v234, v231
    v_mul_f32 v235, v235, v231
    v_mul_f32 v236, v236, v231
    v_mul_f32 v237, v237, v231
    v_accvgpr_write_b32 a92, v234
    v_accvgpr_write_b32 a93, v235
    v_accvgpr_write_b32 a94, v236
    v_accvgpr_write_b32 a95, v237
    v_accvgpr_read_b32 v234, a96
    v_accvgpr_read_b32 v235, a97
    v_accvgpr_read_b32 v236, a98
    v_accvgpr_read_b32 v237, a99
    v_mul_f32 v234, v234, v231
    v_mul_f32 v235, v235, v231
    v_mul_f32 v236, v236, v231
    v_mul_f32 v237, v237, v231
    v_accvgpr_write_b32 a96, v234
    v_accvgpr_write_b32 a97, v235
    v_accvgpr_write_b32 a98, v236
    v_accvgpr_write_b32 a99, v237
    v_accvgpr_read_b32 v234, a100
    v_accvgpr_read_b32 v235, a101
    v_accvgpr_read_b32 v236, a102
    v_accvgpr_read_b32 v237, a103
    v_mul_f32 v234, v234, v231
    v_mul_f32 v235, v235, v231
    v_mul_f32 v236, v236, v231
    v_mul_f32 v237, v237, v231
    v_accvgpr_write_b32 a100, v234
    v_accvgpr_write_b32 a101, v235
    v_accvgpr_write_b32 a102, v236
    v_accvgpr_write_b32 a103, v237
    v_accvgpr_read_b32 v234, a104
    v_accvgpr_read_b32 v235, a105
    v_accvgpr_read_b32 v236, a106
    v_accvgpr_read_b32 v237, a107
    v_mul_f32 v234, v234, v231
    v_mul_f32 v235, v235, v231
    v_mul_f32 v236, v236, v231
    v_mul_f32 v237, v237, v231
    v_accvgpr_write_b32 a104, v234
    v_accvgpr_write_b32 a105, v235
    v_accvgpr_write_b32 a106, v236
    v_accvgpr_write_b32 a107, v237
    v_accvgpr_read_b32 v234, a108
    v_accvgpr_read_b32 v235, a109
    v_accvgpr_read_b32 v236, a110
    v_accvgpr_read_b32 v237, a111
    v_mul_f32 v234, v234, v231
    v_mul_f32 v235, v235, v231
    v_mul_f32 v236, v236, v231
    v_mul_f32 v237, v237, v231
    v_accvgpr_write_b32 a108, v234
    v_accvgpr_write_b32 a109, v235
    v_accvgpr_write_b32 a110, v236
    v_accvgpr_write_b32 a111, v237
    v_accvgpr_read_b32 v234, a112
    v_accvgpr_read_b32 v235, a113
    v_accvgpr_read_b32 v236, a114
    v_accvgpr_read_b32 v237, a115
    v_mul_f32 v234, v234, v231
    v_mul_f32 v235, v235, v231
    v_mul_f32 v236, v236, v231
    v_mul_f32 v237, v237, v231
    v_accvgpr_write_b32 a112, v234
    v_accvgpr_write_b32 a113, v235
    v_accvgpr_write_b32 a114, v236
    v_accvgpr_write_b32 a115, v237
    v_accvgpr_read_b32 v234, a116
    v_accvgpr_read_b32 v235, a117
    v_accvgpr_read_b32 v236, a118
    v_accvgpr_read_b32 v237, a119
    v_mul_f32 v234, v234, v231
    v_mul_f32 v235, v235, v231
    v_mul_f32 v236, v236, v231
    v_mul_f32 v237, v237, v231
    v_accvgpr_write_b32 a116, v234
    v_accvgpr_write_b32 a117, v235
    v_accvgpr_write_b32 a118, v236
    v_accvgpr_write_b32 a119, v237
    v_accvgpr_read_b32 v234, a120
    v_accvgpr_read_b32 v235, a121
    v_accvgpr_read_b32 v236, a122
    v_accvgpr_read_b32 v237, a123
    v_mul_f32 v234, v234, v231
    v_mul_f32 v235, v235, v231
    v_mul_f32 v236, v236, v231
    v_mul_f32 v237, v237, v231
    v_accvgpr_write_b32 a120, v234
    v_accvgpr_write_b32 a121, v235
    v_accvgpr_write_b32 a122, v236
    v_accvgpr_write_b32 a123, v237
    v_accvgpr_read_b32 v234, a124
    v_accvgpr_read_b32 v235, a125
    v_accvgpr_read_b32 v236, a126
    v_accvgpr_read_b32 v237, a127
    v_mul_f32 v234, v234, v231
    v_mul_f32 v235, v235, v231
    v_mul_f32 v236, v236, v231
    v_mul_f32 v237, v237, v231
    v_accvgpr_write_b32 a124, v234
    v_accvgpr_write_b32 a125, v235
    v_accvgpr_write_b32 a126, v236
    v_accvgpr_write_b32 a127, v237
    v_mov_b32 v230, 1.0
    v_mov_b32 v231, 1.0
    s_mov_b32 s30, 0
    s_nop 1
    s_branch RBACK_11
RARE_12:
    v_max3_f32 v242, v128, v129, v130
    v_max3_f32 v243, v131, v132, v133
    v_max3_f32 v242, v242, v134, v135
    v_max3_f32 v243, v243, v136, v137
    v_max3_f32 v242, v242, v138, v139
    v_max3_f32 v243, v243, v140, v141
    v_max3_f32 v242, v242, v142, v143
    v_max_f32 v242, v242, v243
    v_mov_b32 v243, v242
    s_nop 1
    v_permlane32_swap_b32 v242, v243
    s_nop 1
    v_max_f32 v242, v242, v243
    v_mul_f32 v242, s20, v242
    v_max_f32_e64 v242, v242, -v226
    v_add_f32 v243, v226, v242
    v_exp_f32_e64 v243, -v243
    v_sub_f32 v226, 0, v242
    v_mul_f32 v228, v228, v243
    v_mul_f32 v230, v230, v243
    s_mov_b32 s30, 1
    v_fma_f32 v234, v128, s20, v226
    v_fma_f32 v235, v129, s20, v226
    v_exp_f32 v234, v234
    v_fma_f32 v236, v130, s20, v226
    v_exp_f32 v235, v235
    v_fma_f32 v237, v131, s20, v226
    v_exp_f32 v236, v236
    v_mov_b32 v232, v234
    v_fma_f32 v238, v132, s20, v226
    v_exp_f32 v237, v237
    v_mov_b32 v233, v235
    v_cvt_pk_bf16_f32 v176, v234, v235
    v_fma_f32 v239, v133, s20, v226
    v_exp_f32 v238, v238
    v_add_f32 v232, v232, v236
    v_fma_f32 v240, v134, s20, v226
    v_exp_f32 v239, v239
    v_add_f32 v233, v233, v237
    v_cvt_pk_bf16_f32 v177, v236, v237
    v_fma_f32 v241, v135, s20, v226
    v_exp_f32 v240, v240
    v_add_f32 v232, v232, v238
    v_fma_f32 v234, v136, s20, v226
    v_exp_f32 v241, v241
    v_add_f32 v233, v233, v239
    v_cvt_pk_bf16_f32 v178, v238, v239
    v_fma_f32 v235, v137, s20, v226
    v_exp_f32 v234, v234
    v_add_f32 v232, v232, v240
    v_fma_f32 v236, v138, s20, v226
    v_exp_f32 v235, v235
    v_add_f32 v233, v233, v241
    v_cvt_pk_bf16_f32 v179, v240, v241
    v_fma_f32 v237, v139, s20, v226
    v_exp_f32 v236, v236
    v_add_f32 v232, v232, v234
    v_fma_f32 v238, v140, s20, v226
    v_exp_f32 v237, v237
    v_add_f32 v233, v233, v235
    v_cvt_pk_bf16_f32 v180, v234, v235
    v_fma_f32 v239, v141, s20, v226
    v_exp_f32 v238, v238
    v_add_f32 v232, v232, v236
    v_fma_f32 v240, v142, s20, v226
    v_exp_f32 v239, v239
    v_add_f32 v233, v233, v237
    v_cvt_pk_bf16_f32 v181, v236, v237
    v_fma_f32 v241, v143, s20, v226
    v_exp_f32 v240, v240
    v_add_f32 v232, v232, v238
    v_exp_f32 v241, v241
    v_add_f32 v233, v233, v239
    v_cvt_pk_bf16_f32 v182, v238, v239
    v_add_f32 v232, v232, v240
    v_add_f32 v233, v233, v241
    v_cvt_pk_bf16_f32 v183, v240, v241
    v_add_f32 v232, v232, v233
    s_branch BACK_12
RARE_13:
    v_max3_f32 v242, v144, v145, v146
    v_max3_f32 v243, v147, v148, v149
    v_max3_f32 v242, v242, v150, v151
    v_max3_f32 v243, v243, v152, v153
    v_max3_f32 v242, v242, v154, v155
    v_max3_f32 v243, v243, v156, v157
    v_max3_f32 v242, v242, v158, v159
    v_max_f32 v242, v242, v243
    v_mov_b32 v243, v242
    s_nop 1
    v_permlane32_swap_b32 v242, v243
    s_nop 1
    v_max_f32 v242, v242, v243
    v_mul_f32 v242, s20, v242
    v_max_f32_e64 v242, v242, -v227
    v_add_f32 v243, v227, v242
    v_exp_f32_e64 v243, -v243
    v_sub_f32 v227, 0, v242
    v_mul_f32 v229, v229, v243
    v_mul_f32 v231, v231, v243
    s_mov_b32 s30, 1
    v_fma_f32 v234, v144, s20, v227
    v_fma_f32 v235, v145, s20, v227
    v_exp_f32 v234, v234
    v_fma_f32 v236, v146, s20, v227
    v_exp_f32 v235, v235
    v_fma_f32 v237, v147, s20, v227
    v_exp_f32 v236, v236
    v_mov_b32 v232, v234
    v_fma_f32 v238, v148, s20, v227
    v_exp_f32 v237, v237
    v_mov_b32 v233, v235
    v_cvt_pk_bf16_f32 v192, v234, v235
    v_fma_f32 v239, v149, s20, v227
    v_exp_f32 v238, v238
    v_add_f32 v232, v232, v236
    v_fma_f32 v240, v150, s20, v227
    v_exp_f32 v239, v239
    v_add_f32 v233, v233, v237
    v_cvt_pk_bf16_f32 v193, v236, v237
    v_fma_f32 v241, v151, s20, v227
    v_exp_f32 v240, v240
    v_add_f32 v232, v232, v238
    v_fma_f32 v234, v152, s20, v227
    v_exp_f32 v241, v241
    v_add_f32 v233, v233, v239
    v_cvt_pk_bf16_f32 v194, v238, v239
    v_fma_f32 v235, v153, s20, v227
    v_exp_f32 v234, v234
    v_add_f32 v232, v232, v240
    v_fma_f32 v236, v154, s20, v227
    v_exp_f32 v235, v235
    v_add_f32 v233, v233, v241
    v_cvt_pk_bf16_f32 v195, v240, v241
    v_fma_f32 v237, v155, s20, v227
    v_exp_f32 v236, v236
    v_add_f32 v232, v232, v234
    v_fma_f32 v238, v156, s20, v227
    v_exp_f32 v237, v237
    v_add_f32 v233, v233, v235
    v_cvt_pk_bf16_f32 v196, v234, v235
    v_fma_f32 v239, v157, s20, v227
    v_exp_f32 v238, v238
    v_add_f32 v232, v232, v236
    v_fma_f32 v240, v158, s20, v227
    v_exp_f32 v239, v239
    v_add_f32 v233, v233, v237
    v_cvt_pk_bf16_f32 v197, v236, v237
    v_fma_f32 v241, v159, s20, v227
    v_exp_f32 v240, v240
    v_add_f32 v232, v232, v238
    v_exp_f32 v241, v241
    v_add_f32 v233, v233, v239
    v_cvt_pk_bf16_f32 v198, v238, v239
    v_add_f32 v232, v232, v240
    v_add_f32 v233, v233, v241
    v_cvt_pk_bf16_f32 v199, v240, v241
    v_add_f32 v232, v232, v233
    s_branch BACK_13
RESC_14:
    s_nop 7
    s_nop 7
    v_mul_f32 v0, v0, v230
    v_mul_f32 v1, v1, v230
    v_mul_f32 v2, v2, v230
    v_mul_f32 v3, v3, v230
    v_mul_f32 v4, v4, v230
    v_mul_f32 v5, v5, v230
    v_mul_f32 v6, v6, v230
    v_mul_f32 v7, v7, v230
    v_mul_f32 v8, v8, v230
    v_mul_f32 v9, v9, v230
    v_mul_f32 v10, v10, v230
    v_mul_f32 v11, v11, v230
    v_mul_f32 v12, v12, v230
    v_mul_f32 v13, v13, v230
    v_mul_f32 v14, v14, v230
    v_mul_f32 v15, v15, v230
    v_mul_f32 v16, v16, v230
    v_mul_f32 v17, v17, v230
    v_mul_f32 v18, v18, v230
    v_mul_f32 v19, v19, v230
    v_mul_f32 v20, v20, v230
    v_mul_f32 v21, v21, v230
    v_mul_f32 v22, v22, v230
    v_mul_f32 v23, v23, v230
    v_mul_f32 v24, v24, v230
    v_mul_f32 v25, v25, v230
    v_mul_f32 v26, v26, v230
    v_mul_f32 v27, v27, v230
    v_mul_f32 v28, v28, v230
    v_mul_f32 v29, v29, v230
    v_mul_f32 v30, v30, v230
    v_mul_f32 v31, v31, v230
    v_mul_f32 v32, v32, v230
    v_mul_f32 v33, v33, v230
    v_mul_f32 v34, v34, v230
    v_mul_f32 v35, v35, v230
    v_mul_f32 v36, v36, v230
    v_mul_f32 v37, v37, v230
    v_mul_f32 v38, v38, v230
    v_mul_f32 v39, v39, v230
    v_mul_f32 v40, v40, v230
    v_mul_f32 v41, v41, v230
    v_mul_f32 v42, v42, v230
    v_mul_f32 v43, v43, v230
    v_mul_f32 v44, v44, v230
    v_mul_f32 v45, v45, v230
    v_mul_f32 v46, v46, v230
    v_mul_f32 v47, v47, v230
    v_mul_f32 v48, v48, v230
    v_mul_f32 v49, v49, v230
    v_mul_f32 v50, v50, v230
    v_mul_f32 v51, v51, v230
    v_mul_f32 v52, v52, v230
    v_mul_f32 v53, v53, v230
    v_mul_f32 v54, v54, v230
    v_mul_f32 v55, v55, v230
    v_mul_f32 v56, v56, v230
    v_mul_f32 v57, v57, v230
    v_mul_f32 v58, v58, v230
    v_mul_f32 v59, v59, v230
    v_mul_f32 v60, v60, v230
    v_mul_f32 v61, v61, v230
    v_mul_f32 v62, v62, v230
    v_mul_f32 v63, v63, v230
    v_mul_f32 v64, v64, v230
    v_mul_f32 v65, v65, v230
    v_mul_f32 v66, v66, v230
    v_mul_f32 v67, v67, v230
    v_mul_f32 v68, v68, v230
    v_mul_f32 v69, v69, v230
    v_mul_f32 v70, v70, v230
    v_mul_f32 v71, v71, v230
    v_mul_f32 v72, v72, v230
    v_mul_f32 v73, v73, v230
    v_mul_f32 v74, v74, v230
    v_mul_f32 v75, v75, v230
    v_mul_f32 v76, v76, v230
    v_mul_f32 v77, v77, v230
    v_mul_f32 v78, v78, v230
    v_mul_f32 v79, v79, v230
    v_mul_f32 v80, v80, v230
    v_mul_f32 v81, v81, v230
    v_mul_f32 v82, v82, v230
    v_mul_f32 v83, v83, v230
    v_mul_f32 v84, v84, v230
    v_mul_f32 v85, v85, v230
    v_mul_f32 v86, v86, v230
    v_mul_f32 v87, v87, v230
    v_mul_f32 v88, v88, v230
    v_mul_f32 v89, v89, v230
    v_mul_f32 v90, v90, v230
    v_mul_f32 v91, v91, v230
    v_mul_f32 v92, v92, v230
    v_mul_f32 v93, v93, v230
    v_mul_f32 v94, v94, v230
    v_mul_f32 v95, v95, v230
    v_mul_f32 v96, v96, v230
    v_mul_f32 v97, v97, v230
    v_mul_f32 v98, v98, v230
    v_mul_f32 v99, v99, v230
    v_mul_f32 v100, v100, v230
    v_mul_f32 v101, v101, v230
    v_mul_f32 v102, v102, v230
    v_mul_f32 v103, v103, v230
    v_mul_f32 v104, v104, v230
    v_mul_f32 v105, v105, v230
    v_mul_f32 v106, v106, v230
    v_mul_f32 v107, v107, v230
    v_mul_f32 v108, v108, v230
    v_mul_f32 v109, v109, v230
    v_mul_f32 v110, v110, v230
    v_mul_f32 v111, v111, v230
    v_mul_f32 v112, v112, v230
    v_mul_f32 v113, v113, v230
    v_mul_f32 v114, v114, v230
    v_mul_f32 v115, v115, v230
    v_mul_f32 v116, v116, v230
    v_mul_f32 v117, v117, v230
    v_mul_f32 v118, v118, v230
    v_mul_f32 v119, v119, v230
    v_mul_f32 v120, v120, v230
    v_mul_f32 v121, v121, v230
    v_mul_f32 v122, v122, v230
    v_mul_f32 v123, v123, v230
    v_mul_f32 v124, v124, v230
    v_mul_f32 v125, v125, v230
    v_mul_f32 v126, v126, v230
    v_mul_f32 v127, v127, v230
    v_accvgpr_read_b32 v234, a0
    v_accvgpr_read_b32 v235, a1
    v_accvgpr_read_b32 v236, a2
    v_accvgpr_read_b32 v237, a3
    v_mul_f32 v234, v234, v231
    v_mul_f32 v235, v235, v231
    v_mul_f32 v236, v236, v231
    v_mul_f32 v237, v237, v231
    v_accvgpr_write_b32 a0, v234
    v_accvgpr_write_b32 a1, v235
    v_accvgpr_write_b32 a2, v236
    v_accvgpr_write_b32 a3, v237
    v_accvgpr_read_b32 v234, a4
    v_accvgpr_read_b32 v235, a5
    v_accvgpr_read_b32 v236, a6
    v_accvgpr_read_b32 v237, a7
    v_mul_f32 v234, v234, v231
    v_mul_f32 v235, v235, v231
    v_mul_f32 v236, v236, v231
    v_mul_f32 v237, v237, v231
    v_accvgpr_write_b32 a4, v234
    v_accvgpr_write_b32 a5, v235
    v_accvgpr_write_b32 a6, v236
    v_accvgpr_write_b32 a7, v237
    v_accvgpr_read_b32 v234, a8
    v_accvgpr_read_b32 v235, a9
    v_accvgpr_read_b32 v236, a10
    v_accvgpr_read_b32 v237, a11
    v_mul_f32 v234, v234, v231
    v_mul_f32 v235, v235, v231
    v_mul_f32 v236, v236, v231
    v_mul_f32 v237, v237, v231
    v_accvgpr_write_b32 a8, v234
    v_accvgpr_write_b32 a9, v235
    v_accvgpr_write_b32 a10, v236
    v_accvgpr_write_b32 a11, v237
    v_accvgpr_read_b32 v234, a12
    v_accvgpr_read_b32 v235, a13
    v_accvgpr_read_b32 v236, a14
    v_accvgpr_read_b32 v237, a15
    v_mul_f32 v234, v234, v231
    v_mul_f32 v235, v235, v231
    v_mul_f32 v236, v236, v231
    v_mul_f32 v237, v237, v231
    v_accvgpr_write_b32 a12, v234
    v_accvgpr_write_b32 a13, v235
    v_accvgpr_write_b32 a14, v236
    v_accvgpr_write_b32 a15, v237
    v_accvgpr_read_b32 v234, a16
    v_accvgpr_read_b32 v235, a17
    v_accvgpr_read_b32 v236, a18
    v_accvgpr_read_b32 v237, a19
    v_mul_f32 v234, v234, v231
    v_mul_f32 v235, v235, v231
    v_mul_f32 v236, v236, v231
    v_mul_f32 v237, v237, v231
    v_accvgpr_write_b32 a16, v234
    v_accvgpr_write_b32 a17, v235
    v_accvgpr_write_b32 a18, v236
    v_accvgpr_write_b32 a19, v237
    v_accvgpr_read_b32 v234, a20
    v_accvgpr_read_b32 v235, a21
    v_accvgpr_read_b32 v236, a22
    v_accvgpr_read_b32 v237, a23
    v_mul_f32 v234, v234, v231
    v_mul_f32 v235, v235, v231
    v_mul_f32 v236, v236, v231
    v_mul_f32 v237, v237, v231
    v_accvgpr_write_b32 a20, v234
    v_accvgpr_write_b32 a21, v235
    v_accvgpr_write_b32 a22, v236
    v_accvgpr_write_b32 a23, v237
    v_accvgpr_read_b32 v234, a24
    v_accvgpr_read_b32 v235, a25
    v_accvgpr_read_b32 v236, a26
    v_accvgpr_read_b32 v237, a27
    v_mul_f32 v234, v234, v231
    v_mul_f32 v235, v235, v231
    v_mul_f32 v236, v236, v231
    v_mul_f32 v237, v237, v231
    v_accvgpr_write_b32 a24, v234
    v_accvgpr_write_b32 a25, v235
    v_accvgpr_write_b32 a26, v236
    v_accvgpr_write_b32 a27, v237
    v_accvgpr_read_b32 v234, a28
    v_accvgpr_read_b32 v235, a29
    v_accvgpr_read_b32 v236, a30
    v_accvgpr_read_b32 v237, a31
    v_mul_f32 v234, v234, v231
    v_mul_f32 v235, v235, v231
    v_mul_f32 v236, v236, v231
    v_mul_f32 v237, v237, v231
    v_accvgpr_write_b32 a28, v234
    v_accvgpr_write_b32 a29, v235
    v_accvgpr_write_b32 a30, v236
    v_accvgpr_write_b32 a31, v237
    v_accvgpr_read_b32 v234, a32
    v_accvgpr_read_b32 v235, a33
    v_accvgpr_read_b32 v236, a34
    v_accvgpr_read_b32 v237, a35
    v_mul_f32 v234, v234, v231
    v_mul_f32 v235, v235, v231
    v_mul_f32 v236, v236, v231
    v_mul_f32 v237, v237, v231
    v_accvgpr_write_b32 a32, v234
    v_accvgpr_write_b32 a33, v235
    v_accvgpr_write_b32 a34, v236
    v_accvgpr_write_b32 a35, v237
    v_accvgpr_read_b32 v234, a36
    v_accvgpr_read_b32 v235, a37
    v_accvgpr_read_b32 v236, a38
    v_accvgpr_read_b32 v237, a39
    v_mul_f32 v234, v234, v231
    v_mul_f32 v235, v235, v231
    v_mul_f32 v236, v236, v231
    v_mul_f32 v237, v237, v231
    v_accvgpr_write_b32 a36, v234
    v_accvgpr_write_b32 a37, v235
    v_accvgpr_write_b32 a38, v236
    v_accvgpr_write_b32 a39, v237
    v_accvgpr_read_b32 v234, a40
    v_accvgpr_read_b32 v235, a41
    v_accvgpr_read_b32 v236, a42
    v_accvgpr_read_b32 v237, a43
    v_mul_f32 v234, v234, v231
    v_mul_f32 v235, v235, v231
    v_mul_f32 v236, v236, v231
    v_mul_f32 v237, v237, v231
    v_accvgpr_write_b32 a40, v234
    v_accvgpr_write_b32 a41, v235
    v_accvgpr_write_b32 a42, v236
    v_accvgpr_write_b32 a43, v237
    v_accvgpr_read_b32 v234, a44
    v_accvgpr_read_b32 v235, a45
    v_accvgpr_read_b32 v236, a46
    v_accvgpr_read_b32 v237, a47
    v_mul_f32 v234, v234, v231
    v_mul_f32 v235, v235, v231
    v_mul_f32 v236, v236, v231
    v_mul_f32 v237, v237, v231
    v_accvgpr_write_b32 a44, v234
    v_accvgpr_write_b32 a45, v235
    v_accvgpr_write_b32 a46, v236
    v_accvgpr_write_b32 a47, v237
    v_accvgpr_read_b32 v234, a48
    v_accvgpr_read_b32 v235, a49
    v_accvgpr_read_b32 v236, a50
    v_accvgpr_read_b32 v237, a51
    v_mul_f32 v234, v234, v231
    v_mul_f32 v235, v235, v231
    v_mul_f32 v236, v236, v231
    v_mul_f32 v237, v237, v231
    v_accvgpr_write_b32 a48, v234
    v_accvgpr_write_b32 a49, v235
    v_accvgpr_write_b32 a50, v236
    v_accvgpr_write_b32 a51, v237
    v_accvgpr_read_b32 v234, a52
    v_accvgpr_read_b32 v235, a53
    v_accvgpr_read_b32 v236, a54
    v_accvgpr_read_b32 v237, a55
    v_mul_f32 v234, v234, v231
    v_mul_f32 v235, v235, v231
    v_mul_f32 v236, v236, v231
    v_mul_f32 v237, v237, v231
    v_accvgpr_write_b32 a52, v234
    v_accvgpr_write_b32 a53, v235
    v_accvgpr_write_b32 a54, v236
    v_accvgpr_write_b32 a55, v237
    v_accvgpr_read_b32 v234, a56
    v_accvgpr_read_b32 v235, a57
    v_accvgpr_read_b32 v236, a58
    v_accvgpr_read_b32 v237, a59
    v_mul_f32 v234, v234, v231
    v_mul_f32 v235, v235, v231
    v_mul_f32 v236, v236, v231
    v_mul_f32 v237, v237, v231
    v_accvgpr_write_b32 a56, v234
    v_accvgpr_write_b32 a57, v235
    v_accvgpr_write_b32 a58, v236
    v_accvgpr_write_b32 a59, v237
    v_accvgpr_read_b32 v234, a60
    v_accvgpr_read_b32 v235, a61
    v_accvgpr_read_b32 v236, a62
    v_accvgpr_read_b32 v237, a63
    v_mul_f32 v234, v234, v231
    v_mul_f32 v235, v235, v231
    v_mul_f32 v236, v236, v231
    v_mul_f32 v237, v237, v231
    v_accvgpr_write_b32 a60, v234
    v_accvgpr_write_b32 a61, v235
    v_accvgpr_write_b32 a62, v236
    v_accvgpr_write_b32 a63, v237
    v_accvgpr_read_b32 v234, a64
    v_accvgpr_read_b32 v235, a65
    v_accvgpr_read_b32 v236, a66
    v_accvgpr_read_b32 v237, a67
    v_mul_f32 v234, v234, v231
    v_mul_f32 v235, v235, v231
    v_mul_f32 v236, v236, v231
    v_mul_f32 v237, v237, v231
    v_accvgpr_write_b32 a64, v234
    v_accvgpr_write_b32 a65, v235
    v_accvgpr_write_b32 a66, v236
    v_accvgpr_write_b32 a67, v237
    v_accvgpr_read_b32 v234, a68
    v_accvgpr_read_b32 v235, a69
    v_accvgpr_read_b32 v236, a70
    v_accvgpr_read_b32 v237, a71
    v_mul_f32 v234, v234, v231
    v_mul_f32 v235, v235, v231
    v_mul_f32 v236, v236, v231
    v_mul_f32 v237, v237, v231
    v_accvgpr_write_b32 a68, v234
    v_accvgpr_write_b32 a69, v235
    v_accvgpr_write_b32 a70, v236
    v_accvgpr_write_b32 a71, v237
    v_accvgpr_read_b32 v234, a72
    v_accvgpr_read_b32 v235, a73
    v_accvgpr_read_b32 v236, a74
    v_accvgpr_read_b32 v237, a75
    v_mul_f32 v234, v234, v231
    v_mul_f32 v235, v235, v231
    v_mul_f32 v236, v236, v231
    v_mul_f32 v237, v237, v231
    v_accvgpr_write_b32 a72, v234
    v_accvgpr_write_b32 a73, v235
    v_accvgpr_write_b32 a74, v236
    v_accvgpr_write_b32 a75, v237
    v_accvgpr_read_b32 v234, a76
    v_accvgpr_read_b32 v235, a77
    v_accvgpr_read_b32 v236, a78
    v_accvgpr_read_b32 v237, a79
    v_mul_f32 v234, v234, v231
    v_mul_f32 v235, v235, v231
    v_mul_f32 v236, v236, v231
    v_mul_f32 v237, v237, v231
    v_accvgpr_write_b32 a76, v234
    v_accvgpr_write_b32 a77, v235
    v_accvgpr_write_b32 a78, v236
    v_accvgpr_write_b32 a79, v237
    v_accvgpr_read_b32 v234, a80
    v_accvgpr_read_b32 v235, a81
    v_accvgpr_read_b32 v236, a82
    v_accvgpr_read_b32 v237, a83
    v_mul_f32 v234, v234, v231
    v_mul_f32 v235, v235, v231
    v_mul_f32 v236, v236, v231
    v_mul_f32 v237, v237, v231
    v_accvgpr_write_b32 a80, v234
    v_accvgpr_write_b32 a81, v235
    v_accvgpr_write_b32 a82, v236
    v_accvgpr_write_b32 a83, v237
    v_accvgpr_read_b32 v234, a84
    v_accvgpr_read_b32 v235, a85
    v_accvgpr_read_b32 v236, a86
    v_accvgpr_read_b32 v237, a87
    v_mul_f32 v234, v234, v231
    v_mul_f32 v235, v235, v231
    v_mul_f32 v236, v236, v231
    v_mul_f32 v237, v237, v231
    v_accvgpr_write_b32 a84, v234
    v_accvgpr_write_b32 a85, v235
    v_accvgpr_write_b32 a86, v236
    v_accvgpr_write_b32 a87, v237
    v_accvgpr_read_b32 v234, a88
    v_accvgpr_read_b32 v235, a89
    v_accvgpr_read_b32 v236, a90
    v_accvgpr_read_b32 v237, a91
    v_mul_f32 v234, v234, v231
    v_mul_f32 v235, v235, v231
    v_mul_f32 v236, v236, v231
    v_mul_f32 v237, v237, v231
    v_accvgpr_write_b32 a88, v234
    v_accvgpr_write_b32 a89, v235
    v_accvgpr_write_b32 a90, v236
    v_accvgpr_write_b32 a91, v237
    v_accvgpr_read_b32 v234, a92
    v_accvgpr_read_b32 v235, a93
    v_accvgpr_read_b32 v236, a94
    v_accvgpr_read_b32 v237, a95
    v_mul_f32 v234, v234, v231
    v_mul_f32 v235, v235, v231
    v_mul_f32 v236, v236, v231
    v_mul_f32 v237, v237, v231
    v_accvgpr_write_b32 a92, v234
    v_accvgpr_write_b32 a93, v235
    v_accvgpr_write_b32 a94, v236
    v_accvgpr_write_b32 a95, v237
    v_accvgpr_read_b32 v234, a96
    v_accvgpr_read_b32 v235, a97
    v_accvgpr_read_b32 v236, a98
    v_accvgpr_read_b32 v237, a99
    v_mul_f32 v234, v234, v231
    v_mul_f32 v235, v235, v231
    v_mul_f32 v236, v236, v231
    v_mul_f32 v237, v237, v231
    v_accvgpr_write_b32 a96, v234
    v_accvgpr_write_b32 a97, v235
    v_accvgpr_write_b32 a98, v236
    v_accvgpr_write_b32 a99, v237
    v_accvgpr_read_b32 v234, a100
    v_accvgpr_read_b32 v235, a101
    v_accvgpr_read_b32 v236, a102
    v_accvgpr_read_b32 v237, a103
    v_mul_f32 v234, v234, v231
    v_mul_f32 v235, v235, v231
    v_mul_f32 v236, v236, v231
    v_mul_f32 v237, v237, v231
    v_accvgpr_write_b32 a100, v234
    v_accvgpr_write_b32 a101, v235
    v_accvgpr_write_b32 a102, v236
    v_accvgpr_write_b32 a103, v237
    v_accvgpr_read_b32 v234, a104
    v_accvgpr_read_b32 v235, a105
    v_accvgpr_read_b32 v236, a106
    v_accvgpr_read_b32 v237, a107
    v_mul_f32 v234, v234, v231
    v_mul_f32 v235, v235, v231
    v_mul_f32 v236, v236, v231
    v_mul_f32 v237, v237, v231
    v_accvgpr_write_b32 a104, v234
    v_accvgpr_write_b32 a105, v235
    v_accvgpr_write_b32 a106, v236
    v_accvgpr_write_b32 a107, v237
    v_accvgpr_read_b32 v234, a108
    v_accvgpr_read_b32 v235, a109
    v_accvgpr_read_b32 v236, a110
    v_accvgpr_read_b32 v237, a111
    v_mul_f32 v234, v234, v231
    v_mul_f32 v235, v235, v231
    v_mul_f32 v236, v236, v231
    v_mul_f32 v237, v237, v231
    v_accvgpr_write_b32 a108, v234
    v_accvgpr_write_b32 a109, v235
    v_accvgpr_write_b32 a110, v236
    v_accvgpr_write_b32 a111, v237
    v_accvgpr_read_b32 v234, a112
    v_accvgpr_read_b32 v235, a113
    v_accvgpr_read_b32 v236, a114
    v_accvgpr_read_b32 v237, a115
    v_mul_f32 v234, v234, v231
    v_mul_f32 v235, v235, v231
    v_mul_f32 v236, v236, v231
    v_mul_f32 v237, v237, v231
    v_accvgpr_write_b32 a112, v234
    v_accvgpr_write_b32 a113, v235
    v_accvgpr_write_b32 a114, v236
    v_accvgpr_write_b32 a115, v237
    v_accvgpr_read_b32 v234, a116
    v_accvgpr_read_b32 v235, a117
    v_accvgpr_read_b32 v236, a118
    v_accvgpr_read_b32 v237, a119
    v_mul_f32 v234, v234, v231
    v_mul_f32 v235, v235, v231
    v_mul_f32 v236, v236, v231
    v_mul_f32 v237, v237, v231
    v_accvgpr_write_b32 a116, v234
    v_accvgpr_write_b32 a117, v235
    v_accvgpr_write_b32 a118, v236
    v_accvgpr_write_b32 a119, v237
    v_accvgpr_read_b32 v234, a120
    v_accvgpr_read_b32 v235, a121
    v_accvgpr_read_b32 v236, a122
    v_accvgpr_read_b32 v237, a123
    v_mul_f32 v234, v234, v231
    v_mul_f32 v235, v235, v231
    v_mul_f32 v236, v236, v231
    v_mul_f32 v237, v237, v231
    v_accvgpr_write_b32 a120, v234
    v_accvgpr_write_b32 a121, v235
    v_accvgpr_write_b32 a122, v236
    v_accvgpr_write_b32 a123, v237
    v_accvgpr_read_b32 v234, a124
    v_accvgpr_read_b32 v235, a125
    v_accvgpr_read_b32 v236, a126
    v_accvgpr_read_b32 v237, a127
    v_mul_f32 v234, v234, v231
    v_mul_f32 v235, v235, v231
    v_mul_f32 v236, v236, v231
    v_mul_f32 v237, v237, v231
    v_accvgpr_write_b32 a124, v234
    v_accvgpr_write_b32 a125, v235
    v_accvgpr_write_b32 a126, v236
    v_accvgpr_write_b32 a127, v237
    v_mov_b32 v230, 1.0
    v_mov_b32 v231, 1.0
    s_mov_b32 s30, 0
    s_nop 1
    s_branch RBACK_14
RARE_15:
    v_max3_f32 v242, v128, v129, v130
    v_max3_f32 v243, v131, v132, v133
    v_max3_f32 v242, v242, v134, v135
    v_max3_f32 v243, v243, v136, v137
    v_max3_f32 v242, v242, v138, v139
    v_max3_f32 v243, v243, v140, v141
    v_max3_f32 v242, v242, v142, v143
    v_max_f32 v242, v242, v243
    v_mov_b32 v243, v242
    s_nop 1
    v_permlane32_swap_b32 v242, v243
    s_nop 1
    v_max_f32 v242, v242, v243
    v_mul_f32 v242, s20, v242
    v_max_f32_e64 v242, v242, -v226
    v_add_f32 v243, v226, v242
    v_exp_f32_e64 v243, -v243
    v_sub_f32 v226, 0, v242
    v_mul_f32 v228, v228, v243
    v_mul_f32 v230, v230, v243
    s_mov_b32 s30, 1
    v_fma_f32 v234, v128, s20, v226
    v_fma_f32 v235, v129, s20, v226
    v_exp_f32 v234, v234
    v_fma_f32 v236, v130, s20, v226
    v_exp_f32 v235, v235
    v_fma_f32 v237, v131, s20, v226
    v_exp_f32 v236, v236
    v_mov_b32 v232, v234
    v_fma_f32 v238, v132, s20, v226
    v_exp_f32 v237, v237
    v_mov_b32 v233, v235
    v_cvt_pk_bf16_f32 v184, v234, v235
    v_fma_f32 v239, v133, s20, v226
    v_exp_f32 v238, v238
    v_add_f32 v232, v232, v236
    v_fma_f32 v240, v134, s20, v226
    v_exp_f32 v239, v239
    v_add_f32 v233, v233, v237
    v_cvt_pk_bf16_f32 v185, v236, v237
    v_fma_f32 v241, v135, s20, v226
    v_exp_f32 v240, v240
    v_add_f32 v232, v232, v238
    v_fma_f32 v234, v136, s20, v226
    v_exp_f32 v241, v241
    v_add_f32 v233, v233, v239
    v_cvt_pk_bf16_f32 v186, v238, v239
    v_fma_f32 v235, v137, s20, v226
    v_exp_f32 v234, v234
    v_add_f32 v232, v232, v240
    v_fma_f32 v236, v138, s20, v226
    v_exp_f32 v235, v235
    v_add_f32 v233, v233, v241
    v_cvt_pk_bf16_f32 v187, v240, v241
    v_fma_f32 v237, v139, s20, v226
    v_exp_f32 v236, v236
    v_add_f32 v232, v232, v234
    v_fma_f32 v238, v140, s20, v226
    v_exp_f32 v237, v237
    v_add_f32 v233, v233, v235
    v_cvt_pk_bf16_f32 v188, v234, v235
    v_fma_f32 v239, v141, s20, v226
    v_exp_f32 v238, v238
    v_add_f32 v232, v232, v236
    v_fma_f32 v240, v142, s20, v226
    v_exp_f32 v239, v239
    v_add_f32 v233, v233, v237
    v_cvt_pk_bf16_f32 v189, v236, v237
    v_fma_f32 v241, v143, s20, v226
    v_exp_f32 v240, v240
    v_add_f32 v232, v232, v238
    v_exp_f32 v241, v241
    v_add_f32 v233, v233, v239
    v_cvt_pk_bf16_f32 v190, v238, v239
    v_add_f32 v232, v232, v240
    v_add_f32 v233, v233, v241
    v_cvt_pk_bf16_f32 v191, v240, v241
    v_add_f32 v232, v232, v233
    s_branch BACK_15
RARE_16:
    v_max3_f32 v242, v160, v161, v162
    v_max3_f32 v243, v163, v164, v165
    v_max3_f32 v242, v242, v166, v167
    v_max3_f32 v243, v243, v168, v169
    v_max3_f32 v242, v242, v170, v171
    v_max3_f32 v243, v243, v172, v173
    v_max3_f32 v242, v242, v174, v175
    v_max_f32 v242, v242, v243
    v_mov_b32 v243, v242
    s_nop 1
    v_permlane32_swap_b32 v242, v243
    s_nop 1
    v_max_f32 v242, v242, v243
    v_mul_f32 v242, s20, v242
    v_max_f32_e64 v242, v242, -v227
    v_add_f32 v243, v227, v242
    v_exp_f32_e64 v243, -v243
    v_sub_f32 v227, 0, v242
    v_mul_f32 v229, v229, v243
    v_mul_f32 v231, v231, v243
    s_mov_b32 s30, 1
    v_fma_f32 v234, v160, s20, v227
    v_fma_f32 v235, v161, s20, v227
    v_exp_f32 v234, v234
    v_fma_f32 v236, v162, s20, v227
    v_exp_f32 v235, v235
    v_fma_f32 v237, v163, s20, v227
    v_exp_f32 v236, v236
    v_mov_b32 v232, v234
    v_fma_f32 v238, v164, s20, v227
    v_exp_f32 v237, v237
    v_mov_b32 v233, v235
    v_cvt_pk_bf16_f32 v192, v234, v235
    v_fma_f32 v239, v165, s20, v227
    v_exp_f32 v238, v238
    v_add_f32 v232, v232, v236
    v_fma_f32 v240, v166, s20, v227
    v_exp_f32 v239, v239
    v_add_f32 v233, v233, v237
    v_cvt_pk_bf16_f32 v193, v236, v237
    v_fma_f32 v241, v167, s20, v227
    v_exp_f32 v240, v240
    v_add_f32 v232, v232, v238
    v_fma_f32 v234, v168, s20, v227
    v_exp_f32 v241, v241
    v_add_f32 v233, v233, v239
    v_cvt_pk_bf16_f32 v194, v238, v239
    v_fma_f32 v235, v169, s20, v227
    v_exp_f32 v234, v234
    v_add_f32 v232, v232, v240
    v_fma_f32 v236, v170, s20, v227
    v_exp_f32 v235, v235
    v_add_f32 v233, v233, v241
    v_cvt_pk_bf16_f32 v195, v240, v241
    v_fma_f32 v237, v171, s20, v227
    v_exp_f32 v236, v236
    v_add_f32 v232, v232, v234
    v_fma_f32 v238, v172, s20, v227
    v_exp_f32 v237, v237
    v_add_f32 v233, v233, v235
    v_cvt_pk_bf16_f32 v196, v234, v235
    v_fma_f32 v239, v173, s20, v227
    v_exp_f32 v238, v238
    v_add_f32 v232, v232, v236
    v_fma_f32 v240, v174, s20, v227
    v_exp_f32 v239, v239
    v_add_f32 v233, v233, v237
    v_cvt_pk_bf16_f32 v197, v236, v237
    v_fma_f32 v241, v175, s20, v227
    v_exp_f32 v240, v240
    v_add_f32 v232, v232, v238
    v_exp_f32 v241, v241
    v_add_f32 v233, v233, v239
    v_cvt_pk_bf16_f32 v198, v238, v239
    v_add_f32 v232, v232, v240
    v_add_f32 v233, v233, v241
    v_cvt_pk_bf16_f32 v199, v240, v241
    v_add_f32 v232, v232, v233
    s_branch BACK_16
RESC_17:
    s_nop 7
    s_nop 7
    v_mul_f32 v0, v0, v230
    v_mul_f32 v1, v1, v230
    v_mul_f32 v2, v2, v230
    v_mul_f32 v3, v3, v230
    v_mul_f32 v4, v4, v230
    v_mul_f32 v5, v5, v230
    v_mul_f32 v6, v6, v230
    v_mul_f32 v7, v7, v230
    v_mul_f32 v8, v8, v230
    v_mul_f32 v9, v9, v230
    v_mul_f32 v10, v10, v230
    v_mul_f32 v11, v11, v230
    v_mul_f32 v12, v12, v230
    v_mul_f32 v13, v13, v230
    v_mul_f32 v14, v14, v230
    v_mul_f32 v15, v15, v230
    v_mul_f32 v16, v16, v230
    v_mul_f32 v17, v17, v230
    v_mul_f32 v18, v18, v230
    v_mul_f32 v19, v19, v230
    v_mul_f32 v20, v20, v230
    v_mul_f32 v21, v21, v230
    v_mul_f32 v22, v22, v230
    v_mul_f32 v23, v23, v230
    v_mul_f32 v24, v24, v230
    v_mul_f32 v25, v25, v230
    v_mul_f32 v26, v26, v230
    v_mul_f32 v27, v27, v230
    v_mul_f32 v28, v28, v230
    v_mul_f32 v29, v29, v230
    v_mul_f32 v30, v30, v230
    v_mul_f32 v31, v31, v230
    v_mul_f32 v32, v32, v230
    v_mul_f32 v33, v33, v230
    v_mul_f32 v34, v34, v230
    v_mul_f32 v35, v35, v230
    v_mul_f32 v36, v36, v230
    v_mul_f32 v37, v37, v230
    v_mul_f32 v38, v38, v230
    v_mul_f32 v39, v39, v230
    v_mul_f32 v40, v40, v230
    v_mul_f32 v41, v41, v230
    v_mul_f32 v42, v42, v230
    v_mul_f32 v43, v43, v230
    v_mul_f32 v44, v44, v230
    v_mul_f32 v45, v45, v230
    v_mul_f32 v46, v46, v230
    v_mul_f32 v47, v47, v230
    v_mul_f32 v48, v48, v230
    v_mul_f32 v49, v49, v230
    v_mul_f32 v50, v50, v230
    v_mul_f32 v51, v51, v230
    v_mul_f32 v52, v52, v230
    v_mul_f32 v53, v53, v230
    v_mul_f32 v54, v54, v230
    v_mul_f32 v55, v55, v230
    v_mul_f32 v56, v56, v230
    v_mul_f32 v57, v57, v230
    v_mul_f32 v58, v58, v230
    v_mul_f32 v59, v59, v230
    v_mul_f32 v60, v60, v230
    v_mul_f32 v61, v61, v230
    v_mul_f32 v62, v62, v230
    v_mul_f32 v63, v63, v230
    v_mul_f32 v64, v64, v230
    v_mul_f32 v65, v65, v230
    v_mul_f32 v66, v66, v230
    v_mul_f32 v67, v67, v230
    v_mul_f32 v68, v68, v230
    v_mul_f32 v69, v69, v230
    v_mul_f32 v70, v70, v230
    v_mul_f32 v71, v71, v230
    v_mul_f32 v72, v72, v230
    v_mul_f32 v73, v73, v230
    v_mul_f32 v74, v74, v230
    v_mul_f32 v75, v75, v230
    v_mul_f32 v76, v76, v230
    v_mul_f32 v77, v77, v230
    v_mul_f32 v78, v78, v230
    v_mul_f32 v79, v79, v230
    v_mul_f32 v80, v80, v230
    v_mul_f32 v81, v81, v230
    v_mul_f32 v82, v82, v230
    v_mul_f32 v83, v83, v230
    v_mul_f32 v84, v84, v230
    v_mul_f32 v85, v85, v230
    v_mul_f32 v86, v86, v230
    v_mul_f32 v87, v87, v230
    v_mul_f32 v88, v88, v230
    v_mul_f32 v89, v89, v230
    v_mul_f32 v90, v90, v230
    v_mul_f32 v91, v91, v230
    v_mul_f32 v92, v92, v230
    v_mul_f32 v93, v93, v230
    v_mul_f32 v94, v94, v230
    v_mul_f32 v95, v95, v230
    v_mul_f32 v96, v96, v230
    v_mul_f32 v97, v97, v230
    v_mul_f32 v98, v98, v230
    v_mul_f32 v99, v99, v230
    v_mul_f32 v100, v100, v230
    v_mul_f32 v101, v101, v230
    v_mul_f32 v102, v102, v230
    v_mul_f32 v103, v103, v230
    v_mul_f32 v104, v104, v230
    v_mul_f32 v105, v105, v230
    v_mul_f32 v106, v106, v230
    v_mul_f32 v107, v107, v230
    v_mul_f32 v108, v108, v230
    v_mul_f32 v109, v109, v230
    v_mul_f32 v110, v110, v230
    v_mul_f32 v111, v111, v230
    v_mul_f32 v112, v112, v230
    v_mul_f32 v113, v113, v230
    v_mul_f32 v114, v114, v230
    v_mul_f32 v115, v115, v230
    v_mul_f32 v116, v116, v230
    v_mul_f32 v117, v117, v230
    v_mul_f32 v118, v118, v230
    v_mul_f32 v119, v119, v230
    v_mul_f32 v120, v120, v230
    v_mul_f32 v121, v121, v230
    v_mul_f32 v122, v122, v230
    v_mul_f32 v123, v123, v230
    v_mul_f32 v124, v124, v230
    v_mul_f32 v125, v125, v230
    v_mul_f32 v126, v126, v230
    v_mul_f32 v127, v127, v230
    v_accvgpr_read_b32 v234, a0
    v_accvgpr_read_b32 v235, a1
    v_accvgpr_read_b32 v236, a2
    v_accvgpr_read_b32 v237, a3
    v_mul_f32 v234, v234, v231
    v_mul_f32 v235, v235, v231
    v_mul_f32 v236, v236, v231
    v_mul_f32 v237, v237, v231
    v_accvgpr_write_b32 a0, v234
    v_accvgpr_write_b32 a1, v235
    v_accvgpr_write_b32 a2, v236
    v_accvgpr_write_b32 a3, v237
    v_accvgpr_read_b32 v234, a4
    v_accvgpr_read_b32 v235, a5
    v_accvgpr_read_b32 v236, a6
    v_accvgpr_read_b32 v237, a7
    v_mul_f32 v234, v234, v231
    v_mul_f32 v235, v235, v231
    v_mul_f32 v236, v236, v231
    v_mul_f32 v237, v237, v231
    v_accvgpr_write_b32 a4, v234
    v_accvgpr_write_b32 a5, v235
    v_accvgpr_write_b32 a6, v236
    v_accvgpr_write_b32 a7, v237
    v_accvgpr_read_b32 v234, a8
    v_accvgpr_read_b32 v235, a9
    v_accvgpr_read_b32 v236, a10
    v_accvgpr_read_b32 v237, a11
    v_mul_f32 v234, v234, v231
    v_mul_f32 v235, v235, v231
    v_mul_f32 v236, v236, v231
    v_mul_f32 v237, v237, v231
    v_accvgpr_write_b32 a8, v234
    v_accvgpr_write_b32 a9, v235
    v_accvgpr_write_b32 a10, v236
    v_accvgpr_write_b32 a11, v237
    v_accvgpr_read_b32 v234, a12
    v_accvgpr_read_b32 v235, a13
    v_accvgpr_read_b32 v236, a14
    v_accvgpr_read_b32 v237, a15
    v_mul_f32 v234, v234, v231
    v_mul_f32 v235, v235, v231
    v_mul_f32 v236, v236, v231
    v_mul_f32 v237, v237, v231
    v_accvgpr_write_b32 a12, v234
    v_accvgpr_write_b32 a13, v235
    v_accvgpr_write_b32 a14, v236
    v_accvgpr_write_b32 a15, v237
    v_accvgpr_read_b32 v234, a16
    v_accvgpr_read_b32 v235, a17
    v_accvgpr_read_b32 v236, a18
    v_accvgpr_read_b32 v237, a19
    v_mul_f32 v234, v234, v231
    v_mul_f32 v235, v235, v231
    v_mul_f32 v236, v236, v231
    v_mul_f32 v237, v237, v231
    v_accvgpr_write_b32 a16, v234
    v_accvgpr_write_b32 a17, v235
    v_accvgpr_write_b32 a18, v236
    v_accvgpr_write_b32 a19, v237
    v_accvgpr_read_b32 v234, a20
    v_accvgpr_read_b32 v235, a21
    v_accvgpr_read_b32 v236, a22
    v_accvgpr_read_b32 v237, a23
    v_mul_f32 v234, v234, v231
    v_mul_f32 v235, v235, v231
    v_mul_f32 v236, v236, v231
    v_mul_f32 v237, v237, v231
    v_accvgpr_write_b32 a20, v234
    v_accvgpr_write_b32 a21, v235
    v_accvgpr_write_b32 a22, v236
    v_accvgpr_write_b32 a23, v237
    v_accvgpr_read_b32 v234, a24
    v_accvgpr_read_b32 v235, a25
    v_accvgpr_read_b32 v236, a26
    v_accvgpr_read_b32 v237, a27
    v_mul_f32 v234, v234, v231
    v_mul_f32 v235, v235, v231
    v_mul_f32 v236, v236, v231
    v_mul_f32 v237, v237, v231
    v_accvgpr_write_b32 a24, v234
    v_accvgpr_write_b32 a25, v235
    v_accvgpr_write_b32 a26, v236
    v_accvgpr_write_b32 a27, v237
    v_accvgpr_read_b32 v234, a28
    v_accvgpr_read_b32 v235, a29
    v_accvgpr_read_b32 v236, a30
    v_accvgpr_read_b32 v237, a31
    v_mul_f32 v234, v234, v231
    v_mul_f32 v235, v235, v231
    v_mul_f32 v236, v236, v231
    v_mul_f32 v237, v237, v231
    v_accvgpr_write_b32 a28, v234
    v_accvgpr_write_b32 a29, v235
    v_accvgpr_write_b32 a30, v236
    v_accvgpr_write_b32 a31, v237
    v_accvgpr_read_b32 v234, a32
    v_accvgpr_read_b32 v235, a33
    v_accvgpr_read_b32 v236, a34
    v_accvgpr_read_b32 v237, a35
    v_mul_f32 v234, v234, v231
    v_mul_f32 v235, v235, v231
    v_mul_f32 v236, v236, v231
    v_mul_f32 v237, v237, v231
    v_accvgpr_write_b32 a32, v234
    v_accvgpr_write_b32 a33, v235
    v_accvgpr_write_b32 a34, v236
    v_accvgpr_write_b32 a35, v237
    v_accvgpr_read_b32 v234, a36
    v_accvgpr_read_b32 v235, a37
    v_accvgpr_read_b32 v236, a38
    v_accvgpr_read_b32 v237, a39
    v_mul_f32 v234, v234, v231
    v_mul_f32 v235, v235, v231
    v_mul_f32 v236, v236, v231
    v_mul_f32 v237, v237, v231
    v_accvgpr_write_b32 a36, v234
    v_accvgpr_write_b32 a37, v235
    v_accvgpr_write_b32 a38, v236
    v_accvgpr_write_b32 a39, v237
    v_accvgpr_read_b32 v234, a40
    v_accvgpr_read_b32 v235, a41
    v_accvgpr_read_b32 v236, a42
    v_accvgpr_read_b32 v237, a43
    v_mul_f32 v234, v234, v231
    v_mul_f32 v235, v235, v231
    v_mul_f32 v236, v236, v231
    v_mul_f32 v237, v237, v231
    v_accvgpr_write_b32 a40, v234
    v_accvgpr_write_b32 a41, v235
    v_accvgpr_write_b32 a42, v236
    v_accvgpr_write_b32 a43, v237
    v_accvgpr_read_b32 v234, a44
    v_accvgpr_read_b32 v235, a45
    v_accvgpr_read_b32 v236, a46
    v_accvgpr_read_b32 v237, a47
    v_mul_f32 v234, v234, v231
    v_mul_f32 v235, v235, v231
    v_mul_f32 v236, v236, v231
    v_mul_f32 v237, v237, v231
    v_accvgpr_write_b32 a44, v234
    v_accvgpr_write_b32 a45, v235
    v_accvgpr_write_b32 a46, v236
    v_accvgpr_write_b32 a47, v237
    v_accvgpr_read_b32 v234, a48
    v_accvgpr_read_b32 v235, a49
    v_accvgpr_read_b32 v236, a50
    v_accvgpr_read_b32 v237, a51
    v_mul_f32 v234, v234, v231
    v_mul_f32 v235, v235, v231
    v_mul_f32 v236, v236, v231
    v_mul_f32 v237, v237, v231
    v_accvgpr_write_b32 a48, v234
    v_accvgpr_write_b32 a49, v235
    v_accvgpr_write_b32 a50, v236
    v_accvgpr_write_b32 a51, v237
    v_accvgpr_read_b32 v234, a52
    v_accvgpr_read_b32 v235, a53
    v_accvgpr_read_b32 v236, a54
    v_accvgpr_read_b32 v237, a55
    v_mul_f32 v234, v234, v231
    v_mul_f32 v235, v235, v231
    v_mul_f32 v236, v236, v231
    v_mul_f32 v237, v237, v231
    v_accvgpr_write_b32 a52, v234
    v_accvgpr_write_b32 a53, v235
    v_accvgpr_write_b32 a54, v236
    v_accvgpr_write_b32 a55, v237
    v_accvgpr_read_b32 v234, a56
    v_accvgpr_read_b32 v235, a57
    v_accvgpr_read_b32 v236, a58
    v_accvgpr_read_b32 v237, a59
    v_mul_f32 v234, v234, v231
    v_mul_f32 v235, v235, v231
    v_mul_f32 v236, v236, v231
    v_mul_f32 v237, v237, v231
    v_accvgpr_write_b32 a56, v234
    v_accvgpr_write_b32 a57, v235
    v_accvgpr_write_b32 a58, v236
    v_accvgpr_write_b32 a59, v237
    v_accvgpr_read_b32 v234, a60
    v_accvgpr_read_b32 v235, a61
    v_accvgpr_read_b32 v236, a62
    v_accvgpr_read_b32 v237, a63
    v_mul_f32 v234, v234, v231
    v_mul_f32 v235, v235, v231
    v_mul_f32 v236, v236, v231
    v_mul_f32 v237, v237, v231
    v_accvgpr_write_b32 a60, v234
    v_accvgpr_write_b32 a61, v235
    v_accvgpr_write_b32 a62, v236
    v_accvgpr_write_b32 a63, v237
    v_accvgpr_read_b32 v234, a64
    v_accvgpr_read_b32 v235, a65
    v_accvgpr_read_b32 v236, a66
    v_accvgpr_read_b32 v237, a67
    v_mul_f32 v234, v234, v231
    v_mul_f32 v235, v235, v231
    v_mul_f32 v236, v236, v231
    v_mul_f32 v237, v237, v231
    v_accvgpr_write_b32 a64, v234
    v_accvgpr_write_b32 a65, v235
    v_accvgpr_write_b32 a66, v236
    v_accvgpr_write_b32 a67, v237
    v_accvgpr_read_b32 v234, a68
    v_accvgpr_read_b32 v235, a69
    v_accvgpr_read_b32 v236, a70
    v_accvgpr_read_b32 v237, a71
    v_mul_f32 v234, v234, v231
    v_mul_f32 v235, v235, v231
    v_mul_f32 v236, v236, v231
    v_mul_f32 v237, v237, v231
    v_accvgpr_write_b32 a68, v234
    v_accvgpr_write_b32 a69, v235
    v_accvgpr_write_b32 a70, v236
    v_accvgpr_write_b32 a71, v237
    v_accvgpr_read_b32 v234, a72
    v_accvgpr_read_b32 v235, a73
    v_accvgpr_read_b32 v236, a74
    v_accvgpr_read_b32 v237, a75
    v_mul_f32 v234, v234, v231
    v_mul_f32 v235, v235, v231
    v_mul_f32 v236, v236, v231
    v_mul_f32 v237, v237, v231
    v_accvgpr_write_b32 a72, v234
    v_accvgpr_write_b32 a73, v235
    v_accvgpr_write_b32 a74, v236
    v_accvgpr_write_b32 a75, v237
    v_accvgpr_read_b32 v234, a76
    v_accvgpr_read_b32 v235, a77
    v_accvgpr_read_b32 v236, a78
    v_accvgpr_read_b32 v237, a79
    v_mul_f32 v234, v234, v231
    v_mul_f32 v235, v235, v231
    v_mul_f32 v236, v236, v231
    v_mul_f32 v237, v237, v231
    v_accvgpr_write_b32 a76, v234
    v_accvgpr_write_b32 a77, v235
    v_accvgpr_write_b32 a78, v236
    v_accvgpr_write_b32 a79, v237
    v_accvgpr_read_b32 v234, a80
    v_accvgpr_read_b32 v235, a81
    v_accvgpr_read_b32 v236, a82
    v_accvgpr_read_b32 v237, a83
    v_mul_f32 v234, v234, v231
    v_mul_f32 v235, v235, v231
    v_mul_f32 v236, v236, v231
    v_mul_f32 v237, v237, v231
    v_accvgpr_write_b32 a80, v234
    v_accvgpr_write_b32 a81, v235
    v_accvgpr_write_b32 a82, v236
    v_accvgpr_write_b32 a83, v237
    v_accvgpr_read_b32 v234, a84
    v_accvgpr_read_b32 v235, a85
    v_accvgpr_read_b32 v236, a86
    v_accvgpr_read_b32 v237, a87
    v_mul_f32 v234, v234, v231
    v_mul_f32 v235, v235, v231
    v_mul_f32 v236, v236, v231
    v_mul_f32 v237, v237, v231
    v_accvgpr_write_b32 a84, v234
    v_accvgpr_write_b32 a85, v235
    v_accvgpr_write_b32 a86, v236
    v_accvgpr_write_b32 a87, v237
    v_accvgpr_read_b32 v234, a88
    v_accvgpr_read_b32 v235, a89
    v_accvgpr_read_b32 v236, a90
    v_accvgpr_read_b32 v237, a91
    v_mul_f32 v234, v234, v231
    v_mul_f32 v235, v235, v231
    v_mul_f32 v236, v236, v231
    v_mul_f32 v237, v237, v231
    v_accvgpr_write_b32 a88, v234
    v_accvgpr_write_b32 a89, v235
    v_accvgpr_write_b32 a90, v236
    v_accvgpr_write_b32 a91, v237
    v_accvgpr_read_b32 v234, a92
    v_accvgpr_read_b32 v235, a93
    v_accvgpr_read_b32 v236, a94
    v_accvgpr_read_b32 v237, a95
    v_mul_f32 v234, v234, v231
    v_mul_f32 v235, v235, v231
    v_mul_f32 v236, v236, v231
    v_mul_f32 v237, v237, v231
    v_accvgpr_write_b32 a92, v234
    v_accvgpr_write_b32 a93, v235
    v_accvgpr_write_b32 a94, v236
    v_accvgpr_write_b32 a95, v237
    v_accvgpr_read_b32 v234, a96
    v_accvgpr_read_b32 v235, a97
    v_accvgpr_read_b32 v236, a98
    v_accvgpr_read_b32 v237, a99
    v_mul_f32 v234, v234, v231
    v_mul_f32 v235, v235, v231
    v_mul_f32 v236, v236, v231
    v_mul_f32 v237, v237, v231
    v_accvgpr_write_b32 a96, v234
    v_accvgpr_write_b32 a97, v235
    v_accvgpr_write_b32 a98, v236
    v_accvgpr_write_b32 a99, v237
    v_accvgpr_read_b32 v234, a100
    v_accvgpr_read_b32 v235, a101
    v_accvgpr_read_b32 v236, a102
    v_accvgpr_read_b32 v237, a103
    v_mul_f32 v234, v234, v231
    v_mul_f32 v235, v235, v231
    v_mul_f32 v236, v236, v231
    v_mul_f32 v237, v237, v231
    v_accvgpr_write_b32 a100, v234
    v_accvgpr_write_b32 a101, v235
    v_accvgpr_write_b32 a102, v236
    v_accvgpr_write_b32 a103, v237
    v_accvgpr_read_b32 v234, a104
    v_accvgpr_read_b32 v235, a105
    v_accvgpr_read_b32 v236, a106
    v_accvgpr_read_b32 v237, a107
    v_mul_f32 v234, v234, v231
    v_mul_f32 v235, v235, v231
    v_mul_f32 v236, v236, v231
    v_mul_f32 v237, v237, v231
    v_accvgpr_write_b32 a104, v234
    v_accvgpr_write_b32 a105, v235
    v_accvgpr_write_b32 a106, v236
    v_accvgpr_write_b32 a107, v237
    v_accvgpr_read_b32 v234, a108
    v_accvgpr_read_b32 v235, a109
    v_accvgpr_read_b32 v236, a110
    v_accvgpr_read_b32 v237, a111
    v_mul_f32 v234, v234, v231
    v_mul_f32 v235, v235, v231
    v_mul_f32 v236, v236, v231
    v_mul_f32 v237, v237, v231
    v_accvgpr_write_b32 a108, v234
    v_accvgpr_write_b32 a109, v235
    v_accvgpr_write_b32 a110, v236
    v_accvgpr_write_b32 a111, v237
    v_accvgpr_read_b32 v234, a112
    v_accvgpr_read_b32 v235, a113
    v_accvgpr_read_b32 v236, a114
    v_accvgpr_read_b32 v237, a115
    v_mul_f32 v234, v234, v231
    v_mul_f32 v235, v235, v231
    v_mul_f32 v236, v236, v231
    v_mul_f32 v237, v237, v231
    v_accvgpr_write_b32 a112, v234
    v_accvgpr_write_b32 a113, v235
    v_accvgpr_write_b32 a114, v236
    v_accvgpr_write_b32 a115, v237
    v_accvgpr_read_b32 v234, a116
    v_accvgpr_read_b32 v235, a117
    v_accvgpr_read_b32 v236, a118
    v_accvgpr_read_b32 v237, a119
    v_mul_f32 v234, v234, v231
    v_mul_f32 v235, v235, v231
    v_mul_f32 v236, v236, v231
    v_mul_f32 v237, v237, v231
    v_accvgpr_write_b32 a116, v234
    v_accvgpr_write_b32 a117, v235
    v_accvgpr_write_b32 a118, v236
    v_accvgpr_write_b32 a119, v237
    v_accvgpr_read_b32 v234, a120
    v_accvgpr_read_b32 v235, a121
    v_accvgpr_read_b32 v236, a122
    v_accvgpr_read_b32 v237, a123
    v_mul_f32 v234, v234, v231
    v_mul_f32 v235, v235, v231
    v_mul_f32 v236, v236, v231
    v_mul_f32 v237, v237, v231
    v_accvgpr_write_b32 a120, v234
    v_accvgpr_write_b32 a121, v235
    v_accvgpr_write_b32 a122, v236
    v_accvgpr_write_b32 a123, v237
    v_accvgpr_read_b32 v234, a124
    v_accvgpr_read_b32 v235, a125
    v_accvgpr_read_b32 v236, a126
    v_accvgpr_read_b32 v237, a127
    v_mul_f32 v234, v234, v231
    v_mul_f32 v235, v235, v231
    v_mul_f32 v236, v236, v231
    v_mul_f32 v237, v237, v231
    v_accvgpr_write_b32 a124, v234
    v_accvgpr_write_b32 a125, v235
    v_accvgpr_write_b32 a126, v236
    v_accvgpr_write_b32 a127, v237
    v_mov_b32 v230, 1.0
    v_mov_b32 v231, 1.0
    s_mov_b32 s30, 0
    s_nop 1
    s_branch RBACK_17
RARE_18:
    v_max3_f32 v242, v128, v129, v130
    v_max3_f32 v243, v131, v132, v133
    v_max3_f32 v242, v242, v134, v135
    v_max3_f32 v243, v243, v136, v137
    v_max3_f32 v242, v242, v138, v139
    v_max3_f32 v243, v243, v140, v141
    v_max3_f32 v242, v242, v142, v143
    v_max_f32 v242, v242, v243
    v_mov_b32 v243, v242
    s_nop 1
    v_permlane32_swap_b32 v242, v243
    s_nop 1
    v_max_f32 v242, v242, v243
    v_mul_f32 v242, s20, v242
    v_max_f32_e64 v242, v242, -v226
    v_add_f32 v243, v226, v242
    v_exp_f32_e64 v243, -v243
    v_sub_f32 v226, 0, v242
    v_mul_f32 v228, v228, v243
    v_mul_f32 v230, v230, v243
    s_mov_b32 s30, 1
    v_fma_f32 v234, v128, s20, v226
    v_fma_f32 v235, v129, s20, v226
    v_exp_f32 v234, v234
    v_fma_f32 v236, v130, s20, v226
    v_exp_f32 v235, v235
    v_fma_f32 v237, v131, s20, v226
    v_exp_f32 v236, v236
    v_mov_b32 v232, v234
    v_fma_f32 v238, v132, s20, v226
    v_exp_f32 v237, v237
    v_mov_b32 v233, v235
    v_cvt_pk_bf16_f32 v176, v234, v235
    v_fma_f32 v239, v133, s20, v226
    v_exp_f32 v238, v238
    v_add_f32 v232, v232, v236
    v_fma_f32 v240, v134, s20, v226
    v_exp_f32 v239, v239
    v_add_f32 v233, v233, v237
    v_cvt_pk_bf16_f32 v177, v236, v237
    v_fma_f32 v241, v135, s20, v226
    v_exp_f32 v240, v240
    v_add_f32 v232, v232, v238
    v_fma_f32 v234, v136, s20, v226
    v_exp_f32 v241, v241
    v_add_f32 v233, v233, v239
    v_cvt_pk_bf16_f32 v178, v238, v239
    v_fma_f32 v235, v137, s20, v226
    v_exp_f32 v234, v234
    v_add_f32 v232, v232, v240
    v_fma_f32 v236, v138, s20, v226
    v_exp_f32 v235, v235
    v_add_f32 v233, v233, v241
    v_cvt_pk_bf16_f32 v179, v240, v241
    v_fma_f32 v237, v139, s20, v226
    v_exp_f32 v236, v236
    v_add_f32 v232, v232, v234
    v_fma_f32 v238, v140, s20, v226
    v_exp_f32 v237, v237
    v_add_f32 v233, v233, v235
    v_cvt_pk_bf16_f32 v180, v234, v235
    v_fma_f32 v239, v141, s20, v226
    v_exp_f32 v238, v238
    v_add_f32 v232, v232, v236
    v_fma_f32 v240, v142, s20, v226
    v_exp_f32 v239, v239
    v_add_f32 v233, v233, v237
    v_cvt_pk_bf16_f32 v181, v236, v237
    v_fma_f32 v241, v143, s20, v226
    v_exp_f32 v240, v240
    v_add_f32 v232, v232, v238
    v_exp_f32 v241, v241
    v_add_f32 v233, v233, v239
    v_cvt_pk_bf16_f32 v182, v238, v239
    v_add_f32 v232, v232, v240
    v_add_f32 v233, v233, v241
    v_cvt_pk_bf16_f32 v183, v240, v241
    v_add_f32 v232, v232, v233
    s_branch BACK_18
RARE_19:
    v_max3_f32 v242, v144, v145, v146
    v_max3_f32 v243, v147, v148, v149
    v_max3_f32 v242, v242, v150, v151
    v_max3_f32 v243, v243, v152, v153
    v_max3_f32 v242, v242, v154, v155
    v_max3_f32 v243, v243, v156, v157
    v_max3_f32 v242, v242, v158, v159
    v_max_f32 v242, v242, v243
    v_mov_b32 v243, v242
    s_nop 1
    v_permlane32_swap_b32 v242, v243
    s_nop 1
    v_max_f32 v242, v242, v243
    v_mul_f32 v242, s20, v242
    v_max_f32_e64 v242, v242, -v227
    v_add_f32 v243, v227, v242
    v_exp_f32_e64 v243, -v243
    v_sub_f32 v227, 0, v242
    v_mul_f32 v229, v229, v243
    v_mul_f32 v231, v231, v243
    s_mov_b32 s30, 1
    v_fma_f32 v234, v144, s20, v227
    v_fma_f32 v235, v145, s20, v227
    v_exp_f32 v234, v234
    v_fma_f32 v236, v146, s20, v227
    v_exp_f32 v235, v235
    v_fma_f32 v237, v147, s20, v227
    v_exp_f32 v236, v236
    v_mov_b32 v232, v234
    v_fma_f32 v238, v148, s20, v227
    v_exp_f32 v237, v237
    v_mov_b32 v233, v235
    v_cvt_pk_bf16_f32 v192, v234, v235
    v_fma_f32 v239, v149, s20, v227
    v_exp_f32 v238, v238
    v_add_f32 v232, v232, v236
    v_fma_f32 v240, v150, s20, v227
    v_exp_f32 v239, v239
    v_add_f32 v233, v233, v237
    v_cvt_pk_bf16_f32 v193, v236, v237
    v_fma_f32 v241, v151, s20, v227
    v_exp_f32 v240, v240
    v_add_f32 v232, v232, v238
    v_fma_f32 v234, v152, s20, v227
    v_exp_f32 v241, v241
    v_add_f32 v233, v233, v239
    v_cvt_pk_bf16_f32 v194, v238, v239
    v_fma_f32 v235, v153, s20, v227
    v_exp_f32 v234, v234
    v_add_f32 v232, v232, v240
    v_fma_f32 v236, v154, s20, v227
    v_exp_f32 v235, v235
    v_add_f32 v233, v233, v241
    v_cvt_pk_bf16_f32 v195, v240, v241
    v_fma_f32 v237, v155, s20, v227
    v_exp_f32 v236, v236
    v_add_f32 v232, v232, v234
    v_fma_f32 v238, v156, s20, v227
    v_exp_f32 v237, v237
    v_add_f32 v233, v233, v235
    v_cvt_pk_bf16_f32 v196, v234, v235
    v_fma_f32 v239, v157, s20, v227
    v_exp_f32 v238, v238
    v_add_f32 v232, v232, v236
    v_fma_f32 v240, v158, s20, v227
    v_exp_f32 v239, v239
    v_add_f32 v233, v233, v237
    v_cvt_pk_bf16_f32 v197, v236, v237
    v_fma_f32 v241, v159, s20, v227
    v_exp_f32 v240, v240
    v_add_f32 v232, v232, v238
    v_exp_f32 v241, v241
    v_add_f32 v233, v233, v239
    v_cvt_pk_bf16_f32 v198, v238, v239
    v_add_f32 v232, v232, v240
    v_add_f32 v233, v233, v241
    v_cvt_pk_bf16_f32 v199, v240, v241
    v_add_f32 v232, v232, v233
    s_branch BACK_19
RESC_20:
    s_nop 7
    s_nop 7
    v_mul_f32 v0, v0, v230
    v_mul_f32 v1, v1, v230
    v_mul_f32 v2, v2, v230
    v_mul_f32 v3, v3, v230
    v_mul_f32 v4, v4, v230
    v_mul_f32 v5, v5, v230
    v_mul_f32 v6, v6, v230
    v_mul_f32 v7, v7, v230
    v_mul_f32 v8, v8, v230
    v_mul_f32 v9, v9, v230
    v_mul_f32 v10, v10, v230
    v_mul_f32 v11, v11, v230
    v_mul_f32 v12, v12, v230
    v_mul_f32 v13, v13, v230
    v_mul_f32 v14, v14, v230
    v_mul_f32 v15, v15, v230
    v_mul_f32 v16, v16, v230
    v_mul_f32 v17, v17, v230
    v_mul_f32 v18, v18, v230
    v_mul_f32 v19, v19, v230
    v_mul_f32 v20, v20, v230
    v_mul_f32 v21, v21, v230
    v_mul_f32 v22, v22, v230
    v_mul_f32 v23, v23, v230
    v_mul_f32 v24, v24, v230
    v_mul_f32 v25, v25, v230
    v_mul_f32 v26, v26, v230
    v_mul_f32 v27, v27, v230
    v_mul_f32 v28, v28, v230
    v_mul_f32 v29, v29, v230
    v_mul_f32 v30, v30, v230
    v_mul_f32 v31, v31, v230
    v_mul_f32 v32, v32, v230
    v_mul_f32 v33, v33, v230
    v_mul_f32 v34, v34, v230
    v_mul_f32 v35, v35, v230
    v_mul_f32 v36, v36, v230
    v_mul_f32 v37, v37, v230
    v_mul_f32 v38, v38, v230
    v_mul_f32 v39, v39, v230
    v_mul_f32 v40, v40, v230
    v_mul_f32 v41, v41, v230
    v_mul_f32 v42, v42, v230
    v_mul_f32 v43, v43, v230
    v_mul_f32 v44, v44, v230
    v_mul_f32 v45, v45, v230
    v_mul_f32 v46, v46, v230
    v_mul_f32 v47, v47, v230
    v_mul_f32 v48, v48, v230
    v_mul_f32 v49, v49, v230
    v_mul_f32 v50, v50, v230
    v_mul_f32 v51, v51, v230
    v_mul_f32 v52, v52, v230
    v_mul_f32 v53, v53, v230
    v_mul_f32 v54, v54, v230
    v_mul_f32 v55, v55, v230
    v_mul_f32 v56, v56, v230
    v_mul_f32 v57, v57, v230
    v_mul_f32 v58, v58, v230
    v_mul_f32 v59, v59, v230
    v_mul_f32 v60, v60, v230
    v_mul_f32 v61, v61, v230
    v_mul_f32 v62, v62, v230
    v_mul_f32 v63, v63, v230
    v_mul_f32 v64, v64, v230
    v_mul_f32 v65, v65, v230
    v_mul_f32 v66, v66, v230
    v_mul_f32 v67, v67, v230
    v_mul_f32 v68, v68, v230
    v_mul_f32 v69, v69, v230
    v_mul_f32 v70, v70, v230
    v_mul_f32 v71, v71, v230
    v_mul_f32 v72, v72, v230
    v_mul_f32 v73, v73, v230
    v_mul_f32 v74, v74, v230
    v_mul_f32 v75, v75, v230
    v_mul_f32 v76, v76, v230
    v_mul_f32 v77, v77, v230
    v_mul_f32 v78, v78, v230
    v_mul_f32 v79, v79, v230
    v_mul_f32 v80, v80, v230
    v_mul_f32 v81, v81, v230
    v_mul_f32 v82, v82, v230
    v_mul_f32 v83, v83, v230
    v_mul_f32 v84, v84, v230
    v_mul_f32 v85, v85, v230
    v_mul_f32 v86, v86, v230
    v_mul_f32 v87, v87, v230
    v_mul_f32 v88, v88, v230
    v_mul_f32 v89, v89, v230
    v_mul_f32 v90, v90, v230
    v_mul_f32 v91, v91, v230
    v_mul_f32 v92, v92, v230
    v_mul_f32 v93, v93, v230
    v_mul_f32 v94, v94, v230
    v_mul_f32 v95, v95, v230
    v_mul_f32 v96, v96, v230
    v_mul_f32 v97, v97, v230
    v_mul_f32 v98, v98, v230
    v_mul_f32 v99, v99, v230
    v_mul_f32 v100, v100, v230
    v_mul_f32 v101, v101, v230
    v_mul_f32 v102, v102, v230
    v_mul_f32 v103, v103, v230
    v_mul_f32 v104, v104, v230
    v_mul_f32 v105, v105, v230
    v_mul_f32 v106, v106, v230
    v_mul_f32 v107, v107, v230
    v_mul_f32 v108, v108, v230
    v_mul_f32 v109, v109, v230
    v_mul_f32 v110, v110, v230
    v_mul_f32 v111, v111, v230
    v_mul_f32 v112, v112, v230
    v_mul_f32 v113, v113, v230
    v_mul_f32 v114, v114, v230
    v_mul_f32 v115, v115, v230
    v_mul_f32 v116, v116, v230
    v_mul_f32 v117, v117, v230
    v_mul_f32 v118, v118, v230
    v_mul_f32 v119, v119, v230
    v_mul_f32 v120, v120, v230
    v_mul_f32 v121, v121, v230
    v_mul_f32 v122, v122, v230
    v_mul_f32 v123, v123, v230
    v_mul_f32 v124, v124, v230
    v_mul_f32 v125, v125, v230
    v_mul_f32 v126, v126, v230
    v_mul_f32 v127, v127, v230
    v_accvgpr_read_b32 v234, a0
    v_accvgpr_read_b32 v235, a1
    v_accvgpr_read_b32 v236, a2
    v_accvgpr_read_b32 v237, a3
    v_mul_f32 v234, v234, v231
    v_mul_f32 v235, v235, v231
    v_mul_f32 v236, v236, v231
    v_mul_f32 v237, v237, v231
    v_accvgpr_write_b32 a0, v234
    v_accvgpr_write_b32 a1, v235
    v_accvgpr_write_b32 a2, v236
    v_accvgpr_write_b32 a3, v237
    v_accvgpr_read_b32 v234, a4
    v_accvgpr_read_b32 v235, a5
    v_accvgpr_read_b32 v236, a6
    v_accvgpr_read_b32 v237, a7
    v_mul_f32 v234, v234, v231
    v_mul_f32 v235, v235, v231
    v_mul_f32 v236, v236, v231
    v_mul_f32 v237, v237, v231
    v_accvgpr_write_b32 a4, v234
    v_accvgpr_write_b32 a5, v235
    v_accvgpr_write_b32 a6, v236
    v_accvgpr_write_b32 a7, v237
    v_accvgpr_read_b32 v234, a8
    v_accvgpr_read_b32 v235, a9
    v_accvgpr_read_b32 v236, a10
    v_accvgpr_read_b32 v237, a11
    v_mul_f32 v234, v234, v231
    v_mul_f32 v235, v235, v231
    v_mul_f32 v236, v236, v231
    v_mul_f32 v237, v237, v231
    v_accvgpr_write_b32 a8, v234
    v_accvgpr_write_b32 a9, v235
    v_accvgpr_write_b32 a10, v236
    v_accvgpr_write_b32 a11, v237
    v_accvgpr_read_b32 v234, a12
    v_accvgpr_read_b32 v235, a13
    v_accvgpr_read_b32 v236, a14
    v_accvgpr_read_b32 v237, a15
    v_mul_f32 v234, v234, v231
    v_mul_f32 v235, v235, v231
    v_mul_f32 v236, v236, v231
    v_mul_f32 v237, v237, v231
    v_accvgpr_write_b32 a12, v234
    v_accvgpr_write_b32 a13, v235
    v_accvgpr_write_b32 a14, v236
    v_accvgpr_write_b32 a15, v237
    v_accvgpr_read_b32 v234, a16
    v_accvgpr_read_b32 v235, a17
    v_accvgpr_read_b32 v236, a18
    v_accvgpr_read_b32 v237, a19
    v_mul_f32 v234, v234, v231
    v_mul_f32 v235, v235, v231
    v_mul_f32 v236, v236, v231
    v_mul_f32 v237, v237, v231
    v_accvgpr_write_b32 a16, v234
    v_accvgpr_write_b32 a17, v235
    v_accvgpr_write_b32 a18, v236
    v_accvgpr_write_b32 a19, v237
    v_accvgpr_read_b32 v234, a20
    v_accvgpr_read_b32 v235, a21
    v_accvgpr_read_b32 v236, a22
    v_accvgpr_read_b32 v237, a23
    v_mul_f32 v234, v234, v231
    v_mul_f32 v235, v235, v231
    v_mul_f32 v236, v236, v231
    v_mul_f32 v237, v237, v231
    v_accvgpr_write_b32 a20, v234
    v_accvgpr_write_b32 a21, v235
    v_accvgpr_write_b32 a22, v236
    v_accvgpr_write_b32 a23, v237
    v_accvgpr_read_b32 v234, a24
    v_accvgpr_read_b32 v235, a25
    v_accvgpr_read_b32 v236, a26
    v_accvgpr_read_b32 v237, a27
    v_mul_f32 v234, v234, v231
    v_mul_f32 v235, v235, v231
    v_mul_f32 v236, v236, v231
    v_mul_f32 v237, v237, v231
    v_accvgpr_write_b32 a24, v234
    v_accvgpr_write_b32 a25, v235
    v_accvgpr_write_b32 a26, v236
    v_accvgpr_write_b32 a27, v237
    v_accvgpr_read_b32 v234, a28
    v_accvgpr_read_b32 v235, a29
    v_accvgpr_read_b32 v236, a30
    v_accvgpr_read_b32 v237, a31
    v_mul_f32 v234, v234, v231
    v_mul_f32 v235, v235, v231
    v_mul_f32 v236, v236, v231
    v_mul_f32 v237, v237, v231
    v_accvgpr_write_b32 a28, v234
    v_accvgpr_write_b32 a29, v235
    v_accvgpr_write_b32 a30, v236
    v_accvgpr_write_b32 a31, v237
    v_accvgpr_read_b32 v234, a32
    v_accvgpr_read_b32 v235, a33
    v_accvgpr_read_b32 v236, a34
    v_accvgpr_read_b32 v237, a35
    v_mul_f32 v234, v234, v231
    v_mul_f32 v235, v235, v231
    v_mul_f32 v236, v236, v231
    v_mul_f32 v237, v237, v231
    v_accvgpr_write_b32 a32, v234
    v_accvgpr_write_b32 a33, v235
    v_accvgpr_write_b32 a34, v236
    v_accvgpr_write_b32 a35, v237
    v_accvgpr_read_b32 v234, a36
    v_accvgpr_read_b32 v235, a37
    v_accvgpr_read_b32 v236, a38
    v_accvgpr_read_b32 v237, a39
    v_mul_f32 v234, v234, v231
    v_mul_f32 v235, v235, v231
    v_mul_f32 v236, v236, v231
    v_mul_f32 v237, v237, v231
    v_accvgpr_write_b32 a36, v234
    v_accvgpr_write_b32 a37, v235
    v_accvgpr_write_b32 a38, v236
    v_accvgpr_write_b32 a39, v237
    v_accvgpr_read_b32 v234, a40
    v_accvgpr_read_b32 v235, a41
    v_accvgpr_read_b32 v236, a42
    v_accvgpr_read_b32 v237, a43
    v_mul_f32 v234, v234, v231
    v_mul_f32 v235, v235, v231
    v_mul_f32 v236, v236, v231
    v_mul_f32 v237, v237, v231
    v_accvgpr_write_b32 a40, v234
    v_accvgpr_write_b32 a41, v235
    v_accvgpr_write_b32 a42, v236
    v_accvgpr_write_b32 a43, v237
    v_accvgpr_read_b32 v234, a44
    v_accvgpr_read_b32 v235, a45
    v_accvgpr_read_b32 v236, a46
    v_accvgpr_read_b32 v237, a47
    v_mul_f32 v234, v234, v231
    v_mul_f32 v235, v235, v231
    v_mul_f32 v236, v236, v231
    v_mul_f32 v237, v237, v231
    v_accvgpr_write_b32 a44, v234
    v_accvgpr_write_b32 a45, v235
    v_accvgpr_write_b32 a46, v236
    v_accvgpr_write_b32 a47, v237
    v_accvgpr_read_b32 v234, a48
    v_accvgpr_read_b32 v235, a49
    v_accvgpr_read_b32 v236, a50
    v_accvgpr_read_b32 v237, a51
    v_mul_f32 v234, v234, v231
    v_mul_f32 v235, v235, v231
    v_mul_f32 v236, v236, v231
    v_mul_f32 v237, v237, v231
    v_accvgpr_write_b32 a48, v234
    v_accvgpr_write_b32 a49, v235
    v_accvgpr_write_b32 a50, v236
    v_accvgpr_write_b32 a51, v237
    v_accvgpr_read_b32 v234, a52
    v_accvgpr_read_b32 v235, a53
    v_accvgpr_read_b32 v236, a54
    v_accvgpr_read_b32 v237, a55
    v_mul_f32 v234, v234, v231
    v_mul_f32 v235, v235, v231
    v_mul_f32 v236, v236, v231
    v_mul_f32 v237, v237, v231
    v_accvgpr_write_b32 a52, v234
    v_accvgpr_write_b32 a53, v235
    v_accvgpr_write_b32 a54, v236
    v_accvgpr_write_b32 a55, v237
    v_accvgpr_read_b32 v234, a56
    v_accvgpr_read_b32 v235, a57
    v_accvgpr_read_b32 v236, a58
    v_accvgpr_read_b32 v237, a59
    v_mul_f32 v234, v234, v231
    v_mul_f32 v235, v235, v231
    v_mul_f32 v236, v236, v231
    v_mul_f32 v237, v237, v231
    v_accvgpr_write_b32 a56, v234
    v_accvgpr_write_b32 a57, v235
    v_accvgpr_write_b32 a58, v236
    v_accvgpr_write_b32 a59, v237
    v_accvgpr_read_b32 v234, a60
    v_accvgpr_read_b32 v235, a61
    v_accvgpr_read_b32 v236, a62
    v_accvgpr_read_b32 v237, a63
    v_mul_f32 v234, v234, v231
    v_mul_f32 v235, v235, v231
    v_mul_f32 v236, v236, v231
    v_mul_f32 v237, v237, v231
    v_accvgpr_write_b32 a60, v234
    v_accvgpr_write_b32 a61, v235
    v_accvgpr_write_b32 a62, v236
    v_accvgpr_write_b32 a63, v237
    v_accvgpr_read_b32 v234, a64
    v_accvgpr_read_b32 v235, a65
    v_accvgpr_read_b32 v236, a66
    v_accvgpr_read_b32 v237, a67
    v_mul_f32 v234, v234, v231
    v_mul_f32 v235, v235, v231
    v_mul_f32 v236, v236, v231
    v_mul_f32 v237, v237, v231
    v_accvgpr_write_b32 a64, v234
    v_accvgpr_write_b32 a65, v235
    v_accvgpr_write_b32 a66, v236
    v_accvgpr_write_b32 a67, v237
    v_accvgpr_read_b32 v234, a68
    v_accvgpr_read_b32 v235, a69
    v_accvgpr_read_b32 v236, a70
    v_accvgpr_read_b32 v237, a71
    v_mul_f32 v234, v234, v231
    v_mul_f32 v235, v235, v231
    v_mul_f32 v236, v236, v231
    v_mul_f32 v237, v237, v231
    v_accvgpr_write_b32 a68, v234
    v_accvgpr_write_b32 a69, v235
    v_accvgpr_write_b32 a70, v236
    v_accvgpr_write_b32 a71, v237
    v_accvgpr_read_b32 v234, a72
    v_accvgpr_read_b32 v235, a73
    v_accvgpr_read_b32 v236, a74
    v_accvgpr_read_b32 v237, a75
    v_mul_f32 v234, v234, v231
    v_mul_f32 v235, v235, v231
    v_mul_f32 v236, v236, v231
    v_mul_f32 v237, v237, v231
    v_accvgpr_write_b32 a72, v234
    v_accvgpr_write_b32 a73, v235
    v_accvgpr_write_b32 a74, v236
    v_accvgpr_write_b32 a75, v237
    v_accvgpr_read_b32 v234, a76
    v_accvgpr_read_b32 v235, a77
    v_accvgpr_read_b32 v236, a78
    v_accvgpr_read_b32 v237, a79
    v_mul_f32 v234, v234, v231
    v_mul_f32 v235, v235, v231
    v_mul_f32 v236, v236, v231
    v_mul_f32 v237, v237, v231
    v_accvgpr_write_b32 a76, v234
    v_accvgpr_write_b32 a77, v235
    v_accvgpr_write_b32 a78, v236
    v_accvgpr_write_b32 a79, v237
    v_accvgpr_read_b32 v234, a80
    v_accvgpr_read_b32 v235, a81
    v_accvgpr_read_b32 v236, a82
    v_accvgpr_read_b32 v237, a83
    v_mul_f32 v234, v234, v231
    v_mul_f32 v235, v235, v231
    v_mul_f32 v236, v236, v231
    v_mul_f32 v237, v237, v231
    v_accvgpr_write_b32 a80, v234
    v_accvgpr_write_b32 a81, v235
    v_accvgpr_write_b32 a82, v236
    v_accvgpr_write_b32 a83, v237
    v_accvgpr_read_b32 v234, a84
    v_accvgpr_read_b32 v235, a85
    v_accvgpr_read_b32 v236, a86
    v_accvgpr_read_b32 v237, a87
    v_mul_f32 v234, v234, v231
    v_mul_f32 v235, v235, v231
    v_mul_f32 v236, v236, v231
    v_mul_f32 v237, v237, v231
    v_accvgpr_write_b32 a84, v234
    v_accvgpr_write_b32 a85, v235
    v_accvgpr_write_b32 a86, v236
    v_accvgpr_write_b32 a87, v237
    v_accvgpr_read_b32 v234, a88
    v_accvgpr_read_b32 v235, a89
    v_accvgpr_read_b32 v236, a90
    v_accvgpr_read_b32 v237, a91
    v_mul_f32 v234, v234, v231
    v_mul_f32 v235, v235, v231
    v_mul_f32 v236, v236, v231
    v_mul_f32 v237, v237, v231
    v_accvgpr_write_b32 a88, v234
    v_accvgpr_write_b32 a89, v235
    v_accvgpr_write_b32 a90, v236
    v_accvgpr_write_b32 a91, v237
    v_accvgpr_read_b32 v234, a92
    v_accvgpr_read_b32 v235, a93
    v_accvgpr_read_b32 v236, a94
    v_accvgpr_read_b32 v237, a95
    v_mul_f32 v234, v234, v231
    v_mul_f32 v235, v235, v231
    v_mul_f32 v236, v236, v231
    v_mul_f32 v237, v237, v231
    v_accvgpr_write_b32 a92, v234
    v_accvgpr_write_b32 a93, v235
    v_accvgpr_write_b32 a94, v236
    v_accvgpr_write_b32 a95, v237
    v_accvgpr_read_b32 v234, a96
    v_accvgpr_read_b32 v235, a97
    v_accvgpr_read_b32 v236, a98
    v_accvgpr_read_b32 v237, a99
    v_mul_f32 v234, v234, v231
    v_mul_f32 v235, v235, v231
    v_mul_f32 v236, v236, v231
    v_mul_f32 v237, v237, v231
    v_accvgpr_write_b32 a96, v234
    v_accvgpr_write_b32 a97, v235
    v_accvgpr_write_b32 a98, v236
    v_accvgpr_write_b32 a99, v237
    v_accvgpr_read_b32 v234, a100
    v_accvgpr_read_b32 v235, a101
    v_accvgpr_read_b32 v236, a102
    v_accvgpr_read_b32 v237, a103
    v_mul_f32 v234, v234, v231
    v_mul_f32 v235, v235, v231
    v_mul_f32 v236, v236, v231
    v_mul_f32 v237, v237, v231
    v_accvgpr_write_b32 a100, v234
    v_accvgpr_write_b32 a101, v235
    v_accvgpr_write_b32 a102, v236
    v_accvgpr_write_b32 a103, v237
    v_accvgpr_read_b32 v234, a104
    v_accvgpr_read_b32 v235, a105
    v_accvgpr_read_b32 v236, a106
    v_accvgpr_read_b32 v237, a107
    v_mul_f32 v234, v234, v231
    v_mul_f32 v235, v235, v231
    v_mul_f32 v236, v236, v231
    v_mul_f32 v237, v237, v231
    v_accvgpr_write_b32 a104, v234
    v_accvgpr_write_b32 a105, v235
    v_accvgpr_write_b32 a106, v236
    v_accvgpr_write_b32 a107, v237
    v_accvgpr_read_b32 v234, a108
    v_accvgpr_read_b32 v235, a109
    v_accvgpr_read_b32 v236, a110
    v_accvgpr_read_b32 v237, a111
    v_mul_f32 v234, v234, v231
    v_mul_f32 v235, v235, v231
    v_mul_f32 v236, v236, v231
    v_mul_f32 v237, v237, v231
    v_accvgpr_write_b32 a108, v234
    v_accvgpr_write_b32 a109, v235
    v_accvgpr_write_b32 a110, v236
    v_accvgpr_write_b32 a111, v237
    v_accvgpr_read_b32 v234, a112
    v_accvgpr_read_b32 v235, a113
    v_accvgpr_read_b32 v236, a114
    v_accvgpr_read_b32 v237, a115
    v_mul_f32 v234, v234, v231
    v_mul_f32 v235, v235, v231
    v_mul_f32 v236, v236, v231
    v_mul_f32 v237, v237, v231
    v_accvgpr_write_b32 a112, v234
    v_accvgpr_write_b32 a113, v235
    v_accvgpr_write_b32 a114, v236
    v_accvgpr_write_b32 a115, v237
    v_accvgpr_read_b32 v234, a116
    v_accvgpr_read_b32 v235, a117
    v_accvgpr_read_b32 v236, a118
    v_accvgpr_read_b32 v237, a119
    v_mul_f32 v234, v234, v231
    v_mul_f32 v235, v235, v231
    v_mul_f32 v236, v236, v231
    v_mul_f32 v237, v237, v231
    v_accvgpr_write_b32 a116, v234
    v_accvgpr_write_b32 a117, v235
    v_accvgpr_write_b32 a118, v236
    v_accvgpr_write_b32 a119, v237
    v_accvgpr_read_b32 v234, a120
    v_accvgpr_read_b32 v235, a121
    v_accvgpr_read_b32 v236, a122
    v_accvgpr_read_b32 v237, a123
    v_mul_f32 v234, v234, v231
    v_mul_f32 v235, v235, v231
    v_mul_f32 v236, v236, v231
    v_mul_f32 v237, v237, v231
    v_accvgpr_write_b32 a120, v234
    v_accvgpr_write_b32 a121, v235
    v_accvgpr_write_b32 a122, v236
    v_accvgpr_write_b32 a123, v237
    v_accvgpr_read_b32 v234, a124
    v_accvgpr_read_b32 v235, a125
    v_accvgpr_read_b32 v236, a126
    v_accvgpr_read_b32 v237, a127
    v_mul_f32 v234, v234, v231
    v_mul_f32 v235, v235, v231
    v_mul_f32 v236, v236, v231
    v_mul_f32 v237, v237, v231
    v_accvgpr_write_b32 a124, v234
    v_accvgpr_write_b32 a125, v235
    v_accvgpr_write_b32 a126, v236
    v_accvgpr_write_b32 a127, v237
    v_mov_b32 v230, 1.0
    v_mov_b32 v231, 1.0
    s_mov_b32 s30, 0
    s_nop 1
    s_branch RBACK_20
RARE_21:
    v_max3_f32 v242, v128, v129, v130
    v_max3_f32 v243, v131, v132, v133
    v_max3_f32 v242, v242, v134, v135
    v_max3_f32 v243, v243, v136, v137
    v_max3_f32 v242, v242, v138, v139
    v_max3_f32 v243, v243, v140, v141
    v_max3_f32 v242, v242, v142, v143
    v_max_f32 v242, v242, v243
    v_mov_b32 v243, v242
    s_nop 1
    v_permlane32_swap_b32 v242, v243
    s_nop 1
    v_max_f32 v242, v242, v243
    v_mul_f32 v242, s20, v242
    v_max_f32_e64 v242, v242, -v226
    v_add_f32 v243, v226, v242
    v_exp_f32_e64 v243, -v243
    v_sub_f32 v226, 0, v242
    v_mul_f32 v228, v228, v243
    v_mul_f32 v230, v230, v243
    s_mov_b32 s30, 1
    v_fma_f32 v234, v128, s20, v226
    v_fma_f32 v235, v129, s20, v226
    v_exp_f32 v234, v234
    v_fma_f32 v236, v130, s20, v226
    v_exp_f32 v235, v235
    v_fma_f32 v237, v131, s20, v226
    v_exp_f32 v236, v236
    v_mov_b32 v232, v234
    v_fma_f32 v238, v132, s20, v226
    v_exp_f32 v237, v237
    v_mov_b32 v233, v235
    v_cvt_pk_bf16_f32 v184, v234, v235
    v_fma_f32 v239, v133, s20, v226
    v_exp_f32 v238, v238
    v_add_f32 v232, v232, v236
    v_fma_f32 v240, v134, s20, v226
    v_exp_f32 v239, v239
    v_add_f32 v233, v233, v237
    v_cvt_pk_bf16_f32 v185, v236, v237
    v_fma_f32 v241, v135, s20, v226
    v_exp_f32 v240, v240
    v_add_f32 v232, v232, v238
    v_fma_f32 v234, v136, s20, v226
    v_exp_f32 v241, v241
    v_add_f32 v233, v233, v239
    v_cvt_pk_bf16_f32 v186, v238, v239
    v_fma_f32 v235, v137, s20, v226
    v_exp_f32 v234, v234
    v_add_f32 v232, v232, v240
    v_fma_f32 v236, v138, s20, v226
    v_exp_f32 v235, v235
    v_add_f32 v233, v233, v241
    v_cvt_pk_bf16_f32 v187, v240, v241
    v_fma_f32 v237, v139, s20, v226
    v_exp_f32 v236, v236
    v_add_f32 v232, v232, v234
    v_fma_f32 v238, v140, s20, v226
    v_exp_f32 v237, v237
    v_add_f32 v233, v233, v235
    v_cvt_pk_bf16_f32 v188, v234, v235
    v_fma_f32 v239, v141, s20, v226
    v_exp_f32 v238, v238
    v_add_f32 v232, v232, v236
    v_fma_f32 v240, v142, s20, v226
    v_exp_f32 v239, v239
    v_add_f32 v233, v233, v237
    v_cvt_pk_bf16_f32 v189, v236, v237
    v_fma_f32 v241, v143, s20, v226
    v_exp_f32 v240, v240
    v_add_f32 v232, v232, v238
    v_exp_f32 v241, v241
    v_add_f32 v233, v233, v239
    v_cvt_pk_bf16_f32 v190, v238, v239
    v_add_f32 v232, v232, v240
    v_add_f32 v233, v233, v241
    v_cvt_pk_bf16_f32 v191, v240, v241
    v_add_f32 v232, v232, v233
    s_branch BACK_21
RESC_22:
    s_nop 7
    s_nop 7
    v_mul_f32 v0, v0, v230
    v_mul_f32 v1, v1, v230
    v_mul_f32 v2, v2, v230
    v_mul_f32 v3, v3, v230
    v_mul_f32 v4, v4, v230
    v_mul_f32 v5, v5, v230
    v_mul_f32 v6, v6, v230
    v_mul_f32 v7, v7, v230
    v_mul_f32 v8, v8, v230
    v_mul_f32 v9, v9, v230
    v_mul_f32 v10, v10, v230
    v_mul_f32 v11, v11, v230
    v_mul_f32 v12, v12, v230
    v_mul_f32 v13, v13, v230
    v_mul_f32 v14, v14, v230
    v_mul_f32 v15, v15, v230
    v_mul_f32 v16, v16, v230
    v_mul_f32 v17, v17, v230
    v_mul_f32 v18, v18, v230
    v_mul_f32 v19, v19, v230
    v_mul_f32 v20, v20, v230
    v_mul_f32 v21, v21, v230
    v_mul_f32 v22, v22, v230
    v_mul_f32 v23, v23, v230
    v_mul_f32 v24, v24, v230
    v_mul_f32 v25, v25, v230
    v_mul_f32 v26, v26, v230
    v_mul_f32 v27, v27, v230
    v_mul_f32 v28, v28, v230
    v_mul_f32 v29, v29, v230
    v_mul_f32 v30, v30, v230
    v_mul_f32 v31, v31, v230
    v_mul_f32 v32, v32, v230
    v_mul_f32 v33, v33, v230
    v_mul_f32 v34, v34, v230
    v_mul_f32 v35, v35, v230
    v_mul_f32 v36, v36, v230
    v_mul_f32 v37, v37, v230
    v_mul_f32 v38, v38, v230
    v_mul_f32 v39, v39, v230
    v_mul_f32 v40, v40, v230
    v_mul_f32 v41, v41, v230
    v_mul_f32 v42, v42, v230
    v_mul_f32 v43, v43, v230
    v_mul_f32 v44, v44, v230
    v_mul_f32 v45, v45, v230
    v_mul_f32 v46, v46, v230
    v_mul_f32 v47, v47, v230
    v_mul_f32 v48, v48, v230
    v_mul_f32 v49, v49, v230
    v_mul_f32 v50, v50, v230
    v_mul_f32 v51, v51, v230
    v_mul_f32 v52, v52, v230
    v_mul_f32 v53, v53, v230
    v_mul_f32 v54, v54, v230
    v_mul_f32 v55, v55, v230
    v_mul_f32 v56, v56, v230
    v_mul_f32 v57, v57, v230
    v_mul_f32 v58, v58, v230
    v_mul_f32 v59, v59, v230
    v_mul_f32 v60, v60, v230
    v_mul_f32 v61, v61, v230
    v_mul_f32 v62, v62, v230
    v_mul_f32 v63, v63, v230
    v_mul_f32 v64, v64, v230
    v_mul_f32 v65, v65, v230
    v_mul_f32 v66, v66, v230
    v_mul_f32 v67, v67, v230
    v_mul_f32 v68, v68, v230
    v_mul_f32 v69, v69, v230
    v_mul_f32 v70, v70, v230
    v_mul_f32 v71, v71, v230
    v_mul_f32 v72, v72, v230
    v_mul_f32 v73, v73, v230
    v_mul_f32 v74, v74, v230
    v_mul_f32 v75, v75, v230
    v_mul_f32 v76, v76, v230
    v_mul_f32 v77, v77, v230
    v_mul_f32 v78, v78, v230
    v_mul_f32 v79, v79, v230
    v_mul_f32 v80, v80, v230
    v_mul_f32 v81, v81, v230
    v_mul_f32 v82, v82, v230
    v_mul_f32 v83, v83, v230
    v_mul_f32 v84, v84, v230
    v_mul_f32 v85, v85, v230
    v_mul_f32 v86, v86, v230
    v_mul_f32 v87, v87, v230
    v_mul_f32 v88, v88, v230
    v_mul_f32 v89, v89, v230
    v_mul_f32 v90, v90, v230
    v_mul_f32 v91, v91, v230
    v_mul_f32 v92, v92, v230
    v_mul_f32 v93, v93, v230
    v_mul_f32 v94, v94, v230
    v_mul_f32 v95, v95, v230
    v_mul_f32 v96, v96, v230
    v_mul_f32 v97, v97, v230
    v_mul_f32 v98, v98, v230
    v_mul_f32 v99, v99, v230
    v_mul_f32 v100, v100, v230
    v_mul_f32 v101, v101, v230
    v_mul_f32 v102, v102, v230
    v_mul_f32 v103, v103, v230
    v_mul_f32 v104, v104, v230
    v_mul_f32 v105, v105, v230
    v_mul_f32 v106, v106, v230
    v_mul_f32 v107, v107, v230
    v_mul_f32 v108, v108, v230
    v_mul_f32 v109, v109, v230
    v_mul_f32 v110, v110, v230
    v_mul_f32 v111, v111, v230
    v_mul_f32 v112, v112, v230
    v_mul_f32 v113, v113, v230
    v_mul_f32 v114, v114, v230
    v_mul_f32 v115, v115, v230
    v_mul_f32 v116, v116, v230
    v_mul_f32 v117, v117, v230
    v_mul_f32 v118, v118, v230
    v_mul_f32 v119, v119, v230
    v_mul_f32 v120, v120, v230
    v_mul_f32 v121, v121, v230
    v_mul_f32 v122, v122, v230
    v_mul_f32 v123, v123, v230
    v_mul_f32 v124, v124, v230
    v_mul_f32 v125, v125, v230
    v_mul_f32 v126, v126, v230
    v_mul_f32 v127, v127, v230
    v_accvgpr_read_b32 v234, a0
    v_accvgpr_read_b32 v235, a1
    v_accvgpr_read_b32 v236, a2
    v_accvgpr_read_b32 v237, a3
    v_mul_f32 v234, v234, v231
    v_mul_f32 v235, v235, v231
    v_mul_f32 v236, v236, v231
    v_mul_f32 v237, v237, v231
    v_accvgpr_write_b32 a0, v234
    v_accvgpr_write_b32 a1, v235
    v_accvgpr_write_b32 a2, v236
    v_accvgpr_write_b32 a3, v237
    v_accvgpr_read_b32 v234, a4
    v_accvgpr_read_b32 v235, a5
    v_accvgpr_read_b32 v236, a6
    v_accvgpr_read_b32 v237, a7
    v_mul_f32 v234, v234, v231
    v_mul_f32 v235, v235, v231
    v_mul_f32 v236, v236, v231
    v_mul_f32 v237, v237, v231
    v_accvgpr_write_b32 a4, v234
    v_accvgpr_write_b32 a5, v235
    v_accvgpr_write_b32 a6, v236
    v_accvgpr_write_b32 a7, v237
    v_accvgpr_read_b32 v234, a8
    v_accvgpr_read_b32 v235, a9
    v_accvgpr_read_b32 v236, a10
    v_accvgpr_read_b32 v237, a11
    v_mul_f32 v234, v234, v231
    v_mul_f32 v235, v235, v231
    v_mul_f32 v236, v236, v231
    v_mul_f32 v237, v237, v231
    v_accvgpr_write_b32 a8, v234
    v_accvgpr_write_b32 a9, v235
    v_accvgpr_write_b32 a10, v236
    v_accvgpr_write_b32 a11, v237
    v_accvgpr_read_b32 v234, a12
    v_accvgpr_read_b32 v235, a13
    v_accvgpr_read_b32 v236, a14
    v_accvgpr_read_b32 v237, a15
    v_mul_f32 v234, v234, v231
    v_mul_f32 v235, v235, v231
    v_mul_f32 v236, v236, v231
    v_mul_f32 v237, v237, v231
    v_accvgpr_write_b32 a12, v234
    v_accvgpr_write_b32 a13, v235
    v_accvgpr_write_b32 a14, v236
    v_accvgpr_write_b32 a15, v237
    v_accvgpr_read_b32 v234, a16
    v_accvgpr_read_b32 v235, a17
    v_accvgpr_read_b32 v236, a18
    v_accvgpr_read_b32 v237, a19
    v_mul_f32 v234, v234, v231
    v_mul_f32 v235, v235, v231
    v_mul_f32 v236, v236, v231
    v_mul_f32 v237, v237, v231
    v_accvgpr_write_b32 a16, v234
    v_accvgpr_write_b32 a17, v235
    v_accvgpr_write_b32 a18, v236
    v_accvgpr_write_b32 a19, v237
    v_accvgpr_read_b32 v234, a20
    v_accvgpr_read_b32 v235, a21
    v_accvgpr_read_b32 v236, a22
    v_accvgpr_read_b32 v237, a23
    v_mul_f32 v234, v234, v231
    v_mul_f32 v235, v235, v231
    v_mul_f32 v236, v236, v231
    v_mul_f32 v237, v237, v231
    v_accvgpr_write_b32 a20, v234
    v_accvgpr_write_b32 a21, v235
    v_accvgpr_write_b32 a22, v236
    v_accvgpr_write_b32 a23, v237
    v_accvgpr_read_b32 v234, a24
    v_accvgpr_read_b32 v235, a25
    v_accvgpr_read_b32 v236, a26
    v_accvgpr_read_b32 v237, a27
    v_mul_f32 v234, v234, v231
    v_mul_f32 v235, v235, v231
    v_mul_f32 v236, v236, v231
    v_mul_f32 v237, v237, v231
    v_accvgpr_write_b32 a24, v234
    v_accvgpr_write_b32 a25, v235
    v_accvgpr_write_b32 a26, v236
    v_accvgpr_write_b32 a27, v237
    v_accvgpr_read_b32 v234, a28
    v_accvgpr_read_b32 v235, a29
    v_accvgpr_read_b32 v236, a30
    v_accvgpr_read_b32 v237, a31
    v_mul_f32 v234, v234, v231
    v_mul_f32 v235, v235, v231
    v_mul_f32 v236, v236, v231
    v_mul_f32 v237, v237, v231
    v_accvgpr_write_b32 a28, v234
    v_accvgpr_write_b32 a29, v235
    v_accvgpr_write_b32 a30, v236
    v_accvgpr_write_b32 a31, v237
    v_accvgpr_read_b32 v234, a32
    v_accvgpr_read_b32 v235, a33
    v_accvgpr_read_b32 v236, a34
    v_accvgpr_read_b32 v237, a35
    v_mul_f32 v234, v234, v231
    v_mul_f32 v235, v235, v231
    v_mul_f32 v236, v236, v231
    v_mul_f32 v237, v237, v231
    v_accvgpr_write_b32 a32, v234
    v_accvgpr_write_b32 a33, v235
    v_accvgpr_write_b32 a34, v236
    v_accvgpr_write_b32 a35, v237
    v_accvgpr_read_b32 v234, a36
    v_accvgpr_read_b32 v235, a37
    v_accvgpr_read_b32 v236, a38
    v_accvgpr_read_b32 v237, a39
    v_mul_f32 v234, v234, v231
    v_mul_f32 v235, v235, v231
    v_mul_f32 v236, v236, v231
    v_mul_f32 v237, v237, v231
    v_accvgpr_write_b32 a36, v234
    v_accvgpr_write_b32 a37, v235
    v_accvgpr_write_b32 a38, v236
    v_accvgpr_write_b32 a39, v237
    v_accvgpr_read_b32 v234, a40
    v_accvgpr_read_b32 v235, a41
    v_accvgpr_read_b32 v236, a42
    v_accvgpr_read_b32 v237, a43
    v_mul_f32 v234, v234, v231
    v_mul_f32 v235, v235, v231
    v_mul_f32 v236, v236, v231
    v_mul_f32 v237, v237, v231
    v_accvgpr_write_b32 a40, v234
    v_accvgpr_write_b32 a41, v235
    v_accvgpr_write_b32 a42, v236
    v_accvgpr_write_b32 a43, v237
    v_accvgpr_read_b32 v234, a44
    v_accvgpr_read_b32 v235, a45
    v_accvgpr_read_b32 v236, a46
    v_accvgpr_read_b32 v237, a47
    v_mul_f32 v234, v234, v231
    v_mul_f32 v235, v235, v231
    v_mul_f32 v236, v236, v231
    v_mul_f32 v237, v237, v231
    v_accvgpr_write_b32 a44, v234
    v_accvgpr_write_b32 a45, v235
    v_accvgpr_write_b32 a46, v236
    v_accvgpr_write_b32 a47, v237
    v_accvgpr_read_b32 v234, a48
    v_accvgpr_read_b32 v235, a49
    v_accvgpr_read_b32 v236, a50
    v_accvgpr_read_b32 v237, a51
    v_mul_f32 v234, v234, v231
    v_mul_f32 v235, v235, v231
    v_mul_f32 v236, v236, v231
    v_mul_f32 v237, v237, v231
    v_accvgpr_write_b32 a48, v234
    v_accvgpr_write_b32 a49, v235
    v_accvgpr_write_b32 a50, v236
    v_accvgpr_write_b32 a51, v237
    v_accvgpr_read_b32 v234, a52
    v_accvgpr_read_b32 v235, a53
    v_accvgpr_read_b32 v236, a54
    v_accvgpr_read_b32 v237, a55
    v_mul_f32 v234, v234, v231
    v_mul_f32 v235, v235, v231
    v_mul_f32 v236, v236, v231
    v_mul_f32 v237, v237, v231
    v_accvgpr_write_b32 a52, v234
    v_accvgpr_write_b32 a53, v235
    v_accvgpr_write_b32 a54, v236
    v_accvgpr_write_b32 a55, v237
    v_accvgpr_read_b32 v234, a56
    v_accvgpr_read_b32 v235, a57
    v_accvgpr_read_b32 v236, a58
    v_accvgpr_read_b32 v237, a59
    v_mul_f32 v234, v234, v231
    v_mul_f32 v235, v235, v231
    v_mul_f32 v236, v236, v231
    v_mul_f32 v237, v237, v231
    v_accvgpr_write_b32 a56, v234
    v_accvgpr_write_b32 a57, v235
    v_accvgpr_write_b32 a58, v236
    v_accvgpr_write_b32 a59, v237
    v_accvgpr_read_b32 v234, a60
    v_accvgpr_read_b32 v235, a61
    v_accvgpr_read_b32 v236, a62
    v_accvgpr_read_b32 v237, a63
    v_mul_f32 v234, v234, v231
    v_mul_f32 v235, v235, v231
    v_mul_f32 v236, v236, v231
    v_mul_f32 v237, v237, v231
    v_accvgpr_write_b32 a60, v234
    v_accvgpr_write_b32 a61, v235
    v_accvgpr_write_b32 a62, v236
    v_accvgpr_write_b32 a63, v237
    v_accvgpr_read_b32 v234, a64
    v_accvgpr_read_b32 v235, a65
    v_accvgpr_read_b32 v236, a66
    v_accvgpr_read_b32 v237, a67
    v_mul_f32 v234, v234, v231
    v_mul_f32 v235, v235, v231
    v_mul_f32 v236, v236, v231
    v_mul_f32 v237, v237, v231
    v_accvgpr_write_b32 a64, v234
    v_accvgpr_write_b32 a65, v235
    v_accvgpr_write_b32 a66, v236
    v_accvgpr_write_b32 a67, v237
    v_accvgpr_read_b32 v234, a68
    v_accvgpr_read_b32 v235, a69
    v_accvgpr_read_b32 v236, a70
    v_accvgpr_read_b32 v237, a71
    v_mul_f32 v234, v234, v231
    v_mul_f32 v235, v235, v231
    v_mul_f32 v236, v236, v231
    v_mul_f32 v237, v237, v231
    v_accvgpr_write_b32 a68, v234
    v_accvgpr_write_b32 a69, v235
    v_accvgpr_write_b32 a70, v236
    v_accvgpr_write_b32 a71, v237
    v_accvgpr_read_b32 v234, a72
    v_accvgpr_read_b32 v235, a73
    v_accvgpr_read_b32 v236, a74
    v_accvgpr_read_b32 v237, a75
    v_mul_f32 v234, v234, v231
    v_mul_f32 v235, v235, v231
    v_mul_f32 v236, v236, v231
    v_mul_f32 v237, v237, v231
    v_accvgpr_write_b32 a72, v234
    v_accvgpr_write_b32 a73, v235
    v_accvgpr_write_b32 a74, v236
    v_accvgpr_write_b32 a75, v237
    v_accvgpr_read_b32 v234, a76
    v_accvgpr_read_b32 v235, a77
    v_accvgpr_read_b32 v236, a78
    v_accvgpr_read_b32 v237, a79
    v_mul_f32 v234, v234, v231
    v_mul_f32 v235, v235, v231
    v_mul_f32 v236, v236, v231
    v_mul_f32 v237, v237, v231
    v_accvgpr_write_b32 a76, v234
    v_accvgpr_write_b32 a77, v235
    v_accvgpr_write_b32 a78, v236
    v_accvgpr_write_b32 a79, v237
    v_accvgpr_read_b32 v234, a80
    v_accvgpr_read_b32 v235, a81
    v_accvgpr_read_b32 v236, a82
    v_accvgpr_read_b32 v237, a83
    v_mul_f32 v234, v234, v231
    v_mul_f32 v235, v235, v231
    v_mul_f32 v236, v236, v231
    v_mul_f32 v237, v237, v231
    v_accvgpr_write_b32 a80, v234
    v_accvgpr_write_b32 a81, v235
    v_accvgpr_write_b32 a82, v236
    v_accvgpr_write_b32 a83, v237
    v_accvgpr_read_b32 v234, a84
    v_accvgpr_read_b32 v235, a85
    v_accvgpr_read_b32 v236, a86
    v_accvgpr_read_b32 v237, a87
    v_mul_f32 v234, v234, v231
    v_mul_f32 v235, v235, v231
    v_mul_f32 v236, v236, v231
    v_mul_f32 v237, v237, v231
    v_accvgpr_write_b32 a84, v234
    v_accvgpr_write_b32 a85, v235
    v_accvgpr_write_b32 a86, v236
    v_accvgpr_write_b32 a87, v237
    v_accvgpr_read_b32 v234, a88
    v_accvgpr_read_b32 v235, a89
    v_accvgpr_read_b32 v236, a90
    v_accvgpr_read_b32 v237, a91
    v_mul_f32 v234, v234, v231
    v_mul_f32 v235, v235, v231
    v_mul_f32 v236, v236, v231
    v_mul_f32 v237, v237, v231
    v_accvgpr_write_b32 a88, v234
    v_accvgpr_write_b32 a89, v235
    v_accvgpr_write_b32 a90, v236
    v_accvgpr_write_b32 a91, v237
    v_accvgpr_read_b32 v234, a92
    v_accvgpr_read_b32 v235, a93
    v_accvgpr_read_b32 v236, a94
    v_accvgpr_read_b32 v237, a95
    v_mul_f32 v234, v234, v231
    v_mul_f32 v235, v235, v231
    v_mul_f32 v236, v236, v231
    v_mul_f32 v237, v237, v231
    v_accvgpr_write_b32 a92, v234
    v_accvgpr_write_b32 a93, v235
    v_accvgpr_write_b32 a94, v236
    v_accvgpr_write_b32 a95, v237
    v_accvgpr_read_b32 v234, a96
    v_accvgpr_read_b32 v235, a97
    v_accvgpr_read_b32 v236, a98
    v_accvgpr_read_b32 v237, a99
    v_mul_f32 v234, v234, v231
    v_mul_f32 v235, v235, v231
    v_mul_f32 v236, v236, v231
    v_mul_f32 v237, v237, v231
    v_accvgpr_write_b32 a96, v234
    v_accvgpr_write_b32 a97, v235
    v_accvgpr_write_b32 a98, v236
    v_accvgpr_write_b32 a99, v237
    v_accvgpr_read_b32 v234, a100
    v_accvgpr_read_b32 v235, a101
    v_accvgpr_read_b32 v236, a102
    v_accvgpr_read_b32 v237, a103
    v_mul_f32 v234, v234, v231
    v_mul_f32 v235, v235, v231
    v_mul_f32 v236, v236, v231
    v_mul_f32 v237, v237, v231
    v_accvgpr_write_b32 a100, v234
    v_accvgpr_write_b32 a101, v235
    v_accvgpr_write_b32 a102, v236
    v_accvgpr_write_b32 a103, v237
    v_accvgpr_read_b32 v234, a104
    v_accvgpr_read_b32 v235, a105
    v_accvgpr_read_b32 v236, a106
    v_accvgpr_read_b32 v237, a107
    v_mul_f32 v234, v234, v231
    v_mul_f32 v235, v235, v231
    v_mul_f32 v236, v236, v231
    v_mul_f32 v237, v237, v231
    v_accvgpr_write_b32 a104, v234
    v_accvgpr_write_b32 a105, v235
    v_accvgpr_write_b32 a106, v236
    v_accvgpr_write_b32 a107, v237
    v_accvgpr_read_b32 v234, a108
    v_accvgpr_read_b32 v235, a109
    v_accvgpr_read_b32 v236, a110
    v_accvgpr_read_b32 v237, a111
    v_mul_f32 v234, v234, v231
    v_mul_f32 v235, v235, v231
    v_mul_f32 v236, v236, v231
    v_mul_f32 v237, v237, v231
    v_accvgpr_write_b32 a108, v234
    v_accvgpr_write_b32 a109, v235
    v_accvgpr_write_b32 a110, v236
    v_accvgpr_write_b32 a111, v237
    v_accvgpr_read_b32 v234, a112
    v_accvgpr_read_b32 v235, a113
    v_accvgpr_read_b32 v236, a114
    v_accvgpr_read_b32 v237, a115
    v_mul_f32 v234, v234, v231
    v_mul_f32 v235, v235, v231
    v_mul_f32 v236, v236, v231
    v_mul_f32 v237, v237, v231
    v_accvgpr_write_b32 a112, v234
    v_accvgpr_write_b32 a113, v235
    v_accvgpr_write_b32 a114, v236
    v_accvgpr_write_b32 a115, v237
    v_accvgpr_read_b32 v234, a116
    v_accvgpr_read_b32 v235, a117
    v_accvgpr_read_b32 v236, a118
    v_accvgpr_read_b32 v237, a119
    v_mul_f32 v234, v234, v231
    v_mul_f32 v235, v235, v231
    v_mul_f32 v236, v236, v231
    v_mul_f32 v237, v237, v231
    v_accvgpr_write_b32 a116, v234
    v_accvgpr_write_b32 a117, v235
    v_accvgpr_write_b32 a118, v236
    v_accvgpr_write_b32 a119, v237
    v_accvgpr_read_b32 v234, a120
    v_accvgpr_read_b32 v235, a121
    v_accvgpr_read_b32 v236, a122
    v_accvgpr_read_b32 v237, a123
    v_mul_f32 v234, v234, v231
    v_mul_f32 v235, v235, v231
    v_mul_f32 v236, v236, v231
    v_mul_f32 v237, v237, v231
    v_accvgpr_write_b32 a120, v234
    v_accvgpr_write_b32 a121, v235
    v_accvgpr_write_b32 a122, v236
    v_accvgpr_write_b32 a123, v237
    v_accvgpr_read_b32 v234, a124
    v_accvgpr_read_b32 v235, a125
    v_accvgpr_read_b32 v236, a126
    v_accvgpr_read_b32 v237, a127
    v_mul_f32 v234, v234, v231
    v_mul_f32 v235, v235, v231
    v_mul_f32 v236, v236, v231
    v_mul_f32 v237, v237, v231
    v_accvgpr_write_b32 a124, v234
    v_accvgpr_write_b32 a125, v235
    v_accvgpr_write_b32 a126, v236
    v_accvgpr_write_b32 a127, v237
    v_mov_b32 v230, 1.0
    v_mov_b32 v231, 1.0
    s_mov_b32 s30, 0
    s_nop 1
    s_branch RBACK_22
RARE_23:
    v_max3_f32 v242, v160, v161, v162
    v_max3_f32 v243, v163, v164, v165
    v_max3_f32 v242, v242, v166, v167
    v_max3_f32 v243, v243, v168, v169
    v_max3_f32 v242, v242, v170, v171
    v_max3_f32 v243, v243, v172, v173
    v_max3_f32 v242, v242, v174, v175
    v_max_f32 v242, v242, v243
    v_mov_b32 v243, v242
    s_nop 1
    v_permlane32_swap_b32 v242, v243
    s_nop 1
    v_max_f32 v242, v242, v243
    v_mul_f32 v242, s20, v242
    v_max_f32_e64 v242, v242, -v227
    v_add_f32 v243, v227, v242
    v_exp_f32_e64 v243, -v243
    v_sub_f32 v227, 0, v242
    v_mul_f32 v229, v229, v243
    v_mul_f32 v231, v231, v243
    s_mov_b32 s30, 1
    v_fma_f32 v234, v160, s20, v227
    v_fma_f32 v235, v161, s20, v227
    v_exp_f32 v234, v234
    v_fma_f32 v236, v162, s20, v227
    v_exp_f32 v235, v235
    v_fma_f32 v237, v163, s20, v227
    v_exp_f32 v236, v236
    v_mov_b32 v232, v234
    v_fma_f32 v238, v164, s20, v227
    v_exp_f32 v237, v237
    v_mov_b32 v233, v235
    v_cvt_pk_bf16_f32 v192, v234, v235
    v_fma_f32 v239, v165, s20, v227
    v_exp_f32 v238, v238
    v_add_f32 v232, v232, v236
    v_fma_f32 v240, v166, s20, v227
    v_exp_f32 v239, v239
    v_add_f32 v233, v233, v237
    v_cvt_pk_bf16_f32 v193, v236, v237
    v_fma_f32 v241, v167, s20, v227
    v_exp_f32 v240, v240
    v_add_f32 v232, v232, v238
    v_fma_f32 v234, v168, s20, v227
    v_exp_f32 v241, v241
    v_add_f32 v233, v233, v239
    v_cvt_pk_bf16_f32 v194, v238, v239
    v_fma_f32 v235, v169, s20, v227
    v_exp_f32 v234, v234
    v_add_f32 v232, v232, v240
    v_fma_f32 v236, v170, s20, v227
    v_exp_f32 v235, v235
    v_add_f32 v233, v233, v241
    v_cvt_pk_bf16_f32 v195, v240, v241
    v_fma_f32 v237, v171, s20, v227
    v_exp_f32 v236, v236
    v_add_f32 v232, v232, v234
    v_fma_f32 v238, v172, s20, v227
    v_exp_f32 v237, v237
    v_add_f32 v233, v233, v235
    v_cvt_pk_bf16_f32 v196, v234, v235
    v_fma_f32 v239, v173, s20, v227
    v_exp_f32 v238, v238
    v_add_f32 v232, v232, v236
    v_fma_f32 v240, v174, s20, v227
    v_exp_f32 v239, v239
    v_add_f32 v233, v233, v237
    v_cvt_pk_bf16_f32 v197, v236, v237
    v_fma_f32 v241, v175, s20, v227
    v_exp_f32 v240, v240
    v_add_f32 v232, v232, v238
    v_exp_f32 v241, v241
    v_add_f32 v233, v233, v239
    v_cvt_pk_bf16_f32 v198, v238, v239
    v_add_f32 v232, v232, v240
    v_add_f32 v233, v233, v241
    v_cvt_pk_bf16_f32 v199, v240, v241
    v_add_f32 v232, v232, v233
    s_branch BACK_23
RESC_24:
    s_nop 7
    s_nop 7
    v_mul_f32 v0, v0, v230
    v_mul_f32 v1, v1, v230
    v_mul_f32 v2, v2, v230
    v_mul_f32 v3, v3, v230
    v_mul_f32 v4, v4, v230
    v_mul_f32 v5, v5, v230
    v_mul_f32 v6, v6, v230
    v_mul_f32 v7, v7, v230
    v_mul_f32 v8, v8, v230
    v_mul_f32 v9, v9, v230
    v_mul_f32 v10, v10, v230
    v_mul_f32 v11, v11, v230
    v_mul_f32 v12, v12, v230
    v_mul_f32 v13, v13, v230
    v_mul_f32 v14, v14, v230
    v_mul_f32 v15, v15, v230
    v_mul_f32 v16, v16, v230
    v_mul_f32 v17, v17, v230
    v_mul_f32 v18, v18, v230
    v_mul_f32 v19, v19, v230
    v_mul_f32 v20, v20, v230
    v_mul_f32 v21, v21, v230
    v_mul_f32 v22, v22, v230
    v_mul_f32 v23, v23, v230
    v_mul_f32 v24, v24, v230
    v_mul_f32 v25, v25, v230
    v_mul_f32 v26, v26, v230
    v_mul_f32 v27, v27, v230
    v_mul_f32 v28, v28, v230
    v_mul_f32 v29, v29, v230
    v_mul_f32 v30, v30, v230
    v_mul_f32 v31, v31, v230
    v_mul_f32 v32, v32, v230
    v_mul_f32 v33, v33, v230
    v_mul_f32 v34, v34, v230
    v_mul_f32 v35, v35, v230
    v_mul_f32 v36, v36, v230
    v_mul_f32 v37, v37, v230
    v_mul_f32 v38, v38, v230
    v_mul_f32 v39, v39, v230
    v_mul_f32 v40, v40, v230
    v_mul_f32 v41, v41, v230
    v_mul_f32 v42, v42, v230
    v_mul_f32 v43, v43, v230
    v_mul_f32 v44, v44, v230
    v_mul_f32 v45, v45, v230
    v_mul_f32 v46, v46, v230
    v_mul_f32 v47, v47, v230
    v_mul_f32 v48, v48, v230
    v_mul_f32 v49, v49, v230
    v_mul_f32 v50, v50, v230
    v_mul_f32 v51, v51, v230
    v_mul_f32 v52, v52, v230
    v_mul_f32 v53, v53, v230
    v_mul_f32 v54, v54, v230
    v_mul_f32 v55, v55, v230
    v_mul_f32 v56, v56, v230
    v_mul_f32 v57, v57, v230
    v_mul_f32 v58, v58, v230
    v_mul_f32 v59, v59, v230
    v_mul_f32 v60, v60, v230
    v_mul_f32 v61, v61, v230
    v_mul_f32 v62, v62, v230
    v_mul_f32 v63, v63, v230
    v_mul_f32 v64, v64, v230
    v_mul_f32 v65, v65, v230
    v_mul_f32 v66, v66, v230
    v_mul_f32 v67, v67, v230
    v_mul_f32 v68, v68, v230
    v_mul_f32 v69, v69, v230
    v_mul_f32 v70, v70, v230
    v_mul_f32 v71, v71, v230
    v_mul_f32 v72, v72, v230
    v_mul_f32 v73, v73, v230
    v_mul_f32 v74, v74, v230
    v_mul_f32 v75, v75, v230
    v_mul_f32 v76, v76, v230
    v_mul_f32 v77, v77, v230
    v_mul_f32 v78, v78, v230
    v_mul_f32 v79, v79, v230
    v_mul_f32 v80, v80, v230
    v_mul_f32 v81, v81, v230
    v_mul_f32 v82, v82, v230
    v_mul_f32 v83, v83, v230
    v_mul_f32 v84, v84, v230
    v_mul_f32 v85, v85, v230
    v_mul_f32 v86, v86, v230
    v_mul_f32 v87, v87, v230
    v_mul_f32 v88, v88, v230
    v_mul_f32 v89, v89, v230
    v_mul_f32 v90, v90, v230
    v_mul_f32 v91, v91, v230
    v_mul_f32 v92, v92, v230
    v_mul_f32 v93, v93, v230
    v_mul_f32 v94, v94, v230
    v_mul_f32 v95, v95, v230
    v_mul_f32 v96, v96, v230
    v_mul_f32 v97, v97, v230
    v_mul_f32 v98, v98, v230
    v_mul_f32 v99, v99, v230
    v_mul_f32 v100, v100, v230
    v_mul_f32 v101, v101, v230
    v_mul_f32 v102, v102, v230
    v_mul_f32 v103, v103, v230
    v_mul_f32 v104, v104, v230
    v_mul_f32 v105, v105, v230
    v_mul_f32 v106, v106, v230
    v_mul_f32 v107, v107, v230
    v_mul_f32 v108, v108, v230
    v_mul_f32 v109, v109, v230
    v_mul_f32 v110, v110, v230
    v_mul_f32 v111, v111, v230
    v_mul_f32 v112, v112, v230
    v_mul_f32 v113, v113, v230
    v_mul_f32 v114, v114, v230
    v_mul_f32 v115, v115, v230
    v_mul_f32 v116, v116, v230
    v_mul_f32 v117, v117, v230
    v_mul_f32 v118, v118, v230
    v_mul_f32 v119, v119, v230
    v_mul_f32 v120, v120, v230
    v_mul_f32 v121, v121, v230
    v_mul_f32 v122, v122, v230
    v_mul_f32 v123, v123, v230
    v_mul_f32 v124, v124, v230
    v_mul_f32 v125, v125, v230
    v_mul_f32 v126, v126, v230
    v_mul_f32 v127, v127, v230
    v_accvgpr_read_b32 v234, a0
    v_accvgpr_read_b32 v235, a1
    v_accvgpr_read_b32 v236, a2
    v_accvgpr_read_b32 v237, a3
    v_mul_f32 v234, v234, v231
    v_mul_f32 v235, v235, v231
    v_mul_f32 v236, v236, v231
    v_mul_f32 v237, v237, v231
    v_accvgpr_write_b32 a0, v234
    v_accvgpr_write_b32 a1, v235
    v_accvgpr_write_b32 a2, v236
    v_accvgpr_write_b32 a3, v237
    v_accvgpr_read_b32 v234, a4
    v_accvgpr_read_b32 v235, a5
    v_accvgpr_read_b32 v236, a6
    v_accvgpr_read_b32 v237, a7
    v_mul_f32 v234, v234, v231
    v_mul_f32 v235, v235, v231
    v_mul_f32 v236, v236, v231
    v_mul_f32 v237, v237, v231
    v_accvgpr_write_b32 a4, v234
    v_accvgpr_write_b32 a5, v235
    v_accvgpr_write_b32 a6, v236
    v_accvgpr_write_b32 a7, v237
    v_accvgpr_read_b32 v234, a8
    v_accvgpr_read_b32 v235, a9
    v_accvgpr_read_b32 v236, a10
    v_accvgpr_read_b32 v237, a11
    v_mul_f32 v234, v234, v231
    v_mul_f32 v235, v235, v231
    v_mul_f32 v236, v236, v231
    v_mul_f32 v237, v237, v231
    v_accvgpr_write_b32 a8, v234
    v_accvgpr_write_b32 a9, v235
    v_accvgpr_write_b32 a10, v236
    v_accvgpr_write_b32 a11, v237
    v_accvgpr_read_b32 v234, a12
    v_accvgpr_read_b32 v235, a13
    v_accvgpr_read_b32 v236, a14
    v_accvgpr_read_b32 v237, a15
    v_mul_f32 v234, v234, v231
    v_mul_f32 v235, v235, v231
    v_mul_f32 v236, v236, v231
    v_mul_f32 v237, v237, v231
    v_accvgpr_write_b32 a12, v234
    v_accvgpr_write_b32 a13, v235
    v_accvgpr_write_b32 a14, v236
    v_accvgpr_write_b32 a15, v237
    v_accvgpr_read_b32 v234, a16
    v_accvgpr_read_b32 v235, a17
    v_accvgpr_read_b32 v236, a18
    v_accvgpr_read_b32 v237, a19
    v_mul_f32 v234, v234, v231
    v_mul_f32 v235, v235, v231
    v_mul_f32 v236, v236, v231
    v_mul_f32 v237, v237, v231
    v_accvgpr_write_b32 a16, v234
    v_accvgpr_write_b32 a17, v235
    v_accvgpr_write_b32 a18, v236
    v_accvgpr_write_b32 a19, v237
    v_accvgpr_read_b32 v234, a20
    v_accvgpr_read_b32 v235, a21
    v_accvgpr_read_b32 v236, a22
    v_accvgpr_read_b32 v237, a23
    v_mul_f32 v234, v234, v231
    v_mul_f32 v235, v235, v231
    v_mul_f32 v236, v236, v231
    v_mul_f32 v237, v237, v231
    v_accvgpr_write_b32 a20, v234
    v_accvgpr_write_b32 a21, v235
    v_accvgpr_write_b32 a22, v236
    v_accvgpr_write_b32 a23, v237
    v_accvgpr_read_b32 v234, a24
    v_accvgpr_read_b32 v235, a25
    v_accvgpr_read_b32 v236, a26
    v_accvgpr_read_b32 v237, a27
    v_mul_f32 v234, v234, v231
    v_mul_f32 v235, v235, v231
    v_mul_f32 v236, v236, v231
    v_mul_f32 v237, v237, v231
    v_accvgpr_write_b32 a24, v234
    v_accvgpr_write_b32 a25, v235
    v_accvgpr_write_b32 a26, v236
    v_accvgpr_write_b32 a27, v237
    v_accvgpr_read_b32 v234, a28
    v_accvgpr_read_b32 v235, a29
    v_accvgpr_read_b32 v236, a30
    v_accvgpr_read_b32 v237, a31
    v_mul_f32 v234, v234, v231
    v_mul_f32 v235, v235, v231
    v_mul_f32 v236, v236, v231
    v_mul_f32 v237, v237, v231
    v_accvgpr_write_b32 a28, v234
    v_accvgpr_write_b32 a29, v235
    v_accvgpr_write_b32 a30, v236
    v_accvgpr_write_b32 a31, v237
    v_accvgpr_read_b32 v234, a32
    v_accvgpr_read_b32 v235, a33
    v_accvgpr_read_b32 v236, a34
    v_accvgpr_read_b32 v237, a35
    v_mul_f32 v234, v234, v231
    v_mul_f32 v235, v235, v231
    v_mul_f32 v236, v236, v231
    v_mul_f32 v237, v237, v231
    v_accvgpr_write_b32 a32, v234
    v_accvgpr_write_b32 a33, v235
    v_accvgpr_write_b32 a34, v236
    v_accvgpr_write_b32 a35, v237
    v_accvgpr_read_b32 v234, a36
    v_accvgpr_read_b32 v235, a37
    v_accvgpr_read_b32 v236, a38
    v_accvgpr_read_b32 v237, a39
    v_mul_f32 v234, v234, v231
    v_mul_f32 v235, v235, v231
    v_mul_f32 v236, v236, v231
    v_mul_f32 v237, v237, v231
    v_accvgpr_write_b32 a36, v234
    v_accvgpr_write_b32 a37, v235
    v_accvgpr_write_b32 a38, v236
    v_accvgpr_write_b32 a39, v237
    v_accvgpr_read_b32 v234, a40
    v_accvgpr_read_b32 v235, a41
    v_accvgpr_read_b32 v236, a42
    v_accvgpr_read_b32 v237, a43
    v_mul_f32 v234, v234, v231
    v_mul_f32 v235, v235, v231
    v_mul_f32 v236, v236, v231
    v_mul_f32 v237, v237, v231
    v_accvgpr_write_b32 a40, v234
    v_accvgpr_write_b32 a41, v235
    v_accvgpr_write_b32 a42, v236
    v_accvgpr_write_b32 a43, v237
    v_accvgpr_read_b32 v234, a44
    v_accvgpr_read_b32 v235, a45
    v_accvgpr_read_b32 v236, a46
    v_accvgpr_read_b32 v237, a47
    v_mul_f32 v234, v234, v231
    v_mul_f32 v235, v235, v231
    v_mul_f32 v236, v236, v231
    v_mul_f32 v237, v237, v231
    v_accvgpr_write_b32 a44, v234
    v_accvgpr_write_b32 a45, v235
    v_accvgpr_write_b32 a46, v236
    v_accvgpr_write_b32 a47, v237
    v_accvgpr_read_b32 v234, a48
    v_accvgpr_read_b32 v235, a49
    v_accvgpr_read_b32 v236, a50
    v_accvgpr_read_b32 v237, a51
    v_mul_f32 v234, v234, v231
    v_mul_f32 v235, v235, v231
    v_mul_f32 v236, v236, v231
    v_mul_f32 v237, v237, v231
    v_accvgpr_write_b32 a48, v234
    v_accvgpr_write_b32 a49, v235
    v_accvgpr_write_b32 a50, v236
    v_accvgpr_write_b32 a51, v237
    v_accvgpr_read_b32 v234, a52
    v_accvgpr_read_b32 v235, a53
    v_accvgpr_read_b32 v236, a54
    v_accvgpr_read_b32 v237, a55
    v_mul_f32 v234, v234, v231
    v_mul_f32 v235, v235, v231
    v_mul_f32 v236, v236, v231
    v_mul_f32 v237, v237, v231
    v_accvgpr_write_b32 a52, v234
    v_accvgpr_write_b32 a53, v235
    v_accvgpr_write_b32 a54, v236
    v_accvgpr_write_b32 a55, v237
    v_accvgpr_read_b32 v234, a56
    v_accvgpr_read_b32 v235, a57
    v_accvgpr_read_b32 v236, a58
    v_accvgpr_read_b32 v237, a59
    v_mul_f32 v234, v234, v231
    v_mul_f32 v235, v235, v231
    v_mul_f32 v236, v236, v231
    v_mul_f32 v237, v237, v231
    v_accvgpr_write_b32 a56, v234
    v_accvgpr_write_b32 a57, v235
    v_accvgpr_write_b32 a58, v236
    v_accvgpr_write_b32 a59, v237
    v_accvgpr_read_b32 v234, a60
    v_accvgpr_read_b32 v235, a61
    v_accvgpr_read_b32 v236, a62
    v_accvgpr_read_b32 v237, a63
    v_mul_f32 v234, v234, v231
    v_mul_f32 v235, v235, v231
    v_mul_f32 v236, v236, v231
    v_mul_f32 v237, v237, v231
    v_accvgpr_write_b32 a60, v234
    v_accvgpr_write_b32 a61, v235
    v_accvgpr_write_b32 a62, v236
    v_accvgpr_write_b32 a63, v237
    v_accvgpr_read_b32 v234, a64
    v_accvgpr_read_b32 v235, a65
    v_accvgpr_read_b32 v236, a66
    v_accvgpr_read_b32 v237, a67
    v_mul_f32 v234, v234, v231
    v_mul_f32 v235, v235, v231
    v_mul_f32 v236, v236, v231
    v_mul_f32 v237, v237, v231
    v_accvgpr_write_b32 a64, v234
    v_accvgpr_write_b32 a65, v235
    v_accvgpr_write_b32 a66, v236
    v_accvgpr_write_b32 a67, v237
    v_accvgpr_read_b32 v234, a68
    v_accvgpr_read_b32 v235, a69
    v_accvgpr_read_b32 v236, a70
    v_accvgpr_read_b32 v237, a71
    v_mul_f32 v234, v234, v231
    v_mul_f32 v235, v235, v231
    v_mul_f32 v236, v236, v231
    v_mul_f32 v237, v237, v231
    v_accvgpr_write_b32 a68, v234
    v_accvgpr_write_b32 a69, v235
    v_accvgpr_write_b32 a70, v236
    v_accvgpr_write_b32 a71, v237
    v_accvgpr_read_b32 v234, a72
    v_accvgpr_read_b32 v235, a73
    v_accvgpr_read_b32 v236, a74
    v_accvgpr_read_b32 v237, a75
    v_mul_f32 v234, v234, v231
    v_mul_f32 v235, v235, v231
    v_mul_f32 v236, v236, v231
    v_mul_f32 v237, v237, v231
    v_accvgpr_write_b32 a72, v234
    v_accvgpr_write_b32 a73, v235
    v_accvgpr_write_b32 a74, v236
    v_accvgpr_write_b32 a75, v237
    v_accvgpr_read_b32 v234, a76
    v_accvgpr_read_b32 v235, a77
    v_accvgpr_read_b32 v236, a78
    v_accvgpr_read_b32 v237, a79
    v_mul_f32 v234, v234, v231
    v_mul_f32 v235, v235, v231
    v_mul_f32 v236, v236, v231
    v_mul_f32 v237, v237, v231
    v_accvgpr_write_b32 a76, v234
    v_accvgpr_write_b32 a77, v235
    v_accvgpr_write_b32 a78, v236
    v_accvgpr_write_b32 a79, v237
    v_accvgpr_read_b32 v234, a80
    v_accvgpr_read_b32 v235, a81
    v_accvgpr_read_b32 v236, a82
    v_accvgpr_read_b32 v237, a83
    v_mul_f32 v234, v234, v231
    v_mul_f32 v235, v235, v231
    v_mul_f32 v236, v236, v231
    v_mul_f32 v237, v237, v231
    v_accvgpr_write_b32 a80, v234
    v_accvgpr_write_b32 a81, v235
    v_accvgpr_write_b32 a82, v236
    v_accvgpr_write_b32 a83, v237
    v_accvgpr_read_b32 v234, a84
    v_accvgpr_read_b32 v235, a85
    v_accvgpr_read_b32 v236, a86
    v_accvgpr_read_b32 v237, a87
    v_mul_f32 v234, v234, v231
    v_mul_f32 v235, v235, v231
    v_mul_f32 v236, v236, v231
    v_mul_f32 v237, v237, v231
    v_accvgpr_write_b32 a84, v234
    v_accvgpr_write_b32 a85, v235
    v_accvgpr_write_b32 a86, v236
    v_accvgpr_write_b32 a87, v237
    v_accvgpr_read_b32 v234, a88
    v_accvgpr_read_b32 v235, a89
    v_accvgpr_read_b32 v236, a90
    v_accvgpr_read_b32 v237, a91
    v_mul_f32 v234, v234, v231
    v_mul_f32 v235, v235, v231
    v_mul_f32 v236, v236, v231
    v_mul_f32 v237, v237, v231
    v_accvgpr_write_b32 a88, v234
    v_accvgpr_write_b32 a89, v235
    v_accvgpr_write_b32 a90, v236
    v_accvgpr_write_b32 a91, v237
    v_accvgpr_read_b32 v234, a92
    v_accvgpr_read_b32 v235, a93
    v_accvgpr_read_b32 v236, a94
    v_accvgpr_read_b32 v237, a95
    v_mul_f32 v234, v234, v231
    v_mul_f32 v235, v235, v231
    v_mul_f32 v236, v236, v231
    v_mul_f32 v237, v237, v231
    v_accvgpr_write_b32 a92, v234
    v_accvgpr_write_b32 a93, v235
    v_accvgpr_write_b32 a94, v236
    v_accvgpr_write_b32 a95, v237
    v_accvgpr_read_b32 v234, a96
    v_accvgpr_read_b32 v235, a97
    v_accvgpr_read_b32 v236, a98
    v_accvgpr_read_b32 v237, a99
    v_mul_f32 v234, v234, v231
    v_mul_f32 v235, v235, v231
    v_mul_f32 v236, v236, v231
    v_mul_f32 v237, v237, v231
    v_accvgpr_write_b32 a96, v234
    v_accvgpr_write_b32 a97, v235
    v_accvgpr_write_b32 a98, v236
    v_accvgpr_write_b32 a99, v237
    v_accvgpr_read_b32 v234, a100
    v_accvgpr_read_b32 v235, a101
    v_accvgpr_read_b32 v236, a102
    v_accvgpr_read_b32 v237, a103
    v_mul_f32 v234, v234, v231
    v_mul_f32 v235, v235, v231
    v_mul_f32 v236, v236, v231
    v_mul_f32 v237, v237, v231
    v_accvgpr_write_b32 a100, v234
    v_accvgpr_write_b32 a101, v235
    v_accvgpr_write_b32 a102, v236
    v_accvgpr_write_b32 a103, v237
    v_accvgpr_read_b32 v234, a104
    v_accvgpr_read_b32 v235, a105
    v_accvgpr_read_b32 v236, a106
    v_accvgpr_read_b32 v237, a107
    v_mul_f32 v234, v234, v231
    v_mul_f32 v235, v235, v231
    v_mul_f32 v236, v236, v231
    v_mul_f32 v237, v237, v231
    v_accvgpr_write_b32 a104, v234
    v_accvgpr_write_b32 a105, v235
    v_accvgpr_write_b32 a106, v236
    v_accvgpr_write_b32 a107, v237
    v_accvgpr_read_b32 v234, a108
    v_accvgpr_read_b32 v235, a109
    v_accvgpr_read_b32 v236, a110
    v_accvgpr_read_b32 v237, a111
    v_mul_f32 v234, v234, v231
    v_mul_f32 v235, v235, v231
    v_mul_f32 v236, v236, v231
    v_mul_f32 v237, v237, v231
    v_accvgpr_write_b32 a108, v234
    v_accvgpr_write_b32 a109, v235
    v_accvgpr_write_b32 a110, v236
    v_accvgpr_write_b32 a111, v237
    v_accvgpr_read_b32 v234, a112
    v_accvgpr_read_b32 v235, a113
    v_accvgpr_read_b32 v236, a114
    v_accvgpr_read_b32 v237, a115
    v_mul_f32 v234, v234, v231
    v_mul_f32 v235, v235, v231
    v_mul_f32 v236, v236, v231
    v_mul_f32 v237, v237, v231
    v_accvgpr_write_b32 a112, v234
    v_accvgpr_write_b32 a113, v235
    v_accvgpr_write_b32 a114, v236
    v_accvgpr_write_b32 a115, v237
    v_accvgpr_read_b32 v234, a116
    v_accvgpr_read_b32 v235, a117
    v_accvgpr_read_b32 v236, a118
    v_accvgpr_read_b32 v237, a119
    v_mul_f32 v234, v234, v231
    v_mul_f32 v235, v235, v231
    v_mul_f32 v236, v236, v231
    v_mul_f32 v237, v237, v231
    v_accvgpr_write_b32 a116, v234
    v_accvgpr_write_b32 a117, v235
    v_accvgpr_write_b32 a118, v236
    v_accvgpr_write_b32 a119, v237
    v_accvgpr_read_b32 v234, a120
    v_accvgpr_read_b32 v235, a121
    v_accvgpr_read_b32 v236, a122
    v_accvgpr_read_b32 v237, a123
    v_mul_f32 v234, v234, v231
    v_mul_f32 v235, v235, v231
    v_mul_f32 v236, v236, v231
    v_mul_f32 v237, v237, v231
    v_accvgpr_write_b32 a120, v234
    v_accvgpr_write_b32 a121, v235
    v_accvgpr_write_b32 a122, v236
    v_accvgpr_write_b32 a123, v237
    v_accvgpr_read_b32 v234, a124
    v_accvgpr_read_b32 v235, a125
    v_accvgpr_read_b32 v236, a126
    v_accvgpr_read_b32 v237, a127
    v_mul_f32 v234, v234, v231
    v_mul_f32 v235, v235, v231
    v_mul_f32 v236, v236, v231
    v_mul_f32 v237, v237, v231
    v_accvgpr_write_b32 a124, v234
    v_accvgpr_write_b32 a125, v235
    v_accvgpr_write_b32 a126, v236
    v_accvgpr_write_b32 a127, v237
    v_mov_b32 v230, 1.0
    v_mov_b32 v231, 1.0
    s_mov_b32 s30, 0
    s_nop 1
    s_branch RBACK_24
RESC_25:
    s_nop 7
    s_nop 7
    v_mul_f32 v0, v0, v230
    v_mul_f32 v1, v1, v230
    v_mul_f32 v2, v2, v230
    v_mul_f32 v3, v3, v230
    v_mul_f32 v4, v4, v230
    v_mul_f32 v5, v5, v230
    v_mul_f32 v6, v6, v230
    v_mul_f32 v7, v7, v230
    v_mul_f32 v8, v8, v230
    v_mul_f32 v9, v9, v230
    v_mul_f32 v10, v10, v230
    v_mul_f32 v11, v11, v230
    v_mul_f32 v12, v12, v230
    v_mul_f32 v13, v13, v230
    v_mul_f32 v14, v14, v230
    v_mul_f32 v15, v15, v230
    v_mul_f32 v16, v16, v230
    v_mul_f32 v17, v17, v230
    v_mul_f32 v18, v18, v230
    v_mul_f32 v19, v19, v230
    v_mul_f32 v20, v20, v230
    v_mul_f32 v21, v21, v230
    v_mul_f32 v22, v22, v230
    v_mul_f32 v23, v23, v230
    v_mul_f32 v24, v24, v230
    v_mul_f32 v25, v25, v230
    v_mul_f32 v26, v26, v230
    v_mul_f32 v27, v27, v230
    v_mul_f32 v28, v28, v230
    v_mul_f32 v29, v29, v230
    v_mul_f32 v30, v30, v230
    v_mul_f32 v31, v31, v230
    v_mul_f32 v32, v32, v230
    v_mul_f32 v33, v33, v230
    v_mul_f32 v34, v34, v230
    v_mul_f32 v35, v35, v230
    v_mul_f32 v36, v36, v230
    v_mul_f32 v37, v37, v230
    v_mul_f32 v38, v38, v230
    v_mul_f32 v39, v39, v230
    v_mul_f32 v40, v40, v230
    v_mul_f32 v41, v41, v230
    v_mul_f32 v42, v42, v230
    v_mul_f32 v43, v43, v230
    v_mul_f32 v44, v44, v230
    v_mul_f32 v45, v45, v230
    v_mul_f32 v46, v46, v230
    v_mul_f32 v47, v47, v230
    v_mul_f32 v48, v48, v230
    v_mul_f32 v49, v49, v230
    v_mul_f32 v50, v50, v230
    v_mul_f32 v51, v51, v230
    v_mul_f32 v52, v52, v230
    v_mul_f32 v53, v53, v230
    v_mul_f32 v54, v54, v230
    v_mul_f32 v55, v55, v230
    v_mul_f32 v56, v56, v230
    v_mul_f32 v57, v57, v230
    v_mul_f32 v58, v58, v230
    v_mul_f32 v59, v59, v230
    v_mul_f32 v60, v60, v230
    v_mul_f32 v61, v61, v230
    v_mul_f32 v62, v62, v230
    v_mul_f32 v63, v63, v230
    v_mul_f32 v64, v64, v230
    v_mul_f32 v65, v65, v230
    v_mul_f32 v66, v66, v230
    v_mul_f32 v67, v67, v230
    v_mul_f32 v68, v68, v230
    v_mul_f32 v69, v69, v230
    v_mul_f32 v70, v70, v230
    v_mul_f32 v71, v71, v230
    v_mul_f32 v72, v72, v230
    v_mul_f32 v73, v73, v230
    v_mul_f32 v74, v74, v230
    v_mul_f32 v75, v75, v230
    v_mul_f32 v76, v76, v230
    v_mul_f32 v77, v77, v230
    v_mul_f32 v78, v78, v230
    v_mul_f32 v79, v79, v230
    v_mul_f32 v80, v80, v230
    v_mul_f32 v81, v81, v230
    v_mul_f32 v82, v82, v230
    v_mul_f32 v83, v83, v230
    v_mul_f32 v84, v84, v230
    v_mul_f32 v85, v85, v230
    v_mul_f32 v86, v86, v230
    v_mul_f32 v87, v87, v230
    v_mul_f32 v88, v88, v230
    v_mul_f32 v89, v89, v230
    v_mul_f32 v90, v90, v230
    v_mul_f32 v91, v91, v230
    v_mul_f32 v92, v92, v230
    v_mul_f32 v93, v93, v230
    v_mul_f32 v94, v94, v230
    v_mul_f32 v95, v95, v230
    v_mul_f32 v96, v96, v230
    v_mul_f32 v97, v97, v230
    v_mul_f32 v98, v98, v230
    v_mul_f32 v99, v99, v230
    v_mul_f32 v100, v100, v230
    v_mul_f32 v101, v101, v230
    v_mul_f32 v102, v102, v230
    v_mul_f32 v103, v103, v230
    v_mul_f32 v104, v104, v230
    v_mul_f32 v105, v105, v230
    v_mul_f32 v106, v106, v230
    v_mul_f32 v107, v107, v230
    v_mul_f32 v108, v108, v230
    v_mul_f32 v109, v109, v230
    v_mul_f32 v110, v110, v230
    v_mul_f32 v111, v111, v230
    v_mul_f32 v112, v112, v230
    v_mul_f32 v113, v113, v230
    v_mul_f32 v114, v114, v230
    v_mul_f32 v115, v115, v230
    v_mul_f32 v116, v116, v230
    v_mul_f32 v117, v117, v230
    v_mul_f32 v118, v118, v230
    v_mul_f32 v119, v119, v230
    v_mul_f32 v120, v120, v230
    v_mul_f32 v121, v121, v230
    v_mul_f32 v122, v122, v230
    v_mul_f32 v123, v123, v230
    v_mul_f32 v124, v124, v230
    v_mul_f32 v125, v125, v230
    v_mul_f32 v126, v126, v230
    v_mul_f32 v127, v127, v230
    v_accvgpr_read_b32 v234, a0
    v_accvgpr_read_b32 v235, a1
    v_accvgpr_read_b32 v236, a2
    v_accvgpr_read_b32 v237, a3
    v_mul_f32 v234, v234, v231
    v_mul_f32 v235, v235, v231
    v_mul_f32 v236, v236, v231
    v_mul_f32 v237, v237, v231
    v_accvgpr_write_b32 a0, v234
    v_accvgpr_write_b32 a1, v235
    v_accvgpr_write_b32 a2, v236
    v_accvgpr_write_b32 a3, v237
    v_accvgpr_read_b32 v234, a4
    v_accvgpr_read_b32 v235, a5
    v_accvgpr_read_b32 v236, a6
    v_accvgpr_read_b32 v237, a7
    v_mul_f32 v234, v234, v231
    v_mul_f32 v235, v235, v231
    v_mul_f32 v236, v236, v231
    v_mul_f32 v237, v237, v231
    v_accvgpr_write_b32 a4, v234
    v_accvgpr_write_b32 a5, v235
    v_accvgpr_write_b32 a6, v236
    v_accvgpr_write_b32 a7, v237
    v_accvgpr_read_b32 v234, a8
    v_accvgpr_read_b32 v235, a9
    v_accvgpr_read_b32 v236, a10
    v_accvgpr_read_b32 v237, a11
    v_mul_f32 v234, v234, v231
    v_mul_f32 v235, v235, v231
    v_mul_f32 v236, v236, v231
    v_mul_f32 v237, v237, v231
    v_accvgpr_write_b32 a8, v234
    v_accvgpr_write_b32 a9, v235
    v_accvgpr_write_b32 a10, v236
    v_accvgpr_write_b32 a11, v237
    v_accvgpr_read_b32 v234, a12
    v_accvgpr_read_b32 v235, a13
    v_accvgpr_read_b32 v236, a14
    v_accvgpr_read_b32 v237, a15
    v_mul_f32 v234, v234, v231
    v_mul_f32 v235, v235, v231
    v_mul_f32 v236, v236, v231
    v_mul_f32 v237, v237, v231
    v_accvgpr_write_b32 a12, v234
    v_accvgpr_write_b32 a13, v235
    v_accvgpr_write_b32 a14, v236
    v_accvgpr_write_b32 a15, v237
    v_accvgpr_read_b32 v234, a16
    v_accvgpr_read_b32 v235, a17
    v_accvgpr_read_b32 v236, a18
    v_accvgpr_read_b32 v237, a19
    v_mul_f32 v234, v234, v231
    v_mul_f32 v235, v235, v231
    v_mul_f32 v236, v236, v231
    v_mul_f32 v237, v237, v231
    v_accvgpr_write_b32 a16, v234
    v_accvgpr_write_b32 a17, v235
    v_accvgpr_write_b32 a18, v236
    v_accvgpr_write_b32 a19, v237
    v_accvgpr_read_b32 v234, a20
    v_accvgpr_read_b32 v235, a21
    v_accvgpr_read_b32 v236, a22
    v_accvgpr_read_b32 v237, a23
    v_mul_f32 v234, v234, v231
    v_mul_f32 v235, v235, v231
    v_mul_f32 v236, v236, v231
    v_mul_f32 v237, v237, v231
    v_accvgpr_write_b32 a20, v234
    v_accvgpr_write_b32 a21, v235
    v_accvgpr_write_b32 a22, v236
    v_accvgpr_write_b32 a23, v237
    v_accvgpr_read_b32 v234, a24
    v_accvgpr_read_b32 v235, a25
    v_accvgpr_read_b32 v236, a26
    v_accvgpr_read_b32 v237, a27
    v_mul_f32 v234, v234, v231
    v_mul_f32 v235, v235, v231
    v_mul_f32 v236, v236, v231
    v_mul_f32 v237, v237, v231
    v_accvgpr_write_b32 a24, v234
    v_accvgpr_write_b32 a25, v235
    v_accvgpr_write_b32 a26, v236
    v_accvgpr_write_b32 a27, v237
    v_accvgpr_read_b32 v234, a28
    v_accvgpr_read_b32 v235, a29
    v_accvgpr_read_b32 v236, a30
    v_accvgpr_read_b32 v237, a31
    v_mul_f32 v234, v234, v231
    v_mul_f32 v235, v235, v231
    v_mul_f32 v236, v236, v231
    v_mul_f32 v237, v237, v231
    v_accvgpr_write_b32 a28, v234
    v_accvgpr_write_b32 a29, v235
    v_accvgpr_write_b32 a30, v236
    v_accvgpr_write_b32 a31, v237
    v_accvgpr_read_b32 v234, a32
    v_accvgpr_read_b32 v235, a33
    v_accvgpr_read_b32 v236, a34
    v_accvgpr_read_b32 v237, a35
    v_mul_f32 v234, v234, v231
    v_mul_f32 v235, v235, v231
    v_mul_f32 v236, v236, v231
    v_mul_f32 v237, v237, v231
    v_accvgpr_write_b32 a32, v234
    v_accvgpr_write_b32 a33, v235
    v_accvgpr_write_b32 a34, v236
    v_accvgpr_write_b32 a35, v237
    v_accvgpr_read_b32 v234, a36
    v_accvgpr_read_b32 v235, a37
    v_accvgpr_read_b32 v236, a38
    v_accvgpr_read_b32 v237, a39
    v_mul_f32 v234, v234, v231
    v_mul_f32 v235, v235, v231
    v_mul_f32 v236, v236, v231
    v_mul_f32 v237, v237, v231
    v_accvgpr_write_b32 a36, v234
    v_accvgpr_write_b32 a37, v235
    v_accvgpr_write_b32 a38, v236
    v_accvgpr_write_b32 a39, v237
    v_accvgpr_read_b32 v234, a40
    v_accvgpr_read_b32 v235, a41
    v_accvgpr_read_b32 v236, a42
    v_accvgpr_read_b32 v237, a43
    v_mul_f32 v234, v234, v231
    v_mul_f32 v235, v235, v231
    v_mul_f32 v236, v236, v231
    v_mul_f32 v237, v237, v231
    v_accvgpr_write_b32 a40, v234
    v_accvgpr_write_b32 a41, v235
    v_accvgpr_write_b32 a42, v236
    v_accvgpr_write_b32 a43, v237
    v_accvgpr_read_b32 v234, a44
    v_accvgpr_read_b32 v235, a45
    v_accvgpr_read_b32 v236, a46
    v_accvgpr_read_b32 v237, a47
    v_mul_f32 v234, v234, v231
    v_mul_f32 v235, v235, v231
    v_mul_f32 v236, v236, v231
    v_mul_f32 v237, v237, v231
    v_accvgpr_write_b32 a44, v234
    v_accvgpr_write_b32 a45, v235
    v_accvgpr_write_b32 a46, v236
    v_accvgpr_write_b32 a47, v237
    v_accvgpr_read_b32 v234, a48
    v_accvgpr_read_b32 v235, a49
    v_accvgpr_read_b32 v236, a50
    v_accvgpr_read_b32 v237, a51
    v_mul_f32 v234, v234, v231
    v_mul_f32 v235, v235, v231
    v_mul_f32 v236, v236, v231
    v_mul_f32 v237, v237, v231
    v_accvgpr_write_b32 a48, v234
    v_accvgpr_write_b32 a49, v235
    v_accvgpr_write_b32 a50, v236
    v_accvgpr_write_b32 a51, v237
    v_accvgpr_read_b32 v234, a52
    v_accvgpr_read_b32 v235, a53
    v_accvgpr_read_b32 v236, a54
    v_accvgpr_read_b32 v237, a55
    v_mul_f32 v234, v234, v231
    v_mul_f32 v235, v235, v231
    v_mul_f32 v236, v236, v231
    v_mul_f32 v237, v237, v231
    v_accvgpr_write_b32 a52, v234
    v_accvgpr_write_b32 a53, v235
    v_accvgpr_write_b32 a54, v236
    v_accvgpr_write_b32 a55, v237
    v_accvgpr_read_b32 v234, a56
    v_accvgpr_read_b32 v235, a57
    v_accvgpr_read_b32 v236, a58
    v_accvgpr_read_b32 v237, a59
    v_mul_f32 v234, v234, v231
    v_mul_f32 v235, v235, v231
    v_mul_f32 v236, v236, v231
    v_mul_f32 v237, v237, v231
    v_accvgpr_write_b32 a56, v234
    v_accvgpr_write_b32 a57, v235
    v_accvgpr_write_b32 a58, v236
    v_accvgpr_write_b32 a59, v237
    v_accvgpr_read_b32 v234, a60
    v_accvgpr_read_b32 v235, a61
    v_accvgpr_read_b32 v236, a62
    v_accvgpr_read_b32 v237, a63
    v_mul_f32 v234, v234, v231
    v_mul_f32 v235, v235, v231
    v_mul_f32 v236, v236, v231
    v_mul_f32 v237, v237, v231
    v_accvgpr_write_b32 a60, v234
    v_accvgpr_write_b32 a61, v235
    v_accvgpr_write_b32 a62, v236
    v_accvgpr_write_b32 a63, v237
    v_accvgpr_read_b32 v234, a64
    v_accvgpr_read_b32 v235, a65
    v_accvgpr_read_b32 v236, a66
    v_accvgpr_read_b32 v237, a67
    v_mul_f32 v234, v234, v231
    v_mul_f32 v235, v235, v231
    v_mul_f32 v236, v236, v231
    v_mul_f32 v237, v237, v231
    v_accvgpr_write_b32 a64, v234
    v_accvgpr_write_b32 a65, v235
    v_accvgpr_write_b32 a66, v236
    v_accvgpr_write_b32 a67, v237
    v_accvgpr_read_b32 v234, a68
    v_accvgpr_read_b32 v235, a69
    v_accvgpr_read_b32 v236, a70
    v_accvgpr_read_b32 v237, a71
    v_mul_f32 v234, v234, v231
    v_mul_f32 v235, v235, v231
    v_mul_f32 v236, v236, v231
    v_mul_f32 v237, v237, v231
    v_accvgpr_write_b32 a68, v234
    v_accvgpr_write_b32 a69, v235
    v_accvgpr_write_b32 a70, v236
    v_accvgpr_write_b32 a71, v237
    v_accvgpr_read_b32 v234, a72
    v_accvgpr_read_b32 v235, a73
    v_accvgpr_read_b32 v236, a74
    v_accvgpr_read_b32 v237, a75
    v_mul_f32 v234, v234, v231
    v_mul_f32 v235, v235, v231
    v_mul_f32 v236, v236, v231
    v_mul_f32 v237, v237, v231
    v_accvgpr_write_b32 a72, v234
    v_accvgpr_write_b32 a73, v235
    v_accvgpr_write_b32 a74, v236
    v_accvgpr_write_b32 a75, v237
    v_accvgpr_read_b32 v234, a76
    v_accvgpr_read_b32 v235, a77
    v_accvgpr_read_b32 v236, a78
    v_accvgpr_read_b32 v237, a79
    v_mul_f32 v234, v234, v231
    v_mul_f32 v235, v235, v231
    v_mul_f32 v236, v236, v231
    v_mul_f32 v237, v237, v231
    v_accvgpr_write_b32 a76, v234
    v_accvgpr_write_b32 a77, v235
    v_accvgpr_write_b32 a78, v236
    v_accvgpr_write_b32 a79, v237
    v_accvgpr_read_b32 v234, a80
    v_accvgpr_read_b32 v235, a81
    v_accvgpr_read_b32 v236, a82
    v_accvgpr_read_b32 v237, a83
    v_mul_f32 v234, v234, v231
    v_mul_f32 v235, v235, v231
    v_mul_f32 v236, v236, v231
    v_mul_f32 v237, v237, v231
    v_accvgpr_write_b32 a80, v234
    v_accvgpr_write_b32 a81, v235
    v_accvgpr_write_b32 a82, v236
    v_accvgpr_write_b32 a83, v237
    v_accvgpr_read_b32 v234, a84
    v_accvgpr_read_b32 v235, a85
    v_accvgpr_read_b32 v236, a86
    v_accvgpr_read_b32 v237, a87
    v_mul_f32 v234, v234, v231
    v_mul_f32 v235, v235, v231
    v_mul_f32 v236, v236, v231
    v_mul_f32 v237, v237, v231
    v_accvgpr_write_b32 a84, v234
    v_accvgpr_write_b32 a85, v235
    v_accvgpr_write_b32 a86, v236
    v_accvgpr_write_b32 a87, v237
    v_accvgpr_read_b32 v234, a88
    v_accvgpr_read_b32 v235, a89
    v_accvgpr_read_b32 v236, a90
    v_accvgpr_read_b32 v237, a91
    v_mul_f32 v234, v234, v231
    v_mul_f32 v235, v235, v231
    v_mul_f32 v236, v236, v231
    v_mul_f32 v237, v237, v231
    v_accvgpr_write_b32 a88, v234
    v_accvgpr_write_b32 a89, v235
    v_accvgpr_write_b32 a90, v236
    v_accvgpr_write_b32 a91, v237
    v_accvgpr_read_b32 v234, a92
    v_accvgpr_read_b32 v235, a93
    v_accvgpr_read_b32 v236, a94
    v_accvgpr_read_b32 v237, a95
    v_mul_f32 v234, v234, v231
    v_mul_f32 v235, v235, v231
    v_mul_f32 v236, v236, v231
    v_mul_f32 v237, v237, v231
    v_accvgpr_write_b32 a92, v234
    v_accvgpr_write_b32 a93, v235
    v_accvgpr_write_b32 a94, v236
    v_accvgpr_write_b32 a95, v237
    v_accvgpr_read_b32 v234, a96
    v_accvgpr_read_b32 v235, a97
    v_accvgpr_read_b32 v236, a98
    v_accvgpr_read_b32 v237, a99
    v_mul_f32 v234, v234, v231
    v_mul_f32 v235, v235, v231
    v_mul_f32 v236, v236, v231
    v_mul_f32 v237, v237, v231
    v_accvgpr_write_b32 a96, v234
    v_accvgpr_write_b32 a97, v235
    v_accvgpr_write_b32 a98, v236
    v_accvgpr_write_b32 a99, v237
    v_accvgpr_read_b32 v234, a100
    v_accvgpr_read_b32 v235, a101
    v_accvgpr_read_b32 v236, a102
    v_accvgpr_read_b32 v237, a103
    v_mul_f32 v234, v234, v231
    v_mul_f32 v235, v235, v231
    v_mul_f32 v236, v236, v231
    v_mul_f32 v237, v237, v231
    v_accvgpr_write_b32 a100, v234
    v_accvgpr_write_b32 a101, v235
    v_accvgpr_write_b32 a102, v236
    v_accvgpr_write_b32 a103, v237
    v_accvgpr_read_b32 v234, a104
    v_accvgpr_read_b32 v235, a105
    v_accvgpr_read_b32 v236, a106
    v_accvgpr_read_b32 v237, a107
    v_mul_f32 v234, v234, v231
    v_mul_f32 v235, v235, v231
    v_mul_f32 v236, v236, v231
    v_mul_f32 v237, v237, v231
    v_accvgpr_write_b32 a104, v234
    v_accvgpr_write_b32 a105, v235
    v_accvgpr_write_b32 a106, v236
    v_accvgpr_write_b32 a107, v237
    v_accvgpr_read_b32 v234, a108
    v_accvgpr_read_b32 v235, a109
    v_accvgpr_read_b32 v236, a110
    v_accvgpr_read_b32 v237, a111
    v_mul_f32 v234, v234, v231
    v_mul_f32 v235, v235, v231
    v_mul_f32 v236, v236, v231
    v_mul_f32 v237, v237, v231
    v_accvgpr_write_b32 a108, v234
    v_accvgpr_write_b32 a109, v235
    v_accvgpr_write_b32 a110, v236
    v_accvgpr_write_b32 a111, v237
    v_accvgpr_read_b32 v234, a112
    v_accvgpr_read_b32 v235, a113
    v_accvgpr_read_b32 v236, a114
    v_accvgpr_read_b32 v237, a115
    v_mul_f32 v234, v234, v231
    v_mul_f32 v235, v235, v231
    v_mul_f32 v236, v236, v231
    v_mul_f32 v237, v237, v231
    v_accvgpr_write_b32 a112, v234
    v_accvgpr_write_b32 a113, v235
    v_accvgpr_write_b32 a114, v236
    v_accvgpr_write_b32 a115, v237
    v_accvgpr_read_b32 v234, a116
    v_accvgpr_read_b32 v235, a117
    v_accvgpr_read_b32 v236, a118
    v_accvgpr_read_b32 v237, a119
    v_mul_f32 v234, v234, v231
    v_mul_f32 v235, v235, v231
    v_mul_f32 v236, v236, v231
    v_mul_f32 v237, v237, v231
    v_accvgpr_write_b32 a116, v234
    v_accvgpr_write_b32 a117, v235
    v_accvgpr_write_b32 a118, v236
    v_accvgpr_write_b32 a119, v237
    v_accvgpr_read_b32 v234, a120
    v_accvgpr_read_b32 v235, a121
    v_accvgpr_read_b32 v236, a122
    v_accvgpr_read_b32 v237, a123
    v_mul_f32 v234, v234, v231
    v_mul_f32 v235, v235, v231
    v_mul_f32 v236, v236, v231
    v_mul_f32 v237, v237, v231
    v_accvgpr_write_b32 a120, v234
    v_accvgpr_write_b32 a121, v235
    v_accvgpr_write_b32 a122, v236
    v_accvgpr_write_b32 a123, v237
    v_accvgpr_read_b32 v234, a124
    v_accvgpr_read_b32 v235, a125
    v_accvgpr_read_b32 v236, a126
    v_accvgpr_read_b32 v237, a127
    v_mul_f32 v234, v234, v231
    v_mul_f32 v235, v235, v231
    v_mul_f32 v236, v236, v231
    v_mul_f32 v237, v237, v231
    v_accvgpr_write_b32 a124, v234
    v_accvgpr_write_b32 a125, v235
    v_accvgpr_write_b32 a126, v236
    v_accvgpr_write_b32 a127, v237
    v_mov_b32 v230, 1.0
    v_mov_b32 v231, 1.0
    s_mov_b32 s30, 0
    s_nop 1
    s_branch RBACK_25
RARE_26:
    v_max3_f32 v242, v128, v129, v130
    v_max3_f32 v243, v131, v132, v133
    v_max3_f32 v242, v242, v134, v135
    v_max3_f32 v243, v243, v136, v137
    v_max3_f32 v242, v242, v138, v139
    v_max3_f32 v243, v243, v140, v141
    v_max3_f32 v242, v242, v142, v143
    v_max_f32 v242, v242, v243
    v_mov_b32 v243, v242
    s_nop 1
    v_permlane32_swap_b32 v242, v243
    s_nop 1
    v_max_f32 v242, v242, v243
    v_mul_f32 v242, s20, v242
    v_max_f32_e64 v242, v242, -v226
    v_add_f32 v243, v226, v242
    v_exp_f32_e64 v243, -v243
    v_sub_f32 v226, 0, v242
    v_mul_f32 v228, v228, v243
    v_mul_f32 v230, v230, v243
    s_mov_b32 s30, 1
    v_fma_f32 v234, v128, s20, v226
    v_fma_f32 v235, v129, s20, v226
    v_exp_f32 v234, v234
    v_fma_f32 v236, v130, s20, v226
    v_exp_f32 v235, v235
    v_fma_f32 v237, v131, s20, v226
    v_exp_f32 v236, v236
    v_mov_b32 v232, v234
    v_fma_f32 v238, v132, s20, v226
    v_exp_f32 v237, v237
    v_mov_b32 v233, v235
    v_cvt_pk_bf16_f32 v184, v234, v235
    v_fma_f32 v239, v133, s20, v226
    v_exp_f32 v238, v238
    v_add_f32 v232, v232, v236
    v_fma_f32 v240, v134, s20, v226
    v_exp_f32 v239, v239
    v_add_f32 v233, v233, v237
    v_cvt_pk_bf16_f32 v185, v236, v237
    v_fma_f32 v241, v135, s20, v226
    v_exp_f32 v240, v240
    v_add_f32 v232, v232, v238
    v_fma_f32 v234, v136, s20, v226
    v_exp_f32 v241, v241
    v_add_f32 v233, v233, v239
    v_cvt_pk_bf16_f32 v186, v238, v239
    v_fma_f32 v235, v137, s20, v226
    v_exp_f32 v234, v234
    v_add_f32 v232, v232, v240
    v_fma_f32 v236, v138, s20, v226
    v_exp_f32 v235, v235
    v_add_f32 v233, v233, v241
    v_cvt_pk_bf16_f32 v187, v240, v241
    v_fma_f32 v237, v139, s20, v226
    v_exp_f32 v236, v236
    v_add_f32 v232, v232, v234
    v_fma_f32 v238, v140, s20, v226
    v_exp_f32 v237, v237
    v_add_f32 v233, v233, v235
    v_cvt_pk_bf16_f32 v188, v234, v235
    v_fma_f32 v239, v141, s20, v226
    v_exp_f32 v238, v238
    v_add_f32 v232, v232, v236
    v_fma_f32 v240, v142, s20, v226
    v_exp_f32 v239, v239
    v_add_f32 v233, v233, v237
    v_cvt_pk_bf16_f32 v189, v236, v237
    v_fma_f32 v241, v143, s20, v226
    v_exp_f32 v240, v240
    v_add_f32 v232, v232, v238
    v_exp_f32 v241, v241
    v_add_f32 v233, v233, v239
    v_cvt_pk_bf16_f32 v190, v238, v239
    v_add_f32 v232, v232, v240
    v_add_f32 v233, v233, v241
    v_cvt_pk_bf16_f32 v191, v240, v241
    v_add_f32 v232, v232, v233
    s_branch BACK_26
RESC_27:
    s_nop 7
    s_nop 7
    v_mul_f32 v0, v0, v230
    v_mul_f32 v1, v1, v230
    v_mul_f32 v2, v2, v230
    v_mul_f32 v3, v3, v230
    v_mul_f32 v4, v4, v230
    v_mul_f32 v5, v5, v230
    v_mul_f32 v6, v6, v230
    v_mul_f32 v7, v7, v230
    v_mul_f32 v8, v8, v230
    v_mul_f32 v9, v9, v230
    v_mul_f32 v10, v10, v230
    v_mul_f32 v11, v11, v230
    v_mul_f32 v12, v12, v230
    v_mul_f32 v13, v13, v230
    v_mul_f32 v14, v14, v230
    v_mul_f32 v15, v15, v230
    v_mul_f32 v16, v16, v230
    v_mul_f32 v17, v17, v230
    v_mul_f32 v18, v18, v230
    v_mul_f32 v19, v19, v230
    v_mul_f32 v20, v20, v230
    v_mul_f32 v21, v21, v230
    v_mul_f32 v22, v22, v230
    v_mul_f32 v23, v23, v230
    v_mul_f32 v24, v24, v230
    v_mul_f32 v25, v25, v230
    v_mul_f32 v26, v26, v230
    v_mul_f32 v27, v27, v230
    v_mul_f32 v28, v28, v230
    v_mul_f32 v29, v29, v230
    v_mul_f32 v30, v30, v230
    v_mul_f32 v31, v31, v230
    v_mul_f32 v32, v32, v230
    v_mul_f32 v33, v33, v230
    v_mul_f32 v34, v34, v230
    v_mul_f32 v35, v35, v230
    v_mul_f32 v36, v36, v230
    v_mul_f32 v37, v37, v230
    v_mul_f32 v38, v38, v230
    v_mul_f32 v39, v39, v230
    v_mul_f32 v40, v40, v230
    v_mul_f32 v41, v41, v230
    v_mul_f32 v42, v42, v230
    v_mul_f32 v43, v43, v230
    v_mul_f32 v44, v44, v230
    v_mul_f32 v45, v45, v230
    v_mul_f32 v46, v46, v230
    v_mul_f32 v47, v47, v230
    v_mul_f32 v48, v48, v230
    v_mul_f32 v49, v49, v230
    v_mul_f32 v50, v50, v230
    v_mul_f32 v51, v51, v230
    v_mul_f32 v52, v52, v230
    v_mul_f32 v53, v53, v230
    v_mul_f32 v54, v54, v230
    v_mul_f32 v55, v55, v230
    v_mul_f32 v56, v56, v230
    v_mul_f32 v57, v57, v230
    v_mul_f32 v58, v58, v230
    v_mul_f32 v59, v59, v230
    v_mul_f32 v60, v60, v230
    v_mul_f32 v61, v61, v230
    v_mul_f32 v62, v62, v230
    v_mul_f32 v63, v63, v230
    v_mul_f32 v64, v64, v230
    v_mul_f32 v65, v65, v230
    v_mul_f32 v66, v66, v230
    v_mul_f32 v67, v67, v230
    v_mul_f32 v68, v68, v230
    v_mul_f32 v69, v69, v230
    v_mul_f32 v70, v70, v230
    v_mul_f32 v71, v71, v230
    v_mul_f32 v72, v72, v230
    v_mul_f32 v73, v73, v230
    v_mul_f32 v74, v74, v230
    v_mul_f32 v75, v75, v230
    v_mul_f32 v76, v76, v230
    v_mul_f32 v77, v77, v230
    v_mul_f32 v78, v78, v230
    v_mul_f32 v79, v79, v230
    v_mul_f32 v80, v80, v230
    v_mul_f32 v81, v81, v230
    v_mul_f32 v82, v82, v230
    v_mul_f32 v83, v83, v230
    v_mul_f32 v84, v84, v230
    v_mul_f32 v85, v85, v230
    v_mul_f32 v86, v86, v230
    v_mul_f32 v87, v87, v230
    v_mul_f32 v88, v88, v230
    v_mul_f32 v89, v89, v230
    v_mul_f32 v90, v90, v230
    v_mul_f32 v91, v91, v230
    v_mul_f32 v92, v92, v230
    v_mul_f32 v93, v93, v230
    v_mul_f32 v94, v94, v230
    v_mul_f32 v95, v95, v230
    v_mul_f32 v96, v96, v230
    v_mul_f32 v97, v97, v230
    v_mul_f32 v98, v98, v230
    v_mul_f32 v99, v99, v230
    v_mul_f32 v100, v100, v230
    v_mul_f32 v101, v101, v230
    v_mul_f32 v102, v102, v230
    v_mul_f32 v103, v103, v230
    v_mul_f32 v104, v104, v230
    v_mul_f32 v105, v105, v230
    v_mul_f32 v106, v106, v230
    v_mul_f32 v107, v107, v230
    v_mul_f32 v108, v108, v230
    v_mul_f32 v109, v109, v230
    v_mul_f32 v110, v110, v230
    v_mul_f32 v111, v111, v230
    v_mul_f32 v112, v112, v230
    v_mul_f32 v113, v113, v230
    v_mul_f32 v114, v114, v230
    v_mul_f32 v115, v115, v230
    v_mul_f32 v116, v116, v230
    v_mul_f32 v117, v117, v230
    v_mul_f32 v118, v118, v230
    v_mul_f32 v119, v119, v230
    v_mul_f32 v120, v120, v230
    v_mul_f32 v121, v121, v230
    v_mul_f32 v122, v122, v230
    v_mul_f32 v123, v123, v230
    v_mul_f32 v124, v124, v230
    v_mul_f32 v125, v125, v230
    v_mul_f32 v126, v126, v230
    v_mul_f32 v127, v127, v230
    v_accvgpr_read_b32 v234, a0
    v_accvgpr_read_b32 v235, a1
    v_accvgpr_read_b32 v236, a2
    v_accvgpr_read_b32 v237, a3
    v_mul_f32 v234, v234, v231
    v_mul_f32 v235, v235, v231
    v_mul_f32 v236, v236, v231
    v_mul_f32 v237, v237, v231
    v_accvgpr_write_b32 a0, v234
    v_accvgpr_write_b32 a1, v235
    v_accvgpr_write_b32 a2, v236
    v_accvgpr_write_b32 a3, v237
    v_accvgpr_read_b32 v234, a4
    v_accvgpr_read_b32 v235, a5
    v_accvgpr_read_b32 v236, a6
    v_accvgpr_read_b32 v237, a7
    v_mul_f32 v234, v234, v231
    v_mul_f32 v235, v235, v231
    v_mul_f32 v236, v236, v231
    v_mul_f32 v237, v237, v231
    v_accvgpr_write_b32 a4, v234
    v_accvgpr_write_b32 a5, v235
    v_accvgpr_write_b32 a6, v236
    v_accvgpr_write_b32 a7, v237
    v_accvgpr_read_b32 v234, a8
    v_accvgpr_read_b32 v235, a9
    v_accvgpr_read_b32 v236, a10
    v_accvgpr_read_b32 v237, a11
    v_mul_f32 v234, v234, v231
    v_mul_f32 v235, v235, v231
    v_mul_f32 v236, v236, v231
    v_mul_f32 v237, v237, v231
    v_accvgpr_write_b32 a8, v234
    v_accvgpr_write_b32 a9, v235
    v_accvgpr_write_b32 a10, v236
    v_accvgpr_write_b32 a11, v237
    v_accvgpr_read_b32 v234, a12
    v_accvgpr_read_b32 v235, a13
    v_accvgpr_read_b32 v236, a14
    v_accvgpr_read_b32 v237, a15
    v_mul_f32 v234, v234, v231
    v_mul_f32 v235, v235, v231
    v_mul_f32 v236, v236, v231
    v_mul_f32 v237, v237, v231
    v_accvgpr_write_b32 a12, v234
    v_accvgpr_write_b32 a13, v235
    v_accvgpr_write_b32 a14, v236
    v_accvgpr_write_b32 a15, v237
    v_accvgpr_read_b32 v234, a16
    v_accvgpr_read_b32 v235, a17
    v_accvgpr_read_b32 v236, a18
    v_accvgpr_read_b32 v237, a19
    v_mul_f32 v234, v234, v231
    v_mul_f32 v235, v235, v231
    v_mul_f32 v236, v236, v231
    v_mul_f32 v237, v237, v231
    v_accvgpr_write_b32 a16, v234
    v_accvgpr_write_b32 a17, v235
    v_accvgpr_write_b32 a18, v236
    v_accvgpr_write_b32 a19, v237
    v_accvgpr_read_b32 v234, a20
    v_accvgpr_read_b32 v235, a21
    v_accvgpr_read_b32 v236, a22
    v_accvgpr_read_b32 v237, a23
    v_mul_f32 v234, v234, v231
    v_mul_f32 v235, v235, v231
    v_mul_f32 v236, v236, v231
    v_mul_f32 v237, v237, v231
    v_accvgpr_write_b32 a20, v234
    v_accvgpr_write_b32 a21, v235
    v_accvgpr_write_b32 a22, v236
    v_accvgpr_write_b32 a23, v237
    v_accvgpr_read_b32 v234, a24
    v_accvgpr_read_b32 v235, a25
    v_accvgpr_read_b32 v236, a26
    v_accvgpr_read_b32 v237, a27
    v_mul_f32 v234, v234, v231
    v_mul_f32 v235, v235, v231
    v_mul_f32 v236, v236, v231
    v_mul_f32 v237, v237, v231
    v_accvgpr_write_b32 a24, v234
    v_accvgpr_write_b32 a25, v235
    v_accvgpr_write_b32 a26, v236
    v_accvgpr_write_b32 a27, v237
    v_accvgpr_read_b32 v234, a28
    v_accvgpr_read_b32 v235, a29
    v_accvgpr_read_b32 v236, a30
    v_accvgpr_read_b32 v237, a31
    v_mul_f32 v234, v234, v231
    v_mul_f32 v235, v235, v231
    v_mul_f32 v236, v236, v231
    v_mul_f32 v237, v237, v231
    v_accvgpr_write_b32 a28, v234
    v_accvgpr_write_b32 a29, v235
    v_accvgpr_write_b32 a30, v236
    v_accvgpr_write_b32 a31, v237
    v_accvgpr_read_b32 v234, a32
    v_accvgpr_read_b32 v235, a33
    v_accvgpr_read_b32 v236, a34
    v_accvgpr_read_b32 v237, a35
    v_mul_f32 v234, v234, v231
    v_mul_f32 v235, v235, v231
    v_mul_f32 v236, v236, v231
    v_mul_f32 v237, v237, v231
    v_accvgpr_write_b32 a32, v234
    v_accvgpr_write_b32 a33, v235
    v_accvgpr_write_b32 a34, v236
    v_accvgpr_write_b32 a35, v237
    v_accvgpr_read_b32 v234, a36
    v_accvgpr_read_b32 v235, a37
    v_accvgpr_read_b32 v236, a38
    v_accvgpr_read_b32 v237, a39
    v_mul_f32 v234, v234, v231
    v_mul_f32 v235, v235, v231
    v_mul_f32 v236, v236, v231
    v_mul_f32 v237, v237, v231
    v_accvgpr_write_b32 a36, v234
    v_accvgpr_write_b32 a37, v235
    v_accvgpr_write_b32 a38, v236
    v_accvgpr_write_b32 a39, v237
    v_accvgpr_read_b32 v234, a40
    v_accvgpr_read_b32 v235, a41
    v_accvgpr_read_b32 v236, a42
    v_accvgpr_read_b32 v237, a43
    v_mul_f32 v234, v234, v231
    v_mul_f32 v235, v235, v231
    v_mul_f32 v236, v236, v231
    v_mul_f32 v237, v237, v231
    v_accvgpr_write_b32 a40, v234
    v_accvgpr_write_b32 a41, v235
    v_accvgpr_write_b32 a42, v236
    v_accvgpr_write_b32 a43, v237
    v_accvgpr_read_b32 v234, a44
    v_accvgpr_read_b32 v235, a45
    v_accvgpr_read_b32 v236, a46
    v_accvgpr_read_b32 v237, a47
    v_mul_f32 v234, v234, v231
    v_mul_f32 v235, v235, v231
    v_mul_f32 v236, v236, v231
    v_mul_f32 v237, v237, v231
    v_accvgpr_write_b32 a44, v234
    v_accvgpr_write_b32 a45, v235
    v_accvgpr_write_b32 a46, v236
    v_accvgpr_write_b32 a47, v237
    v_accvgpr_read_b32 v234, a48
    v_accvgpr_read_b32 v235, a49
    v_accvgpr_read_b32 v236, a50
    v_accvgpr_read_b32 v237, a51
    v_mul_f32 v234, v234, v231
    v_mul_f32 v235, v235, v231
    v_mul_f32 v236, v236, v231
    v_mul_f32 v237, v237, v231
    v_accvgpr_write_b32 a48, v234
    v_accvgpr_write_b32 a49, v235
    v_accvgpr_write_b32 a50, v236
    v_accvgpr_write_b32 a51, v237
    v_accvgpr_read_b32 v234, a52
    v_accvgpr_read_b32 v235, a53
    v_accvgpr_read_b32 v236, a54
    v_accvgpr_read_b32 v237, a55
    v_mul_f32 v234, v234, v231
    v_mul_f32 v235, v235, v231
    v_mul_f32 v236, v236, v231
    v_mul_f32 v237, v237, v231
    v_accvgpr_write_b32 a52, v234
    v_accvgpr_write_b32 a53, v235
    v_accvgpr_write_b32 a54, v236
    v_accvgpr_write_b32 a55, v237
    v_accvgpr_read_b32 v234, a56
    v_accvgpr_read_b32 v235, a57
    v_accvgpr_read_b32 v236, a58
    v_accvgpr_read_b32 v237, a59
    v_mul_f32 v234, v234, v231
    v_mul_f32 v235, v235, v231
    v_mul_f32 v236, v236, v231
    v_mul_f32 v237, v237, v231
    v_accvgpr_write_b32 a56, v234
    v_accvgpr_write_b32 a57, v235
    v_accvgpr_write_b32 a58, v236
    v_accvgpr_write_b32 a59, v237
    v_accvgpr_read_b32 v234, a60
    v_accvgpr_read_b32 v235, a61
    v_accvgpr_read_b32 v236, a62
    v_accvgpr_read_b32 v237, a63
    v_mul_f32 v234, v234, v231
    v_mul_f32 v235, v235, v231
    v_mul_f32 v236, v236, v231
    v_mul_f32 v237, v237, v231
    v_accvgpr_write_b32 a60, v234
    v_accvgpr_write_b32 a61, v235
    v_accvgpr_write_b32 a62, v236
    v_accvgpr_write_b32 a63, v237
    v_accvgpr_read_b32 v234, a64
    v_accvgpr_read_b32 v235, a65
    v_accvgpr_read_b32 v236, a66
    v_accvgpr_read_b32 v237, a67
    v_mul_f32 v234, v234, v231
    v_mul_f32 v235, v235, v231
    v_mul_f32 v236, v236, v231
    v_mul_f32 v237, v237, v231
    v_accvgpr_write_b32 a64, v234
    v_accvgpr_write_b32 a65, v235
    v_accvgpr_write_b32 a66, v236
    v_accvgpr_write_b32 a67, v237
    v_accvgpr_read_b32 v234, a68
    v_accvgpr_read_b32 v235, a69
    v_accvgpr_read_b32 v236, a70
    v_accvgpr_read_b32 v237, a71
    v_mul_f32 v234, v234, v231
    v_mul_f32 v235, v235, v231
    v_mul_f32 v236, v236, v231
    v_mul_f32 v237, v237, v231
    v_accvgpr_write_b32 a68, v234
    v_accvgpr_write_b32 a69, v235
    v_accvgpr_write_b32 a70, v236
    v_accvgpr_write_b32 a71, v237
    v_accvgpr_read_b32 v234, a72
    v_accvgpr_read_b32 v235, a73
    v_accvgpr_read_b32 v236, a74
    v_accvgpr_read_b32 v237, a75
    v_mul_f32 v234, v234, v231
    v_mul_f32 v235, v235, v231
    v_mul_f32 v236, v236, v231
    v_mul_f32 v237, v237, v231
    v_accvgpr_write_b32 a72, v234
    v_accvgpr_write_b32 a73, v235
    v_accvgpr_write_b32 a74, v236
    v_accvgpr_write_b32 a75, v237
    v_accvgpr_read_b32 v234, a76
    v_accvgpr_read_b32 v235, a77
    v_accvgpr_read_b32 v236, a78
    v_accvgpr_read_b32 v237, a79
    v_mul_f32 v234, v234, v231
    v_mul_f32 v235, v235, v231
    v_mul_f32 v236, v236, v231
    v_mul_f32 v237, v237, v231
    v_accvgpr_write_b32 a76, v234
    v_accvgpr_write_b32 a77, v235
    v_accvgpr_write_b32 a78, v236
    v_accvgpr_write_b32 a79, v237
    v_accvgpr_read_b32 v234, a80
    v_accvgpr_read_b32 v235, a81
    v_accvgpr_read_b32 v236, a82
    v_accvgpr_read_b32 v237, a83
    v_mul_f32 v234, v234, v231
    v_mul_f32 v235, v235, v231
    v_mul_f32 v236, v236, v231
    v_mul_f32 v237, v237, v231
    v_accvgpr_write_b32 a80, v234
    v_accvgpr_write_b32 a81, v235
    v_accvgpr_write_b32 a82, v236
    v_accvgpr_write_b32 a83, v237
    v_accvgpr_read_b32 v234, a84
    v_accvgpr_read_b32 v235, a85
    v_accvgpr_read_b32 v236, a86
    v_accvgpr_read_b32 v237, a87
    v_mul_f32 v234, v234, v231
    v_mul_f32 v235, v235, v231
    v_mul_f32 v236, v236, v231
    v_mul_f32 v237, v237, v231
    v_accvgpr_write_b32 a84, v234
    v_accvgpr_write_b32 a85, v235
    v_accvgpr_write_b32 a86, v236
    v_accvgpr_write_b32 a87, v237
    v_accvgpr_read_b32 v234, a88
    v_accvgpr_read_b32 v235, a89
    v_accvgpr_read_b32 v236, a90
    v_accvgpr_read_b32 v237, a91
    v_mul_f32 v234, v234, v231
    v_mul_f32 v235, v235, v231
    v_mul_f32 v236, v236, v231
    v_mul_f32 v237, v237, v231
    v_accvgpr_write_b32 a88, v234
    v_accvgpr_write_b32 a89, v235
    v_accvgpr_write_b32 a90, v236
    v_accvgpr_write_b32 a91, v237
    v_accvgpr_read_b32 v234, a92
    v_accvgpr_read_b32 v235, a93
    v_accvgpr_read_b32 v236, a94
    v_accvgpr_read_b32 v237, a95
    v_mul_f32 v234, v234, v231
    v_mul_f32 v235, v235, v231
    v_mul_f32 v236, v236, v231
    v_mul_f32 v237, v237, v231
    v_accvgpr_write_b32 a92, v234
    v_accvgpr_write_b32 a93, v235
    v_accvgpr_write_b32 a94, v236
    v_accvgpr_write_b32 a95, v237
    v_accvgpr_read_b32 v234, a96
    v_accvgpr_read_b32 v235, a97
    v_accvgpr_read_b32 v236, a98
    v_accvgpr_read_b32 v237, a99
    v_mul_f32 v234, v234, v231
    v_mul_f32 v235, v235, v231
    v_mul_f32 v236, v236, v231
    v_mul_f32 v237, v237, v231
    v_accvgpr_write_b32 a96, v234
    v_accvgpr_write_b32 a97, v235
    v_accvgpr_write_b32 a98, v236
    v_accvgpr_write_b32 a99, v237
    v_accvgpr_read_b32 v234, a100
    v_accvgpr_read_b32 v235, a101
    v_accvgpr_read_b32 v236, a102
    v_accvgpr_read_b32 v237, a103
    v_mul_f32 v234, v234, v231
    v_mul_f32 v235, v235, v231
    v_mul_f32 v236, v236, v231
    v_mul_f32 v237, v237, v231
    v_accvgpr_write_b32 a100, v234
    v_accvgpr_write_b32 a101, v235
    v_accvgpr_write_b32 a102, v236
    v_accvgpr_write_b32 a103, v237
    v_accvgpr_read_b32 v234, a104
    v_accvgpr_read_b32 v235, a105
    v_accvgpr_read_b32 v236, a106
    v_accvgpr_read_b32 v237, a107
    v_mul_f32 v234, v234, v231
    v_mul_f32 v235, v235, v231
    v_mul_f32 v236, v236, v231
    v_mul_f32 v237, v237, v231
    v_accvgpr_write_b32 a104, v234
    v_accvgpr_write_b32 a105, v235
    v_accvgpr_write_b32 a106, v236
    v_accvgpr_write_b32 a107, v237
    v_accvgpr_read_b32 v234, a108
    v_accvgpr_read_b32 v235, a109
    v_accvgpr_read_b32 v236, a110
    v_accvgpr_read_b32 v237, a111
    v_mul_f32 v234, v234, v231
    v_mul_f32 v235, v235, v231
    v_mul_f32 v236, v236, v231
    v_mul_f32 v237, v237, v231
    v_accvgpr_write_b32 a108, v234
    v_accvgpr_write_b32 a109, v235
    v_accvgpr_write_b32 a110, v236
    v_accvgpr_write_b32 a111, v237
    v_accvgpr_read_b32 v234, a112
    v_accvgpr_read_b32 v235, a113
    v_accvgpr_read_b32 v236, a114
    v_accvgpr_read_b32 v237, a115
    v_mul_f32 v234, v234, v231
    v_mul_f32 v235, v235, v231
    v_mul_f32 v236, v236, v231
    v_mul_f32 v237, v237, v231
    v_accvgpr_write_b32 a112, v234
    v_accvgpr_write_b32 a113, v235
    v_accvgpr_write_b32 a114, v236
    v_accvgpr_write_b32 a115, v237
    v_accvgpr_read_b32 v234, a116
    v_accvgpr_read_b32 v235, a117
    v_accvgpr_read_b32 v236, a118
    v_accvgpr_read_b32 v237, a119
    v_mul_f32 v234, v234, v231
    v_mul_f32 v235, v235, v231
    v_mul_f32 v236, v236, v231
    v_mul_f32 v237, v237, v231
    v_accvgpr_write_b32 a116, v234
    v_accvgpr_write_b32 a117, v235
    v_accvgpr_write_b32 a118, v236
    v_accvgpr_write_b32 a119, v237
    v_accvgpr_read_b32 v234, a120
    v_accvgpr_read_b32 v235, a121
    v_accvgpr_read_b32 v236, a122
    v_accvgpr_read_b32 v237, a123
    v_mul_f32 v234, v234, v231
    v_mul_f32 v235, v235, v231
    v_mul_f32 v236, v236, v231
    v_mul_f32 v237, v237, v231
    v_accvgpr_write_b32 a120, v234
    v_accvgpr_write_b32 a121, v235
    v_accvgpr_write_b32 a122, v236
    v_accvgpr_write_b32 a123, v237
    v_accvgpr_read_b32 v234, a124
    v_accvgpr_read_b32 v235, a125
    v_accvgpr_read_b32 v236, a126
    v_accvgpr_read_b32 v237, a127
    v_mul_f32 v234, v234, v231
    v_mul_f32 v235, v235, v231
    v_mul_f32 v236, v236, v231
    v_mul_f32 v237, v237, v231
    v_accvgpr_write_b32 a124, v234
    v_accvgpr_write_b32 a125, v235
    v_accvgpr_write_b32 a126, v236
    v_accvgpr_write_b32 a127, v237
    v_mov_b32 v230, 1.0
    v_mov_b32 v231, 1.0
    s_mov_b32 s30, 0
    s_nop 1
    s_branch RBACK_27
RARE_28:
    v_max3_f32 v242, v160, v161, v162
    v_max3_f32 v243, v163, v164, v165
    v_max3_f32 v242, v242, v166, v167
    v_max3_f32 v243, v243, v168, v169
    v_max3_f32 v242, v242, v170, v171
    v_max3_f32 v243, v243, v172, v173
    v_max3_f32 v242, v242, v174, v175
    v_max_f32 v242, v242, v243
    v_mov_b32 v243, v242
    s_nop 1
    v_permlane32_swap_b32 v242, v243
    s_nop 1
    v_max_f32 v242, v242, v243
    v_mul_f32 v242, s20, v242
    v_max_f32_e64 v242, v242, -v227
    v_add_f32 v243, v227, v242
    v_exp_f32_e64 v243, -v243
    v_sub_f32 v227, 0, v242
    v_mul_f32 v229, v229, v243
    v_mul_f32 v231, v231, v243
    s_mov_b32 s30, 1
    v_fma_f32 v234, v160, s20, v227
    v_fma_f32 v235, v161, s20, v227
    v_exp_f32 v234, v234
    v_fma_f32 v236, v162, s20, v227
    v_exp_f32 v235, v235
    v_fma_f32 v237, v163, s20, v227
    v_exp_f32 v236, v236
    v_mov_b32 v232, v234
    v_fma_f32 v238, v164, s20, v227
    v_exp_f32 v237, v237
    v_mov_b32 v233, v235
    v_cvt_pk_bf16_f32 v192, v234, v235
    v_fma_f32 v239, v165, s20, v227
    v_exp_f32 v238, v238
    v_add_f32 v232, v232, v236
    v_fma_f32 v240, v166, s20, v227
    v_exp_f32 v239, v239
    v_add_f32 v233, v233, v237
    v_cvt_pk_bf16_f32 v193, v236, v237
    v_fma_f32 v241, v167, s20, v227
    v_exp_f32 v240, v240
    v_add_f32 v232, v232, v238
    v_fma_f32 v234, v168, s20, v227
    v_exp_f32 v241, v241
    v_add_f32 v233, v233, v239
    v_cvt_pk_bf16_f32 v194, v238, v239
    v_fma_f32 v235, v169, s20, v227
    v_exp_f32 v234, v234
    v_add_f32 v232, v232, v240
    v_fma_f32 v236, v170, s20, v227
    v_exp_f32 v235, v235
    v_add_f32 v233, v233, v241
    v_cvt_pk_bf16_f32 v195, v240, v241
    v_fma_f32 v237, v171, s20, v227
    v_exp_f32 v236, v236
    v_add_f32 v232, v232, v234
    v_fma_f32 v238, v172, s20, v227
    v_exp_f32 v237, v237
    v_add_f32 v233, v233, v235
    v_cvt_pk_bf16_f32 v196, v234, v235
    v_fma_f32 v239, v173, s20, v227
    v_exp_f32 v238, v238
    v_add_f32 v232, v232, v236
    v_fma_f32 v240, v174, s20, v227
    v_exp_f32 v239, v239
    v_add_f32 v233, v233, v237
    v_cvt_pk_bf16_f32 v197, v236, v237
    v_fma_f32 v241, v175, s20, v227
    v_exp_f32 v240, v240
    v_add_f32 v232, v232, v238
    v_exp_f32 v241, v241
    v_add_f32 v233, v233, v239
    v_cvt_pk_bf16_f32 v198, v238, v239
    v_add_f32 v232, v232, v240
    v_add_f32 v233, v233, v241
    v_cvt_pk_bf16_f32 v199, v240, v241
    v_add_f32 v232, v232, v233
    s_branch BACK_28
RESC_29:
    s_nop 7
    s_nop 7
    v_mul_f32 v0, v0, v230
    v_mul_f32 v1, v1, v230
    v_mul_f32 v2, v2, v230
    v_mul_f32 v3, v3, v230
    v_mul_f32 v4, v4, v230
    v_mul_f32 v5, v5, v230
    v_mul_f32 v6, v6, v230
    v_mul_f32 v7, v7, v230
    v_mul_f32 v8, v8, v230
    v_mul_f32 v9, v9, v230
    v_mul_f32 v10, v10, v230
    v_mul_f32 v11, v11, v230
    v_mul_f32 v12, v12, v230
    v_mul_f32 v13, v13, v230
    v_mul_f32 v14, v14, v230
    v_mul_f32 v15, v15, v230
    v_mul_f32 v16, v16, v230
    v_mul_f32 v17, v17, v230
    v_mul_f32 v18, v18, v230
    v_mul_f32 v19, v19, v230
    v_mul_f32 v20, v20, v230
    v_mul_f32 v21, v21, v230
    v_mul_f32 v22, v22, v230
    v_mul_f32 v23, v23, v230
    v_mul_f32 v24, v24, v230
    v_mul_f32 v25, v25, v230
    v_mul_f32 v26, v26, v230
    v_mul_f32 v27, v27, v230
    v_mul_f32 v28, v28, v230
    v_mul_f32 v29, v29, v230
    v_mul_f32 v30, v30, v230
    v_mul_f32 v31, v31, v230
    v_mul_f32 v32, v32, v230
    v_mul_f32 v33, v33, v230
    v_mul_f32 v34, v34, v230
    v_mul_f32 v35, v35, v230
    v_mul_f32 v36, v36, v230
    v_mul_f32 v37, v37, v230
    v_mul_f32 v38, v38, v230
    v_mul_f32 v39, v39, v230
    v_mul_f32 v40, v40, v230
    v_mul_f32 v41, v41, v230
    v_mul_f32 v42, v42, v230
    v_mul_f32 v43, v43, v230
    v_mul_f32 v44, v44, v230
    v_mul_f32 v45, v45, v230
    v_mul_f32 v46, v46, v230
    v_mul_f32 v47, v47, v230
    v_mul_f32 v48, v48, v230
    v_mul_f32 v49, v49, v230
    v_mul_f32 v50, v50, v230
    v_mul_f32 v51, v51, v230
    v_mul_f32 v52, v52, v230
    v_mul_f32 v53, v53, v230
    v_mul_f32 v54, v54, v230
    v_mul_f32 v55, v55, v230
    v_mul_f32 v56, v56, v230
    v_mul_f32 v57, v57, v230
    v_mul_f32 v58, v58, v230
    v_mul_f32 v59, v59, v230
    v_mul_f32 v60, v60, v230
    v_mul_f32 v61, v61, v230
    v_mul_f32 v62, v62, v230
    v_mul_f32 v63, v63, v230
    v_mul_f32 v64, v64, v230
    v_mul_f32 v65, v65, v230
    v_mul_f32 v66, v66, v230
    v_mul_f32 v67, v67, v230
    v_mul_f32 v68, v68, v230
    v_mul_f32 v69, v69, v230
    v_mul_f32 v70, v70, v230
    v_mul_f32 v71, v71, v230
    v_mul_f32 v72, v72, v230
    v_mul_f32 v73, v73, v230
    v_mul_f32 v74, v74, v230
    v_mul_f32 v75, v75, v230
    v_mul_f32 v76, v76, v230
    v_mul_f32 v77, v77, v230
    v_mul_f32 v78, v78, v230
    v_mul_f32 v79, v79, v230
    v_mul_f32 v80, v80, v230
    v_mul_f32 v81, v81, v230
    v_mul_f32 v82, v82, v230
    v_mul_f32 v83, v83, v230
    v_mul_f32 v84, v84, v230
    v_mul_f32 v85, v85, v230
    v_mul_f32 v86, v86, v230
    v_mul_f32 v87, v87, v230
    v_mul_f32 v88, v88, v230
    v_mul_f32 v89, v89, v230
    v_mul_f32 v90, v90, v230
    v_mul_f32 v91, v91, v230
    v_mul_f32 v92, v92, v230
    v_mul_f32 v93, v93, v230
    v_mul_f32 v94, v94, v230
    v_mul_f32 v95, v95, v230
    v_mul_f32 v96, v96, v230
    v_mul_f32 v97, v97, v230
    v_mul_f32 v98, v98, v230
    v_mul_f32 v99, v99, v230
    v_mul_f32 v100, v100, v230
    v_mul_f32 v101, v101, v230
    v_mul_f32 v102, v102, v230
    v_mul_f32 v103, v103, v230
    v_mul_f32 v104, v104, v230
    v_mul_f32 v105, v105, v230
    v_mul_f32 v106, v106, v230
    v_mul_f32 v107, v107, v230
    v_mul_f32 v108, v108, v230
    v_mul_f32 v109, v109, v230
    v_mul_f32 v110, v110, v230
    v_mul_f32 v111, v111, v230
    v_mul_f32 v112, v112, v230
    v_mul_f32 v113, v113, v230
    v_mul_f32 v114, v114, v230
    v_mul_f32 v115, v115, v230
    v_mul_f32 v116, v116, v230
    v_mul_f32 v117, v117, v230
    v_mul_f32 v118, v118, v230
    v_mul_f32 v119, v119, v230
    v_mul_f32 v120, v120, v230
    v_mul_f32 v121, v121, v230
    v_mul_f32 v122, v122, v230
    v_mul_f32 v123, v123, v230
    v_mul_f32 v124, v124, v230
    v_mul_f32 v125, v125, v230
    v_mul_f32 v126, v126, v230
    v_mul_f32 v127, v127, v230
    v_accvgpr_read_b32 v234, a0
    v_accvgpr_read_b32 v235, a1
    v_accvgpr_read_b32 v236, a2
    v_accvgpr_read_b32 v237, a3
    v_mul_f32 v234, v234, v231
    v_mul_f32 v235, v235, v231
    v_mul_f32 v236, v236, v231
    v_mul_f32 v237, v237, v231
    v_accvgpr_write_b32 a0, v234
    v_accvgpr_write_b32 a1, v235
    v_accvgpr_write_b32 a2, v236
    v_accvgpr_write_b32 a3, v237
    v_accvgpr_read_b32 v234, a4
    v_accvgpr_read_b32 v235, a5
    v_accvgpr_read_b32 v236, a6
    v_accvgpr_read_b32 v237, a7
    v_mul_f32 v234, v234, v231
    v_mul_f32 v235, v235, v231
    v_mul_f32 v236, v236, v231
    v_mul_f32 v237, v237, v231
    v_accvgpr_write_b32 a4, v234
    v_accvgpr_write_b32 a5, v235
    v_accvgpr_write_b32 a6, v236
    v_accvgpr_write_b32 a7, v237
    v_accvgpr_read_b32 v234, a8
    v_accvgpr_read_b32 v235, a9
    v_accvgpr_read_b32 v236, a10
    v_accvgpr_read_b32 v237, a11
    v_mul_f32 v234, v234, v231
    v_mul_f32 v235, v235, v231
    v_mul_f32 v236, v236, v231
    v_mul_f32 v237, v237, v231
    v_accvgpr_write_b32 a8, v234
    v_accvgpr_write_b32 a9, v235
    v_accvgpr_write_b32 a10, v236
    v_accvgpr_write_b32 a11, v237
    v_accvgpr_read_b32 v234, a12
    v_accvgpr_read_b32 v235, a13
    v_accvgpr_read_b32 v236, a14
    v_accvgpr_read_b32 v237, a15
    v_mul_f32 v234, v234, v231
    v_mul_f32 v235, v235, v231
    v_mul_f32 v236, v236, v231
    v_mul_f32 v237, v237, v231
    v_accvgpr_write_b32 a12, v234
    v_accvgpr_write_b32 a13, v235
    v_accvgpr_write_b32 a14, v236
    v_accvgpr_write_b32 a15, v237
    v_accvgpr_read_b32 v234, a16
    v_accvgpr_read_b32 v235, a17
    v_accvgpr_read_b32 v236, a18
    v_accvgpr_read_b32 v237, a19
    v_mul_f32 v234, v234, v231
    v_mul_f32 v235, v235, v231
    v_mul_f32 v236, v236, v231
    v_mul_f32 v237, v237, v231
    v_accvgpr_write_b32 a16, v234
    v_accvgpr_write_b32 a17, v235
    v_accvgpr_write_b32 a18, v236
    v_accvgpr_write_b32 a19, v237
    v_accvgpr_read_b32 v234, a20
    v_accvgpr_read_b32 v235, a21
    v_accvgpr_read_b32 v236, a22
    v_accvgpr_read_b32 v237, a23
    v_mul_f32 v234, v234, v231
    v_mul_f32 v235, v235, v231
    v_mul_f32 v236, v236, v231
    v_mul_f32 v237, v237, v231
    v_accvgpr_write_b32 a20, v234
    v_accvgpr_write_b32 a21, v235
    v_accvgpr_write_b32 a22, v236
    v_accvgpr_write_b32 a23, v237
    v_accvgpr_read_b32 v234, a24
    v_accvgpr_read_b32 v235, a25
    v_accvgpr_read_b32 v236, a26
    v_accvgpr_read_b32 v237, a27
    v_mul_f32 v234, v234, v231
    v_mul_f32 v235, v235, v231
    v_mul_f32 v236, v236, v231
    v_mul_f32 v237, v237, v231
    v_accvgpr_write_b32 a24, v234
    v_accvgpr_write_b32 a25, v235
    v_accvgpr_write_b32 a26, v236
    v_accvgpr_write_b32 a27, v237
    v_accvgpr_read_b32 v234, a28
    v_accvgpr_read_b32 v235, a29
    v_accvgpr_read_b32 v236, a30
    v_accvgpr_read_b32 v237, a31
    v_mul_f32 v234, v234, v231
    v_mul_f32 v235, v235, v231
    v_mul_f32 v236, v236, v231
    v_mul_f32 v237, v237, v231
    v_accvgpr_write_b32 a28, v234
    v_accvgpr_write_b32 a29, v235
    v_accvgpr_write_b32 a30, v236
    v_accvgpr_write_b32 a31, v237
    v_accvgpr_read_b32 v234, a32
    v_accvgpr_read_b32 v235, a33
    v_accvgpr_read_b32 v236, a34
    v_accvgpr_read_b32 v237, a35
    v_mul_f32 v234, v234, v231
    v_mul_f32 v235, v235, v231
    v_mul_f32 v236, v236, v231
    v_mul_f32 v237, v237, v231
    v_accvgpr_write_b32 a32, v234
    v_accvgpr_write_b32 a33, v235
    v_accvgpr_write_b32 a34, v236
    v_accvgpr_write_b32 a35, v237
    v_accvgpr_read_b32 v234, a36
    v_accvgpr_read_b32 v235, a37
    v_accvgpr_read_b32 v236, a38
    v_accvgpr_read_b32 v237, a39
    v_mul_f32 v234, v234, v231
    v_mul_f32 v235, v235, v231
    v_mul_f32 v236, v236, v231
    v_mul_f32 v237, v237, v231
    v_accvgpr_write_b32 a36, v234
    v_accvgpr_write_b32 a37, v235
    v_accvgpr_write_b32 a38, v236
    v_accvgpr_write_b32 a39, v237
    v_accvgpr_read_b32 v234, a40
    v_accvgpr_read_b32 v235, a41
    v_accvgpr_read_b32 v236, a42
    v_accvgpr_read_b32 v237, a43
    v_mul_f32 v234, v234, v231
    v_mul_f32 v235, v235, v231
    v_mul_f32 v236, v236, v231
    v_mul_f32 v237, v237, v231
    v_accvgpr_write_b32 a40, v234
    v_accvgpr_write_b32 a41, v235
    v_accvgpr_write_b32 a42, v236
    v_accvgpr_write_b32 a43, v237
    v_accvgpr_read_b32 v234, a44
    v_accvgpr_read_b32 v235, a45
    v_accvgpr_read_b32 v236, a46
    v_accvgpr_read_b32 v237, a47
    v_mul_f32 v234, v234, v231
    v_mul_f32 v235, v235, v231
    v_mul_f32 v236, v236, v231
    v_mul_f32 v237, v237, v231
    v_accvgpr_write_b32 a44, v234
    v_accvgpr_write_b32 a45, v235
    v_accvgpr_write_b32 a46, v236
    v_accvgpr_write_b32 a47, v237
    v_accvgpr_read_b32 v234, a48
    v_accvgpr_read_b32 v235, a49
    v_accvgpr_read_b32 v236, a50
    v_accvgpr_read_b32 v237, a51
    v_mul_f32 v234, v234, v231
    v_mul_f32 v235, v235, v231
    v_mul_f32 v236, v236, v231
    v_mul_f32 v237, v237, v231
    v_accvgpr_write_b32 a48, v234
    v_accvgpr_write_b32 a49, v235
    v_accvgpr_write_b32 a50, v236
    v_accvgpr_write_b32 a51, v237
    v_accvgpr_read_b32 v234, a52
    v_accvgpr_read_b32 v235, a53
    v_accvgpr_read_b32 v236, a54
    v_accvgpr_read_b32 v237, a55
    v_mul_f32 v234, v234, v231
    v_mul_f32 v235, v235, v231
    v_mul_f32 v236, v236, v231
    v_mul_f32 v237, v237, v231
    v_accvgpr_write_b32 a52, v234
    v_accvgpr_write_b32 a53, v235
    v_accvgpr_write_b32 a54, v236
    v_accvgpr_write_b32 a55, v237
    v_accvgpr_read_b32 v234, a56
    v_accvgpr_read_b32 v235, a57
    v_accvgpr_read_b32 v236, a58
    v_accvgpr_read_b32 v237, a59
    v_mul_f32 v234, v234, v231
    v_mul_f32 v235, v235, v231
    v_mul_f32 v236, v236, v231
    v_mul_f32 v237, v237, v231
    v_accvgpr_write_b32 a56, v234
    v_accvgpr_write_b32 a57, v235
    v_accvgpr_write_b32 a58, v236
    v_accvgpr_write_b32 a59, v237
    v_accvgpr_read_b32 v234, a60
    v_accvgpr_read_b32 v235, a61
    v_accvgpr_read_b32 v236, a62
    v_accvgpr_read_b32 v237, a63
    v_mul_f32 v234, v234, v231
    v_mul_f32 v235, v235, v231
    v_mul_f32 v236, v236, v231
    v_mul_f32 v237, v237, v231
    v_accvgpr_write_b32 a60, v234
    v_accvgpr_write_b32 a61, v235
    v_accvgpr_write_b32 a62, v236
    v_accvgpr_write_b32 a63, v237
    v_accvgpr_read_b32 v234, a64
    v_accvgpr_read_b32 v235, a65
    v_accvgpr_read_b32 v236, a66
    v_accvgpr_read_b32 v237, a67
    v_mul_f32 v234, v234, v231
    v_mul_f32 v235, v235, v231
    v_mul_f32 v236, v236, v231
    v_mul_f32 v237, v237, v231
    v_accvgpr_write_b32 a64, v234
    v_accvgpr_write_b32 a65, v235
    v_accvgpr_write_b32 a66, v236
    v_accvgpr_write_b32 a67, v237
    v_accvgpr_read_b32 v234, a68
    v_accvgpr_read_b32 v235, a69
    v_accvgpr_read_b32 v236, a70
    v_accvgpr_read_b32 v237, a71
    v_mul_f32 v234, v234, v231
    v_mul_f32 v235, v235, v231
    v_mul_f32 v236, v236, v231
    v_mul_f32 v237, v237, v231
    v_accvgpr_write_b32 a68, v234
    v_accvgpr_write_b32 a69, v235
    v_accvgpr_write_b32 a70, v236
    v_accvgpr_write_b32 a71, v237
    v_accvgpr_read_b32 v234, a72
    v_accvgpr_read_b32 v235, a73
    v_accvgpr_read_b32 v236, a74
    v_accvgpr_read_b32 v237, a75
    v_mul_f32 v234, v234, v231
    v_mul_f32 v235, v235, v231
    v_mul_f32 v236, v236, v231
    v_mul_f32 v237, v237, v231
    v_accvgpr_write_b32 a72, v234
    v_accvgpr_write_b32 a73, v235
    v_accvgpr_write_b32 a74, v236
    v_accvgpr_write_b32 a75, v237
    v_accvgpr_read_b32 v234, a76
    v_accvgpr_read_b32 v235, a77
    v_accvgpr_read_b32 v236, a78
    v_accvgpr_read_b32 v237, a79
    v_mul_f32 v234, v234, v231
    v_mul_f32 v235, v235, v231
    v_mul_f32 v236, v236, v231
    v_mul_f32 v237, v237, v231
    v_accvgpr_write_b32 a76, v234
    v_accvgpr_write_b32 a77, v235
    v_accvgpr_write_b32 a78, v236
    v_accvgpr_write_b32 a79, v237
    v_accvgpr_read_b32 v234, a80
    v_accvgpr_read_b32 v235, a81
    v_accvgpr_read_b32 v236, a82
    v_accvgpr_read_b32 v237, a83
    v_mul_f32 v234, v234, v231
    v_mul_f32 v235, v235, v231
    v_mul_f32 v236, v236, v231
    v_mul_f32 v237, v237, v231
    v_accvgpr_write_b32 a80, v234
    v_accvgpr_write_b32 a81, v235
    v_accvgpr_write_b32 a82, v236
    v_accvgpr_write_b32 a83, v237
    v_accvgpr_read_b32 v234, a84
    v_accvgpr_read_b32 v235, a85
    v_accvgpr_read_b32 v236, a86
    v_accvgpr_read_b32 v237, a87
    v_mul_f32 v234, v234, v231
    v_mul_f32 v235, v235, v231
    v_mul_f32 v236, v236, v231
    v_mul_f32 v237, v237, v231
    v_accvgpr_write_b32 a84, v234
    v_accvgpr_write_b32 a85, v235
    v_accvgpr_write_b32 a86, v236
    v_accvgpr_write_b32 a87, v237
    v_accvgpr_read_b32 v234, a88
    v_accvgpr_read_b32 v235, a89
    v_accvgpr_read_b32 v236, a90
    v_accvgpr_read_b32 v237, a91
    v_mul_f32 v234, v234, v231
    v_mul_f32 v235, v235, v231
    v_mul_f32 v236, v236, v231
    v_mul_f32 v237, v237, v231
    v_accvgpr_write_b32 a88, v234
    v_accvgpr_write_b32 a89, v235
    v_accvgpr_write_b32 a90, v236
    v_accvgpr_write_b32 a91, v237
    v_accvgpr_read_b32 v234, a92
    v_accvgpr_read_b32 v235, a93
    v_accvgpr_read_b32 v236, a94
    v_accvgpr_read_b32 v237, a95
    v_mul_f32 v234, v234, v231
    v_mul_f32 v235, v235, v231
    v_mul_f32 v236, v236, v231
    v_mul_f32 v237, v237, v231
    v_accvgpr_write_b32 a92, v234
    v_accvgpr_write_b32 a93, v235
    v_accvgpr_write_b32 a94, v236
    v_accvgpr_write_b32 a95, v237
    v_accvgpr_read_b32 v234, a96
    v_accvgpr_read_b32 v235, a97
    v_accvgpr_read_b32 v236, a98
    v_accvgpr_read_b32 v237, a99
    v_mul_f32 v234, v234, v231
    v_mul_f32 v235, v235, v231
    v_mul_f32 v236, v236, v231
    v_mul_f32 v237, v237, v231
    v_accvgpr_write_b32 a96, v234
    v_accvgpr_write_b32 a97, v235
    v_accvgpr_write_b32 a98, v236
    v_accvgpr_write_b32 a99, v237
    v_accvgpr_read_b32 v234, a100
    v_accvgpr_read_b32 v235, a101
    v_accvgpr_read_b32 v236, a102
    v_accvgpr_read_b32 v237, a103
    v_mul_f32 v234, v234, v231
    v_mul_f32 v235, v235, v231
    v_mul_f32 v236, v236, v231
    v_mul_f32 v237, v237, v231
    v_accvgpr_write_b32 a100, v234
    v_accvgpr_write_b32 a101, v235
    v_accvgpr_write_b32 a102, v236
    v_accvgpr_write_b32 a103, v237
    v_accvgpr_read_b32 v234, a104
    v_accvgpr_read_b32 v235, a105
    v_accvgpr_read_b32 v236, a106
    v_accvgpr_read_b32 v237, a107
    v_mul_f32 v234, v234, v231
    v_mul_f32 v235, v235, v231
    v_mul_f32 v236, v236, v231
    v_mul_f32 v237, v237, v231
    v_accvgpr_write_b32 a104, v234
    v_accvgpr_write_b32 a105, v235
    v_accvgpr_write_b32 a106, v236
    v_accvgpr_write_b32 a107, v237
    v_accvgpr_read_b32 v234, a108
    v_accvgpr_read_b32 v235, a109
    v_accvgpr_read_b32 v236, a110
    v_accvgpr_read_b32 v237, a111
    v_mul_f32 v234, v234, v231
    v_mul_f32 v235, v235, v231
    v_mul_f32 v236, v236, v231
    v_mul_f32 v237, v237, v231
    v_accvgpr_write_b32 a108, v234
    v_accvgpr_write_b32 a109, v235
    v_accvgpr_write_b32 a110, v236
    v_accvgpr_write_b32 a111, v237
    v_accvgpr_read_b32 v234, a112
    v_accvgpr_read_b32 v235, a113
    v_accvgpr_read_b32 v236, a114
    v_accvgpr_read_b32 v237, a115
    v_mul_f32 v234, v234, v231
    v_mul_f32 v235, v235, v231
    v_mul_f32 v236, v236, v231
    v_mul_f32 v237, v237, v231
    v_accvgpr_write_b32 a112, v234
    v_accvgpr_write_b32 a113, v235
    v_accvgpr_write_b32 a114, v236
    v_accvgpr_write_b32 a115, v237
    v_accvgpr_read_b32 v234, a116
    v_accvgpr_read_b32 v235, a117
    v_accvgpr_read_b32 v236, a118
    v_accvgpr_read_b32 v237, a119
    v_mul_f32 v234, v234, v231
    v_mul_f32 v235, v235, v231
    v_mul_f32 v236, v236, v231
    v_mul_f32 v237, v237, v231
    v_accvgpr_write_b32 a116, v234
    v_accvgpr_write_b32 a117, v235
    v_accvgpr_write_b32 a118, v236
    v_accvgpr_write_b32 a119, v237
    v_accvgpr_read_b32 v234, a120
    v_accvgpr_read_b32 v235, a121
    v_accvgpr_read_b32 v236, a122
    v_accvgpr_read_b32 v237, a123
    v_mul_f32 v234, v234, v231
    v_mul_f32 v235, v235, v231
    v_mul_f32 v236, v236, v231
    v_mul_f32 v237, v237, v231
    v_accvgpr_write_b32 a120, v234
    v_accvgpr_write_b32 a121, v235
    v_accvgpr_write_b32 a122, v236
    v_accvgpr_write_b32 a123, v237
    v_accvgpr_read_b32 v234, a124
    v_accvgpr_read_b32 v235, a125
    v_accvgpr_read_b32 v236, a126
    v_accvgpr_read_b32 v237, a127
    v_mul_f32 v234, v234, v231
    v_mul_f32 v235, v235, v231
    v_mul_f32 v236, v236, v231
    v_mul_f32 v237, v237, v231
    v_accvgpr_write_b32 a124, v234
    v_accvgpr_write_b32 a125, v235
    v_accvgpr_write_b32 a126, v236
    v_accvgpr_write_b32 a127, v237
    v_mov_b32 v230, 1.0
    v_mov_b32 v231, 1.0
    s_mov_b32 s30, 0
    s_nop 1
    s_branch RBACK_29
.section .rodata,"a"
.p2align 6
.amdhsa_kernel standalone__gqa_softmax__near_ridge_kernel
  .amdhsa_next_free_vgpr 512
  .amdhsa_next_free_sgpr 102
  .amdhsa_accum_offset 256
  .amdhsa_group_segment_fixed_size 0
  .amdhsa_kernarg_size 48
  .amdhsa_user_sgpr_count 2
  .amdhsa_user_sgpr_kernarg_segment_ptr 1
  .amdhsa_system_sgpr_workgroup_id_x 1
.end_amdhsa_kernel
```
